```python
import torch

def _softmax(x, axis=-1):
    return torch.softmax(x, dim=axis)
def _gelu(x):
    return torch.nn.functional.gelu(x, approximate="tanh")
def _silu(x):
    return torch.nn.functional.silu(x)
def _sigmoid(x):
    return torch.sigmoid(x)
def _layernorm(x, axis=-1, eps=1e-5):
    m = x.mean(dim=axis, keepdim=True)
    v = x.var(dim=axis, keepdim=True, unbiased=False)
    return (x - m) / torch.sqrt(v + eps)
def _scatter_add(tgt, idx, src, axis=0):
    return tgt.clone().index_add_(axis, idx, src)
def _segment_sum(src, seg, n):
    out = torch.zeros((n,) + src.shape[1:], dtype=src.dtype)
    return out.index_add_(0, seg, src)
def _pad(x, pw):
    flat = tuple(v for pair in reversed(pw) for v in pair)
    return torch.nn.functional.pad(x, flat)

kernel_name = 'gated_mix__mha_block__swiglu_ffn__prompt'

def setup_inputs():

    _w = (lambda a: (lambda t: t.to(torch.bfloat16) if t.is_floating_point() else t)(torch.as_tensor(a)))
    def _A_setup():
        B, S, D, H = 1, 2048, 640, 32
        return {
            "x": _w((lambda *s: torch.randn(*s, dtype=torch.bfloat16) * 0.05)(B, S, D)),
            "wqkv": _w((lambda *s: torch.randn(*s, dtype=torch.bfloat16) * 0.8)(D, 3 * D)),
            "wo": _w((lambda *s: torch.randn(*s, dtype=torch.bfloat16) * 0.05)(D, D)),
        }
    _A_in = _A_setup()

    def _B_setup():
        B, S, D, F = 1, 2048, 640, 1536
        return {
            "x": _w((lambda *s: torch.randn(*s, dtype=torch.bfloat16) * 0.05)(B, S, D)),
            "w_gate": _w((lambda *s: torch.randn(*s, dtype=torch.bfloat16) * 0.1)(D, F)),
            "w_up": _w((lambda *s: torch.randn(*s, dtype=torch.bfloat16) * 0.1)(D, F)),
            "w_down": _w((lambda *s: torch.randn(*s, dtype=torch.bfloat16) * 0.1)(F, D)),
        }
    _B_in = _B_setup()

    return {
        "A_x": _A_in["x"],
        "A_wqkv": _A_in["wqkv"],
        "A_wo": _A_in["wo"],
        "B_x": _B_in["x"],
        "B_w_gate": _B_in["w_gate"],
        "B_w_up": _B_in["w_up"],
        "B_w_down": _B_in["w_down"],
        "gate_w": _w((lambda *s: torch.randn(*s, dtype=torch.bfloat16) * 0.05)(640) * 16.0),
    }

def reference(A_x, A_wqkv, A_wo, B_x, B_w_gate, B_w_up, B_w_down, gate_w):
    def _A_ref(x, wqkv, wo):
        B, S, D = x.shape
        H = 32
        Dh = D // H
        qkv = (lambda x, *d: x.permute(*d))((x @ wqkv).reshape(B, S, 3, H, Dh), 2, 0, 3, 1, 4)
        q, k, v = qkv[0], qkv[1], qkv[2]
        scores = torch.einsum("bhqd,bhkd->bhqk", q, k) * (Dh ** -0.5)
        p = _softmax(scores, axis=-1)
        o = torch.einsum("bhqk,bhkd->bhqd", p, v)
        return (lambda x, *d: x.permute(*d))(o, 0, 2, 1, 3).reshape(B, S, D) @ wo

    def _B_ref(x, w_gate, w_up, w_down):
        g = _silu(x @ w_gate)
        u = x @ w_up
        return (g * u) @ w_down

    x = A_x
    g = _sigmoid((x * gate_w).sum(-1, keepdims=True))
    a = _A_ref(x, A_wqkv, A_wo)
    b = _B_ref(x, B_w_gate, B_w_up, B_w_down)
    return g * a + (1 - g) * b
```

```asm
; @launch grid=(256,1,1) block=(512,1,1) lds=161024
.amdgcn_target "amdgcn-amd-amdhsa--gfx950"
.text
.globl gated_mix__mha_block__swiglu_ffn__prompt_kernel
.p2align 8
.type gated_mix__mha_block__swiglu_ffn__prompt_kernel,@function
gated_mix__mha_block__swiglu_ffn__prompt_kernel:
    s_cmp_ge_u32 s2, 256
    s_cbranch_scc1 L_end
    s_load_dwordx16 s[4:19], s[0:1], 0
    s_load_dwordx4 s[20:23], s[0:1], 64
    s_load_dwordx2 s[24:25], s[0:1], 80
    s_memrealtime s[50:51]
    v_lshrrev_b32 v15, 6, v0
    v_and_b32 v1, 63, v0
    v_readfirstlane_b32 s44, v15
    v_and_b32 v2, 31, v0
    v_lshrrev_b32 v3, 5, v1
    s_and_b32 s45, s44, 3
    s_and_b32 s52, s2, 1
    s_lshl_b32 s52, s52, 3
    s_bfe_u32 s53, s2, 0x30003
    s_add_u32 s46, s52, s53
    s_bfe_u32 s47, s2, 0x20001
    s_lshr_b32 s48, s2, 6
    s_mul_i32 s52, s48, 5
    s_add_u32 s52, s52, 1
    s_lshr_b32 s52, s52, 1
    s_add_u32 s58, s52, s53
    s_cmp_ge_u32 s58, 10
    s_cselect_b32 s52, 10, 0
    s_sub_u32 s58, s58, s52
    s_lshl_b32 s65, s46, 2
    s_add_u32 s65, s65, s45
    v_lshrrev_b32 v15, 3, v1
    v_and_b32 v16, 7, v1
    v_lshrrev_b32 v17, 1, v15
    v_xor_b32 v16, v16, v17
    v_lshlrev_b32 v16, 4, v16
    v_mul_u32_u24 v15, 1280, v15
    v_add_u32 v4, v15, v16
    s_mul_i32 s52, s65, 40960
    v_add_u32 v4, s52, v4
    v_xor_b32 v5, 64, v4
    s_lshr_b32 s26, s45, 1
    s_and_b32 s27, s45, 1
    s_mul_i32 s56, s26, 40960
    s_lshl_b32 s52, s27, 12
    s_add_u32 s56, s56, s52
    s_lshl_b32 s62, s47, 2
    s_add_u32 s62, s62, s48
    s_min_u32 s3, s62, 14
    s_cmp_lg_u32 s44, 1
    s_cbranch_scc1 L_A_nocpf
    s_getpc_b64 s[68:69]
L_pc:
    s_sub_u32 s68, s68, L_pc-gated_mix__mha_block__swiglu_ffn__prompt_kernel
    s_subb_u32 s69, s69, 0
    s_lshr_b32 s52, s2, 3
    s_and_b32 s52, s52, 7
    s_lshl_b32 s52, s52, 13
    v_lshlrev_b32 v15, 7, v1
    v_add_u32 v15, s52, v15
    v_min_u32 v15, L_end-gated_mix__mha_block__swiglu_ffn__prompt_kernel, v15
    global_load_dword v127, v15, s[68:69]
L_A_nocpf:
    s_waitcnt lgkmcnt(0)
    s_or_b32 s52, s2, s44
    s_cbranch_scc1 L_notok
    s_mov_b32 s40, s22
    s_mov_b32 s41, s23
    s_mov_b32 s42, 256
    s_mov_b32 s43, 0x20000
    s_or_b32 s50, s50, 1
    v_mov_b32 v16, s50
    v_mov_b32 v17, s51
    v_mov_b32 v18, 0
    s_mov_b64 exec, 1
    buffer_store_dwordx2 v[16:17], v18, s[40:43], 0 offen sc1
    s_mov_b64 exec, -1
L_notok:
    s_mov_b32 s28, s4
    s_mov_b32 s29, s5
    s_mov_b32 s30, 2621440
    s_mov_b32 s31, 0x20000
    s_mov_b32 s36, s24
    s_mov_b32 s37, s25
    s_mov_b32 s38, 28311552
    s_mov_b32 s39, 0x20000
    s_cmp_lt_u32 s44, 4
    s_cbranch_scc1 L_A
L_G:
    s_lshl_b32 s59, s58, 7
    s_add_u32 m0, s56, 0
    s_add_u32 s55, s59, 0
    buffer_load_dwordx4 v4, s[28:31], s55 offen lds
    s_add_u32 m0, s56, 1024
    s_add_u32 s55, s59, 10240
    buffer_load_dwordx4 v5, s[28:31], s55 offen lds
    s_add_u32 m0, s56, 2048
    s_add_u32 s55, s59, 20480
    buffer_load_dwordx4 v4, s[28:31], s55 offen lds
    s_add_u32 m0, s56, 3072
    s_add_u32 s55, s59, 30720
    buffer_load_dwordx4 v5, s[28:31], s55 offen lds
    s_mov_b32 s32, s6
    s_mov_b32 s33, s7
    s_mov_b32 s34, 2457600
    s_mov_b32 s35, 0x20000
    s_lshl_b32 s54, s3, 8
    s_mul_i32 s52, s45, 61440
    s_add_u32 s52, s52, s54
    v_lshrrev_b32 v15, 4, v1
    v_and_b32 v16, 15, v1
    v_lshlrev_b32 v17, 2, v15
    v_xor_b32 v16, v16, v17
    v_lshlrev_b32 v16, 4, v16
    v_mul_u32_u24 v15, 3840, v15
    v_add3_u32 v6, v15, v16, s52
    s_lshl_b32 s57, s45, 12
    s_add_u32 s57, s57, 81920
    s_mul_i32 s60, s58, 245760
    s_add_u32 m0, s57, 0
    s_add_u32 s55, s60, 0
    buffer_load_dwordx4 v6, s[32:35], s55 offen lds
    s_add_u32 m0, s57, 1024
    s_add_u32 s55, s60, 15360
    buffer_load_dwordx4 v6, s[32:35], s55 offen lds
    s_add_u32 m0, s57, 2048
    s_add_u32 s55, s60, 30720
    buffer_load_dwordx4 v6, s[32:35], s55 offen lds
    s_add_u32 m0, s57, 3072
    s_add_u32 s55, s60, 46080
    buffer_load_dwordx4 v6, s[32:35], s55 offen lds
    s_mov_b32 s61, s58
    s_add_u32 s58, s58, 1
    s_cmp_ge_u32 s58, 10
    s_cselect_b32 s54, 10, 0
    s_sub_u32 s58, s58, s54
    s_mov_b32 s40, s18
    s_mov_b32 s41, s19
    s_mov_b32 s42, 1280
    s_mov_b32 s43, 0x20000
    v_lshlrev_b32 v15, 4, v1
    s_mul_i32 s52, s45, 320
    s_add_u32 m0, s52, 155776
    s_mov_b64 exec, 0xfffff
    buffer_load_dwordx4 v15, s[40:43], s52 offen lds
    s_mov_b64 exec, -1
    s_mul_i32 s60, s58, 245760
    s_add_u32 m0, s57, 24608
    s_add_u32 s55, s60, 0
    buffer_load_dwordx4 v6, s[32:35], s55 offen lds
    s_add_u32 m0, s57, 25632
    s_add_u32 s55, s60, 15360
    buffer_load_dwordx4 v6, s[32:35], s55 offen lds
    v_lshrrev_b32 v15, 1, v2
    v_and_b32 v15, 7, v15
    v_xor_b32 v15, v15, v3
    v_lshlrev_b32 v15, 4, v15
    v_lshlrev_b32 v16, 7, v2
    s_mul_i32 s52, s26, 40960
    v_add3_u32 v9, v15, v16, s52
    v_xor_b32 v10, 32, v9
    v_xor_b32 v11, 64, v9
    v_xor_b32 v12, 96, v9
    v_bfe_u32 v18, v1, 2, 2
    v_lshl_add_u32 v15, v3, 3, v18
    v_bfe_u32 v16, v1, 4, 1
    v_and_b32 v17, 3, v1
    v_mul_u32_u24 v15, 192, v15
    v_mul_u32_u24 v16, 12320, v16
    v_lshlrev_b32 v17, 3, v17
    v_add3_u32 v13, v15, v16, v17
    s_mul_i32 s52, s27, 96
    s_add_u32 s52, s52, 81920
    v_add_u32 v13, s52, v13
    s_mov_b32 s53, 960
    s_mov_b32 s54, 20480
    v_add_u32 v44, 0, v1
    v_mul_u32_u24 v45, 3277, v44
    v_lshrrev_b32 v45, 16, v45
    v_lshlrev_b32 v44, 4, v44
    v_mad_u32_u24 v44, v45, s53, v44
    v_accvgpr_write_b32 a40, v44
    v_lshrrev_b32 v45, 2, v45
    v_mad_u32_u24 v45, v45, s54, v44
    v_accvgpr_write_b32 a45, v45
    v_add_u32 v44, 64, v1
    v_mul_u32_u24 v45, 3277, v44
    v_lshrrev_b32 v45, 16, v45
    v_lshlrev_b32 v44, 4, v44
    v_mad_u32_u24 v44, v45, s53, v44
    v_accvgpr_write_b32 a41, v44
    v_lshrrev_b32 v45, 2, v45
    v_mad_u32_u24 v45, v45, s54, v44
    v_accvgpr_write_b32 a46, v45
    v_add_u32 v44, 128, v1
    v_mul_u32_u24 v45, 3277, v44
    v_lshrrev_b32 v45, 16, v45
    v_lshlrev_b32 v44, 4, v44
    v_mad_u32_u24 v44, v45, s53, v44
    v_accvgpr_write_b32 a42, v44
    v_lshrrev_b32 v45, 2, v45
    v_mad_u32_u24 v45, v45, s54, v44
    v_accvgpr_write_b32 a47, v45
    v_add_u32 v44, 192, v1
    v_mul_u32_u24 v45, 3277, v44
    v_lshrrev_b32 v45, 16, v45
    v_lshlrev_b32 v44, 4, v44
    v_mad_u32_u24 v44, v45, s53, v44
    v_accvgpr_write_b32 a43, v44
    v_lshrrev_b32 v45, 2, v45
    v_mad_u32_u24 v45, v45, s54, v44
    v_accvgpr_write_b32 a48, v45
    v_add_u32 v44, 256, v1
    v_mul_u32_u24 v45, 3277, v44
    v_lshrrev_b32 v45, 16, v45
    v_lshlrev_b32 v44, 4, v44
    v_mad_u32_u24 v44, v45, s53, v44
    v_accvgpr_write_b32 a44, v44
    v_lshrrev_b32 v45, 2, v45
    v_mad_u32_u24 v45, v45, s54, v44
    v_accvgpr_write_b32 a49, v45
    s_mul_i32 s52, s45, 21504
    s_add_u32 s52, s52, 73728
    v_bfe_u32 v44, v1, 2, 2
    v_lshl_add_u32 v44, v3, 2, v44
    v_mul_u32_u24 v44, 320, v44
    v_bfe_u32 v45, v1, 4, 1
    v_lshl_add_u32 v44, v45, 5, v44
    v_and_b32 v46, 3, v1
    v_lshlrev_b32 v46, 3, v46
    v_add3_u32 v44, v44, v46, s52
    v_accvgpr_write_b32 a50, v44
    v_mul_u32_u24 v44, 656, v2
    v_lshl_add_u32 v44, v3, 4, v44
    v_add_u32 v44, s52, v44
    v_accvgpr_write_b32 a126, v44
    s_and_b32 s52, s2, 7
    s_lshl_b32 s52, s52, 2
    s_bfe_u32 s53, s2, 0x20003
    s_add_u32 s53, s52, s53
    s_mul_i32 s53, s53, 1280
    s_lshr_b32 s52, s2, 5
    s_lshl_b32 s52, s52, 2
    s_add_u32 s52, s52, s45
    s_mul_i32 s52, s52, 81920
    s_add_u32 s52, s52, s53
    s_add_u32 s52, s52, 17825792
    v_lshlrev_b32 v20, 4, v1
    v_add_u32 v20, s52, v20
    v_bfe_u32 v21, v1, 4, 1
    v_mul_u32_u24 v21, 40704, v21
    v_lshlrev_b32 v44, 30, v3
    v_add3_u32 v21, v21, v20, v44
    s_mov_b32 s53, 16
    s_mov_b32 s54, 960
    v_add_u32 v44, -256, v0
    v_mul_u32_u24 v45, 3277, v44
    v_lshrrev_b32 v45, 16, v45
    v_lshlrev_b32 v46, 5, v44
    v_mad_u32_u24 v47, v45, s53, v46
    v_add_u32 v47, 73728, v47
    v_accvgpr_write_b32 a120, v47
    v_lshlrev_b32 v46, 4, v44
    v_mad_u32_u24 v47, v45, s54, v46
    v_accvgpr_write_b32 a123, v47
    v_lshlrev_b32 v45, 2, v45
    v_add_u32 v45, 159872, v45
    v_accvgpr_write_b32 a51, v45
    v_add_u32 v44, 0, v0
    v_mul_u32_u24 v45, 3277, v44
    v_lshrrev_b32 v45, 16, v45
    v_lshlrev_b32 v46, 5, v44
    v_mad_u32_u24 v47, v45, s53, v46
    v_add_u32 v47, 73728, v47
    v_accvgpr_write_b32 a121, v47
    v_lshlrev_b32 v46, 4, v44
    v_mad_u32_u24 v47, v45, s54, v46
    v_accvgpr_write_b32 a124, v47
    v_lshlrev_b32 v45, 2, v45
    v_add_u32 v45, 159872, v45
    v_accvgpr_write_b32 a52, v45
    v_add_u32 v44, 256, v0
    v_min_u32 v44, 639, v44
    v_mul_u32_u24 v45, 3277, v44
    v_lshrrev_b32 v45, 16, v45
    v_lshlrev_b32 v46, 5, v44
    v_mad_u32_u24 v47, v45, s53, v46
    v_add_u32 v47, 73728, v47
    v_accvgpr_write_b32 a122, v47
    v_lshlrev_b32 v46, 4, v44
    v_mad_u32_u24 v47, v45, s54, v46
    v_accvgpr_write_b32 a125, v47
    v_lshlrev_b32 v45, 2, v45
    v_add_u32 v45, 159872, v45
    v_accvgpr_write_b32 a53, v45
    v_mov_b32 v28, -1
    v_mov_b32 v29, -1
    v_mov_b32 v30, -1
    v_mov_b32 v31, -1
    s_add_u32 m0, s57, 26656
    s_add_u32 s55, s60, 30720
    buffer_load_dwordx4 v6, s[32:35], s55 offen lds
    s_add_u32 m0, s57, 27680
    s_add_u32 s55, s60, 46080
    buffer_load_dwordx4 v6, s[32:35], s55 offen lds
    s_lshl_b32 s59, s58, 7
    s_add_u32 m0, s56, 8192
    s_add_u32 s55, s59, 0
    buffer_load_dwordx4 v4, s[28:31], s55 offen lds
    s_add_u32 m0, s56, 9216
    s_add_u32 s55, s59, 10240
    buffer_load_dwordx4 v5, s[28:31], s55 offen lds
    s_add_u32 m0, s56, 10240
    s_add_u32 s55, s59, 20480
    buffer_load_dwordx4 v4, s[28:31], s55 offen lds
    s_add_u32 m0, s56, 11264
    s_add_u32 s55, s59, 30720
    buffer_load_dwordx4 v5, s[28:31], s55 offen lds
    s_add_u32 s58, s58, 1
    s_cmp_ge_u32 s58, 10
    s_cselect_b32 s54, 10, 0
    s_sub_u32 s58, s58, s54
    v_lshrrev_b32 v15, 1, v2
    v_and_b32 v15, 7, v15
    v_xor_b32 v15, v15, v3
    s_lshl_b32 s52, s45, 1
    v_xor_b32 v15, s52, v15
    v_lshlrev_b32 v15, 4, v15
    v_lshlrev_b32 v16, 7, v2
    s_lshr_b32 s52, s47, 1
    s_mul_i32 s52, s52, 40960
    s_and_b32 s53, s47, 1
    s_lshl_b32 s53, s53, 12
    s_add_u32 s52, s52, s53
    v_add3_u32 v24, v15, v16, s52
    s_lshl_b32 s52, s45, 5
    s_add_u32 s52, s52, 155776
    v_lshlrev_b32 v25, 4, v3
    v_add_u32 v25, s52, v25
    v_mov_b32 v26, 0
    s_waitcnt vmcnt(8)
    s_barrier
    s_lshl_b32 s52, s61, 7
    v_add_u32 v27, s52, v25
    ds_read_b128 v[32:35], v24 offset:0
    ds_read_b128 v[36:39], v27
    s_add_u32 s61, s61, 1
    s_cmp_ge_u32 s61, 10
    s_cselect_b32 s54, 10, 0
    s_sub_u32 s61, s61, s54
    s_mul_i32 s60, s58, 245760
    s_add_u32 m0, s57, 49216
    s_add_u32 s55, s60, 0
    buffer_load_dwordx4 v6, s[32:35], s55 offen lds
    s_add_u32 m0, s57, 50240
    s_add_u32 s55, s60, 15360
    buffer_load_dwordx4 v6, s[32:35], s55 offen lds
    s_add_u32 m0, s57, 51264
    s_add_u32 s55, s60, 30720
    buffer_load_dwordx4 v6, s[32:35], s55 offen lds
    s_add_u32 m0, s57, 52288
    s_add_u32 s55, s60, 46080
    buffer_load_dwordx4 v6, s[32:35], s55 offen lds
    s_lshl_b32 s59, s58, 7
    s_add_u32 m0, s56, 16384
    s_add_u32 s55, s59, 0
    buffer_load_dwordx4 v4, s[28:31], s55 offen lds
    s_add_u32 m0, s56, 17408
    s_add_u32 s55, s59, 10240
    buffer_load_dwordx4 v5, s[28:31], s55 offen lds
    s_add_u32 m0, s56, 18432
    s_add_u32 s55, s59, 20480
    buffer_load_dwordx4 v4, s[28:31], s55 offen lds
    s_add_u32 m0, s56, 19456
    s_add_u32 s55, s59, 30720
    buffer_load_dwordx4 v5, s[28:31], s55 offen lds
    s_add_u32 s58, s58, 1
    s_cmp_ge_u32 s58, 10
    s_cselect_b32 s54, 10, 0
    s_sub_u32 s58, s58, s54
    s_waitcnt lgkmcnt(0)
    v_dot2c_f32_bf16 v26, v32, v36
    v_dot2c_f32_bf16 v26, v33, v37
    v_dot2c_f32_bf16 v26, v34, v38
    v_dot2c_f32_bf16 v26, v35, v39
    s_waitcnt vmcnt(8)
    s_barrier
    s_lshl_b32 s52, s61, 7
    v_add_u32 v27, s52, v25
    ds_read_b128 v[32:35], v24 offset:8192
    ds_read_b128 v[36:39], v27
    s_add_u32 s61, s61, 1
    s_cmp_ge_u32 s61, 10
    s_cselect_b32 s54, 10, 0
    s_sub_u32 s61, s61, s54
    s_mul_i32 s60, s58, 245760
    s_add_u32 m0, s57, 0
    s_add_u32 s55, s60, 0
    buffer_load_dwordx4 v6, s[32:35], s55 offen lds
    s_add_u32 m0, s57, 1024
    s_add_u32 s55, s60, 15360
    buffer_load_dwordx4 v6, s[32:35], s55 offen lds
    s_add_u32 m0, s57, 2048
    s_add_u32 s55, s60, 30720
    buffer_load_dwordx4 v6, s[32:35], s55 offen lds
    s_add_u32 m0, s57, 3072
    s_add_u32 s55, s60, 46080
    buffer_load_dwordx4 v6, s[32:35], s55 offen lds
    s_lshl_b32 s59, s58, 7
    s_add_u32 m0, s56, 24576
    s_add_u32 s55, s59, 0
    buffer_load_dwordx4 v4, s[28:31], s55 offen lds
    s_add_u32 m0, s56, 25600
    s_add_u32 s55, s59, 10240
    buffer_load_dwordx4 v5, s[28:31], s55 offen lds
    s_add_u32 m0, s56, 26624
    s_add_u32 s55, s59, 20480
    buffer_load_dwordx4 v4, s[28:31], s55 offen lds
    s_add_u32 m0, s56, 27648
    s_add_u32 s55, s59, 30720
    buffer_load_dwordx4 v5, s[28:31], s55 offen lds
    s_add_u32 s58, s58, 1
    s_cmp_ge_u32 s58, 10
    s_cselect_b32 s54, 10, 0
    s_sub_u32 s58, s58, s54
    s_cmp_ge_u32 s45, 2
    s_cselect_b32 s40, s14, s12
    s_cselect_b32 s41, s15, s13
    s_mov_b32 s42, 1966080
    s_mov_b32 s43, 0x20000
    s_lshr_b32 s52, s2, 3
    s_lshl_b32 s52, s52, 1
    s_add_u32 s52, s52, s27
    s_mul_i32 s52, s52, 30720
    s_mul_i32 s53, s47, 768
    s_add_u32 s52, s52, s53
    v_mul_u32_u24 v48, 10923, v1
    v_lshrrev_b32 v48, 16, v48
    v_mul_u32_u24 v48, 2304, v48
    v_lshl_add_u32 v48, v1, 7, v48
    s_mov_b32 exec_hi, 0xfffffff
    buffer_load_dword v49, v48, s[40:43], s52 offen
    s_mov_b32 exec_hi, -1
    s_mov_b32 s40, s22
    s_mov_b32 s41, s23
    s_mov_b32 s42, 256
    s_mov_b32 s43, 0x20000
    v_mov_b32 v42, 0
    s_mov_b64 exec, 1
    buffer_load_dwordx2 v[40:41], v42, s[40:43], 0 offen sc1
    s_mov_b64 exec, -1
    s_waitcnt lgkmcnt(0)
    v_dot2c_f32_bf16 v26, v32, v36
    v_dot2c_f32_bf16 v26, v33, v37
    v_dot2c_f32_bf16 v26, v34, v38
    v_dot2c_f32_bf16 v26, v35, v39
    s_waitcnt vmcnt(10)
    s_barrier
    s_lshl_b32 s52, s61, 7
    v_add_u32 v27, s52, v25
    ds_read_b128 v[32:35], v24 offset:16384
    ds_read_b128 v[36:39], v27
    s_add_u32 s61, s61, 1
    s_cmp_ge_u32 s61, 10
    s_cselect_b32 s54, 10, 0
    s_sub_u32 s61, s61, s54
    s_mul_i32 s60, s58, 245760
    s_add_u32 m0, s57, 24608
    s_add_u32 s55, s60, 0
    buffer_load_dwordx4 v6, s[32:35], s55 offen lds
    s_add_u32 m0, s57, 25632
    s_add_u32 s55, s60, 15360
    buffer_load_dwordx4 v6, s[32:35], s55 offen lds
    s_add_u32 m0, s57, 26656
    s_add_u32 s55, s60, 30720
    buffer_load_dwordx4 v6, s[32:35], s55 offen lds
    s_add_u32 m0, s57, 27680
    s_add_u32 s55, s60, 46080
    buffer_load_dwordx4 v6, s[32:35], s55 offen lds
    s_lshl_b32 s59, s58, 7
    s_add_u32 m0, s56, 32768
    s_add_u32 s55, s59, 0
    buffer_load_dwordx4 v4, s[28:31], s55 offen lds
    s_add_u32 m0, s56, 33792
    s_add_u32 s55, s59, 10240
    buffer_load_dwordx4 v5, s[28:31], s55 offen lds
    s_add_u32 m0, s56, 34816
    s_add_u32 s55, s59, 20480
    buffer_load_dwordx4 v4, s[28:31], s55 offen lds
    s_add_u32 m0, s56, 35840
    s_add_u32 s55, s59, 30720
    buffer_load_dwordx4 v5, s[28:31], s55 offen lds
    s_add_u32 s58, s58, 1
    s_cmp_ge_u32 s58, 10
    s_cselect_b32 s54, 10, 0
    s_sub_u32 s58, s58, s54
    s_waitcnt lgkmcnt(0)
    v_dot2c_f32_bf16 v26, v32, v36
    v_dot2c_f32_bf16 v26, v33, v37
    v_dot2c_f32_bf16 v26, v34, v38
    v_dot2c_f32_bf16 v26, v35, v39
    s_waitcnt vmcnt(10)
    s_barrier
    s_lshl_b32 s52, s61, 7
    v_add_u32 v27, s52, v25
    ds_read_b128 v[32:35], v24 offset:24576
    ds_read_b128 v[36:39], v27
    s_add_u32 s61, s61, 1
    s_cmp_ge_u32 s61, 10
    s_cselect_b32 s54, 10, 0
    s_sub_u32 s61, s61, s54
    s_mul_i32 s60, s58, 245760
    s_add_u32 m0, s57, 49216
    s_add_u32 s55, s60, 0
    buffer_load_dwordx4 v6, s[32:35], s55 offen lds
    s_add_u32 m0, s57, 50240
    s_add_u32 s55, s60, 15360
    buffer_load_dwordx4 v6, s[32:35], s55 offen lds
    s_add_u32 m0, s57, 51264
    s_add_u32 s55, s60, 30720
    buffer_load_dwordx4 v6, s[32:35], s55 offen lds
    s_add_u32 m0, s57, 52288
    s_add_u32 s55, s60, 46080
    buffer_load_dwordx4 v6, s[32:35], s55 offen lds
    s_lshl_b32 s59, s58, 7
    s_add_u32 m0, s56, 0
    s_add_u32 s55, s59, 0
    buffer_load_dwordx4 v4, s[28:31], s55 offen lds
    s_add_u32 m0, s56, 1024
    s_add_u32 s55, s59, 10240
    buffer_load_dwordx4 v5, s[28:31], s55 offen lds
    s_add_u32 m0, s56, 2048
    s_add_u32 s55, s59, 20480
    buffer_load_dwordx4 v4, s[28:31], s55 offen lds
    s_add_u32 m0, s56, 3072
    s_add_u32 s55, s59, 30720
    buffer_load_dwordx4 v5, s[28:31], s55 offen lds
    s_add_u32 s58, s58, 1
    s_cmp_ge_u32 s58, 10
    s_cselect_b32 s54, 10, 0
    s_sub_u32 s58, s58, s54
    s_waitcnt lgkmcnt(0)
    v_dot2c_f32_bf16 v26, v32, v36
    v_dot2c_f32_bf16 v26, v33, v37
    v_dot2c_f32_bf16 v26, v34, v38
    v_dot2c_f32_bf16 v26, v35, v39
    s_waitcnt vmcnt(8)
    s_barrier
    s_lshl_b32 s52, s61, 7
    v_add_u32 v27, s52, v25
    ds_read_b128 v[32:35], v24 offset:32768
    ds_read_b128 v[36:39], v27
    s_add_u32 s61, s61, 1
    s_cmp_ge_u32 s61, 10
    s_cselect_b32 s54, 10, 0
    s_sub_u32 s61, s61, s54
    s_mul_i32 s60, s58, 245760
    s_add_u32 m0, s57, 0
    s_add_u32 s55, s60, 0
    buffer_load_dwordx4 v6, s[32:35], s55 offen lds
    s_add_u32 m0, s57, 1024
    s_add_u32 s55, s60, 15360
    buffer_load_dwordx4 v6, s[32:35], s55 offen lds
    s_add_u32 m0, s57, 2048
    s_add_u32 s55, s60, 30720
    buffer_load_dwordx4 v6, s[32:35], s55 offen lds
    s_add_u32 m0, s57, 3072
    s_add_u32 s55, s60, 46080
    buffer_load_dwordx4 v6, s[32:35], s55 offen lds
    s_lshl_b32 s59, s58, 7
    s_add_u32 m0, s56, 8192
    s_add_u32 s55, s59, 0
    buffer_load_dwordx4 v4, s[28:31], s55 offen lds
    s_add_u32 m0, s56, 9216
    s_add_u32 s55, s59, 10240
    buffer_load_dwordx4 v5, s[28:31], s55 offen lds
    s_add_u32 m0, s56, 10240
    s_add_u32 s55, s59, 20480
    buffer_load_dwordx4 v4, s[28:31], s55 offen lds
    s_add_u32 m0, s56, 11264
    s_add_u32 s55, s59, 30720
    buffer_load_dwordx4 v5, s[28:31], s55 offen lds
    s_add_u32 s58, s58, 1
    s_cmp_ge_u32 s58, 10
    s_cselect_b32 s54, 10, 0
    s_sub_u32 s58, s58, s54
    s_waitcnt lgkmcnt(0)
    v_dot2c_f32_bf16 v26, v32, v36
    v_dot2c_f32_bf16 v26, v33, v37
    v_dot2c_f32_bf16 v26, v34, v38
    v_dot2c_f32_bf16 v26, v35, v39
    s_waitcnt vmcnt(8)
    s_barrier
    s_lshl_b32 s52, s61, 7
    v_add_u32 v27, s52, v25
    ds_read_b128 v[32:35], v24 offset:0
    ds_read_b128 v[36:39], v27
    s_add_u32 s61, s61, 1
    s_cmp_ge_u32 s61, 10
    s_cselect_b32 s54, 10, 0
    s_sub_u32 s61, s61, s54
    s_mul_i32 s60, s58, 245760
    s_add_u32 m0, s57, 24608
    s_add_u32 s55, s60, 0
    buffer_load_dwordx4 v6, s[32:35], s55 offen lds
    s_add_u32 m0, s57, 25632
    s_add_u32 s55, s60, 15360
    buffer_load_dwordx4 v6, s[32:35], s55 offen lds
    s_add_u32 m0, s57, 26656
    s_add_u32 s55, s60, 30720
    buffer_load_dwordx4 v6, s[32:35], s55 offen lds
    s_add_u32 m0, s57, 27680
    s_add_u32 s55, s60, 46080
    buffer_load_dwordx4 v6, s[32:35], s55 offen lds
    s_lshl_b32 s59, s58, 7
    s_add_u32 m0, s56, 16384
    s_add_u32 s55, s59, 0
    buffer_load_dwordx4 v4, s[28:31], s55 offen lds
    s_add_u32 m0, s56, 17408
    s_add_u32 s55, s59, 10240
    buffer_load_dwordx4 v5, s[28:31], s55 offen lds
    s_add_u32 m0, s56, 18432
    s_add_u32 s55, s59, 20480
    buffer_load_dwordx4 v4, s[28:31], s55 offen lds
    s_add_u32 m0, s56, 19456
    s_add_u32 s55, s59, 30720
    buffer_load_dwordx4 v5, s[28:31], s55 offen lds
    s_add_u32 s58, s58, 1
    s_cmp_ge_u32 s58, 10
    s_cselect_b32 s54, 10, 0
    s_sub_u32 s58, s58, s54
    s_waitcnt lgkmcnt(0)
    v_dot2c_f32_bf16 v26, v32, v36
    v_dot2c_f32_bf16 v26, v33, v37
    v_dot2c_f32_bf16 v26, v34, v38
    v_dot2c_f32_bf16 v26, v35, v39
    s_waitcnt vmcnt(8)
    s_barrier
    s_lshl_b32 s52, s61, 7
    v_add_u32 v27, s52, v25
    ds_read_b128 v[32:35], v24 offset:8192
    ds_read_b128 v[36:39], v27
    s_add_u32 s61, s61, 1
    s_cmp_ge_u32 s61, 10
    s_cselect_b32 s54, 10, 0
    s_sub_u32 s61, s61, s54
    s_mul_i32 s60, s58, 245760
    s_add_u32 m0, s57, 49216
    s_add_u32 s55, s60, 0
    buffer_load_dwordx4 v6, s[32:35], s55 offen lds
    s_add_u32 m0, s57, 50240
    s_add_u32 s55, s60, 15360
    buffer_load_dwordx4 v6, s[32:35], s55 offen lds
    s_add_u32 m0, s57, 51264
    s_add_u32 s55, s60, 30720
    buffer_load_dwordx4 v6, s[32:35], s55 offen lds
    s_add_u32 m0, s57, 52288
    s_add_u32 s55, s60, 46080
    buffer_load_dwordx4 v6, s[32:35], s55 offen lds
    s_lshl_b32 s59, s58, 7
    s_add_u32 m0, s56, 24576
    s_add_u32 s55, s59, 0
    buffer_load_dwordx4 v4, s[28:31], s55 offen lds
    s_add_u32 m0, s56, 25600
    s_add_u32 s55, s59, 10240
    buffer_load_dwordx4 v5, s[28:31], s55 offen lds
    s_add_u32 m0, s56, 26624
    s_add_u32 s55, s59, 20480
    buffer_load_dwordx4 v4, s[28:31], s55 offen lds
    s_add_u32 m0, s56, 27648
    s_add_u32 s55, s59, 30720
    buffer_load_dwordx4 v5, s[28:31], s55 offen lds
    s_add_u32 s58, s58, 1
    s_cmp_ge_u32 s58, 10
    s_cselect_b32 s54, 10, 0
    s_sub_u32 s58, s58, s54
    s_waitcnt lgkmcnt(0)
    v_dot2c_f32_bf16 v26, v32, v36
    v_dot2c_f32_bf16 v26, v33, v37
    v_dot2c_f32_bf16 v26, v34, v38
    v_dot2c_f32_bf16 v26, v35, v39
    v_readfirstlane_b32 s50, v40
    v_mov_b32 v15, 159768
    s_cmp_eq_u32 s50, 0
    s_cbranch_scc1 L_G_tokretry
L_G_tokok:
    v_readfirstlane_b32 s51, v41
    s_mov_b64 exec, 1
    ds_write_b64 v15, v[40:41]
    s_mov_b64 exec, -1
    s_waitcnt vmcnt(8)
    s_barrier
    s_lshl_b32 s52, s61, 7
    v_add_u32 v27, s52, v25
    ds_read_b128 v[32:35], v24 offset:16384
    ds_read_b128 v[36:39], v27
    s_add_u32 s61, s61, 1
    s_cmp_ge_u32 s61, 10
    s_cselect_b32 s54, 10, 0
    s_sub_u32 s61, s61, s54
    s_mul_i32 s60, s58, 245760
    s_add_u32 m0, s57, 0
    s_add_u32 s55, s60, 0
    buffer_load_dwordx4 v6, s[32:35], s55 offen lds
    s_add_u32 m0, s57, 1024
    s_add_u32 s55, s60, 15360
    buffer_load_dwordx4 v6, s[32:35], s55 offen lds
    s_add_u32 m0, s57, 2048
    s_add_u32 s55, s60, 30720
    buffer_load_dwordx4 v6, s[32:35], s55 offen lds
    s_add_u32 m0, s57, 3072
    s_add_u32 s55, s60, 46080
    buffer_load_dwordx4 v6, s[32:35], s55 offen lds
    s_lshl_b32 s59, s58, 7
    s_add_u32 m0, s56, 32768
    s_add_u32 s55, s59, 0
    buffer_load_dwordx4 v4, s[28:31], s55 offen lds
    s_add_u32 m0, s56, 33792
    s_add_u32 s55, s59, 10240
    buffer_load_dwordx4 v5, s[28:31], s55 offen lds
    s_add_u32 m0, s56, 34816
    s_add_u32 s55, s59, 20480
    buffer_load_dwordx4 v4, s[28:31], s55 offen lds
    s_add_u32 m0, s56, 35840
    s_add_u32 s55, s59, 30720
    buffer_load_dwordx4 v5, s[28:31], s55 offen lds
    s_waitcnt lgkmcnt(0)
    v_dot2c_f32_bf16 v26, v32, v36
    v_dot2c_f32_bf16 v26, v33, v37
    v_dot2c_f32_bf16 v26, v34, v38
    v_dot2c_f32_bf16 v26, v35, v39
    s_waitcnt vmcnt(8)
    s_barrier
    s_lshl_b32 s52, s61, 7
    v_add_u32 v27, s52, v25
    ds_read_b128 v[32:35], v24 offset:24576
    ds_read_b128 v[36:39], v27
    s_add_u32 s61, s61, 1
    s_cmp_ge_u32 s61, 10
    s_cselect_b32 s54, 10, 0
    s_sub_u32 s61, s61, s54
    s_cmp_ge_u32 s45, 2
    s_cselect_b32 s32, s14, s12
    s_cselect_b32 s33, s15, s13
    s_mov_b32 s34, 1966080
    s_mov_b32 s35, 0x20000
    s_mul_i32 s52, s27, 98304
    s_mul_i32 s54, s62, 192
    s_add_u32 s52, s52, s54
    s_mov_b32 s53, 2880
    v_add_u32 v6, 0, v1
    v_mul_u32_u24 v23, 5462, v6
    v_lshrrev_b32 v23, 16, v23
    v_lshlrev_b32 v6, 4, v6
    v_mad_u32_u24 v6, v23, s53, v6
    v_add_u32 v6, s52, v6
    v_add_u32 v7, 64, v1
    v_mul_u32_u24 v23, 5462, v7
    v_lshrrev_b32 v23, 16, v23
    v_lshlrev_b32 v7, 4, v7
    v_mad_u32_u24 v7, v23, s53, v7
    v_add_u32 v7, s52, v7
    v_add_u32 v8, 128, v1
    v_mul_u32_u24 v23, 5462, v8
    v_lshrrev_b32 v23, 16, v23
    v_lshlrev_b32 v8, 4, v8
    v_mad_u32_u24 v8, v23, s53, v8
    v_add_u32 v8, s52, v8
    s_mul_i32 s57, s45, 6144
    s_lshl_b32 s54, s26, 5
    s_add_u32 s57, s57, s54
    s_add_u32 s57, s57, 81920
    s_mul_i32 s60, s58, 196608
    s_add_u32 m0, s57, 24608
    s_add_u32 s55, s60, 0
    buffer_load_dwordx4 v6, s[32:35], s55 offen lds
    s_add_u32 m0, s57, 25632
    s_add_u32 s55, s60, 0
    buffer_load_dwordx4 v7, s[32:35], s55 offen lds
    s_add_u32 m0, s57, 26656
    s_add_u32 s55, s60, 0
    buffer_load_dwordx4 v8, s[32:35], s55 offen lds
    s_add_u32 m0, s57, 27680
    s_add_u32 s55, s60, 49152
    buffer_load_dwordx4 v6, s[32:35], s55 offen lds
    s_add_u32 m0, s57, 28704
    s_add_u32 s55, s60, 49152
    buffer_load_dwordx4 v7, s[32:35], s55 offen lds
    s_add_u32 m0, s57, 29728
    s_add_u32 s55, s60, 49152
    buffer_load_dwordx4 v8, s[32:35], s55 offen lds
    s_add_u32 s58, s58, 9
    s_cmp_ge_u32 s58, 10
    s_cselect_b32 s54, 10, 0
    s_sub_u32 s58, s58, s54
    s_waitcnt lgkmcnt(0)
    v_dot2c_f32_bf16 v26, v32, v36
    v_dot2c_f32_bf16 v26, v33, v37
    v_dot2c_f32_bf16 v26, v34, v38
    v_dot2c_f32_bf16 v26, v35, v39
    s_waitcnt vmcnt(6)
    s_barrier
    s_lshl_b32 s52, s61, 7
    v_add_u32 v27, s52, v25
    ds_read_b128 v[32:35], v24 offset:32768
    ds_read_b128 v[36:39], v27
    s_add_u32 s61, s61, 1
    s_cmp_ge_u32 s61, 10
    s_cselect_b32 s54, 10, 0
    s_sub_u32 s61, s61, s54
    s_mul_i32 s60, s58, 196608
    s_add_u32 m0, s57, 49216
    s_add_u32 s55, s60, 0
    buffer_load_dwordx4 v6, s[32:35], s55 offen lds
    s_add_u32 m0, s57, 50240
    s_add_u32 s55, s60, 0
    buffer_load_dwordx4 v7, s[32:35], s55 offen lds
    s_add_u32 m0, s57, 51264
    s_add_u32 s55, s60, 0
    buffer_load_dwordx4 v8, s[32:35], s55 offen lds
    s_add_u32 m0, s57, 52288
    s_add_u32 s55, s60, 49152
    buffer_load_dwordx4 v6, s[32:35], s55 offen lds
    s_add_u32 m0, s57, 53312
    s_add_u32 s55, s60, 49152
    buffer_load_dwordx4 v7, s[32:35], s55 offen lds
    s_add_u32 m0, s57, 54336
    s_add_u32 s55, s60, 49152
    buffer_load_dwordx4 v8, s[32:35], s55 offen lds
    s_add_u32 s58, s58, 9
    s_cmp_ge_u32 s58, 10
    s_cselect_b32 s54, 10, 0
    s_sub_u32 s58, s58, s54
    s_waitcnt lgkmcnt(0)
    v_dot2c_f32_bf16 v26, v32, v36
    v_dot2c_f32_bf16 v26, v33, v37
    v_dot2c_f32_bf16 v26, v34, v38
    v_dot2c_f32_bf16 v26, v35, v39
    v_lshlrev_b32 v27, 5, v2
    v_lshl_add_u32 v27, v3, 2, v27
    s_lshl_b32 s52, s45, 3
    s_add_u32 s52, s52, 160000
    v_add_u32 v27, s52, v27
    ds_write_b32 v27, v26
    s_lshl_b32 s52, s45, 2
    s_add_u32 s52, s52, 159776
    v_mov_b32 v15, s52
    v_and_b32 v16, 7, v1
    v_lshlrev_b32 v16, 2, v16
    v_add_u32 v16, 159776, v16
    s_waitcnt lgkmcnt(0)
    s_waitcnt vmcnt(6)
    v_mov_b32 v17, 1
    ds_write_b32 v15, v17
L_G_e1:
    ds_read_b32 v18, v16
    s_waitcnt lgkmcnt(0)
    v_cmp_gt_u32 vcc, 1, v18
    s_cmp_eq_u64 vcc, 0
    s_cbranch_scc0 L_G_e1
    s_setprio 2
    ds_read_b128 a[0:3], v9 offset:32768
    ds_read_b64_tr_b16 a[8:9], v13 offset:24608
    ds_read_b64_tr_b16 a[10:11], v13 offset:25376
    ds_read_b128 a[4:7], v9 offset:36864
    ds_read_b64_tr_b16 a[12:13], v13 offset:24640
    ds_read_b64_tr_b16 a[14:15], v13 offset:25408
    ds_read_b64_tr_b16 a[16:17], v13 offset:24672
    ds_read_b64_tr_b16 a[18:19], v13 offset:25440
    s_waitcnt lgkmcnt(4)
    v_mfma_f32_32x32x16_bf16 v[32:47], a[8:11], a[0:3], 0
    ds_read_b128 a[20:23], v10 offset:32768
    ds_read_b64_tr_b16 a[28:29], v13 offset:27680
    v_mfma_f32_32x32x16_bf16 v[48:63], a[8:11], a[4:7], 0
    ds_read_b64_tr_b16 a[30:31], v13 offset:28448
    ds_read_b128 a[24:27], v10 offset:36864
    s_waitcnt lgkmcnt(6)
    v_mfma_f32_32x32x16_bf16 v[64:79], a[12:15], a[0:3], 0
    ds_read_b64_tr_b16 a[32:33], v13 offset:27712
    ds_read_b64_tr_b16 a[34:35], v13 offset:28480
    v_mfma_f32_32x32x16_bf16 v[80:95], a[12:15], a[4:7], 0
    ds_read_b64_tr_b16 a[36:37], v13 offset:27744
    ds_read_b64_tr_b16 a[38:39], v13 offset:28512
    s_waitcnt lgkmcnt(8)
    v_mfma_f32_32x32x16_bf16 v[96:111], a[16:19], a[0:3], 0
    s_mul_i32 s60, s58, 196608
    s_add_u32 m0, s57, 0
    s_add_u32 s55, s60, 0
    buffer_load_dwordx4 v6, s[32:35], s55 offen lds
    v_mfma_f32_32x32x16_bf16 v[112:127], a[16:19], a[4:7], 0
    s_add_u32 m0, s57, 1024
    s_add_u32 s55, s60, 0
    buffer_load_dwordx4 v7, s[32:35], s55 offen lds
    s_waitcnt lgkmcnt(4)
    v_mfma_f32_32x32x16_bf16 v[32:47], a[28:31], a[20:23], v[32:47]
    ds_read_b128 a[0:3], v11 offset:32768
    ds_read_b64_tr_b16 a[8:9], v13 offset:30752
    v_mfma_f32_32x32x16_bf16 v[48:63], a[28:31], a[24:27], v[48:63]
    ds_read_b64_tr_b16 a[10:11], v13 offset:31520
    ds_read_b128 a[4:7], v11 offset:36864
    s_waitcnt lgkmcnt(6)
    v_mfma_f32_32x32x16_bf16 v[64:79], a[32:35], a[20:23], v[64:79]
    ds_read_b64_tr_b16 a[12:13], v13 offset:30784
    ds_read_b64_tr_b16 a[14:15], v13 offset:31552
    v_mfma_f32_32x32x16_bf16 v[80:95], a[32:35], a[24:27], v[80:95]
    ds_read_b64_tr_b16 a[16:17], v13 offset:30816
    ds_read_b64_tr_b16 a[18:19], v13 offset:31584
    s_waitcnt lgkmcnt(8)
    v_mfma_f32_32x32x16_bf16 v[96:111], a[36:39], a[20:23], v[96:111]
    s_add_u32 m0, s57, 2048
    s_add_u32 s55, s60, 0
    buffer_load_dwordx4 v8, s[32:35], s55 offen lds
    v_mfma_f32_32x32x16_bf16 v[112:127], a[36:39], a[24:27], v[112:127]
    s_add_u32 m0, s57, 3072
    s_add_u32 s55, s60, 49152
    buffer_load_dwordx4 v6, s[32:35], s55 offen lds
    s_waitcnt lgkmcnt(4)
    v_mfma_f32_32x32x16_bf16 v[32:47], a[8:11], a[0:3], v[32:47]
    ds_read_b128 a[20:23], v12 offset:32768
    ds_read_b64_tr_b16 a[28:29], v13 offset:33824
    v_mfma_f32_32x32x16_bf16 v[48:63], a[8:11], a[4:7], v[48:63]
    ds_read_b64_tr_b16 a[30:31], v13 offset:34592
    ds_read_b128 a[24:27], v12 offset:36864
    s_waitcnt lgkmcnt(6)
    v_mfma_f32_32x32x16_bf16 v[64:79], a[12:15], a[0:3], v[64:79]
    ds_read_b64_tr_b16 a[32:33], v13 offset:33856
    ds_read_b64_tr_b16 a[34:35], v13 offset:34624
    v_mfma_f32_32x32x16_bf16 v[80:95], a[12:15], a[4:7], v[80:95]
    ds_read_b64_tr_b16 a[36:37], v13 offset:33888
    ds_read_b64_tr_b16 a[38:39], v13 offset:34656
    s_waitcnt lgkmcnt(8)
    v_mfma_f32_32x32x16_bf16 v[96:111], a[16:19], a[0:3], v[96:111]
    s_add_u32 m0, s57, 4096
    s_add_u32 s55, s60, 49152
    buffer_load_dwordx4 v7, s[32:35], s55 offen lds
    v_mfma_f32_32x32x16_bf16 v[112:127], a[16:19], a[4:7], v[112:127]
    s_add_u32 m0, s57, 5120
    s_add_u32 s55, s60, 49152
    buffer_load_dwordx4 v8, s[32:35], s55 offen lds
    s_add_u32 s58, s58, 9
    s_cmp_ge_u32 s58, 10
    s_cselect_b32 s54, 10, 0
    s_sub_u32 s58, s58, s54
    s_waitcnt lgkmcnt(4)
    v_mfma_f32_32x32x16_bf16 v[32:47], a[28:31], a[20:23], v[32:47]
    s_waitcnt vmcnt(6) lgkmcnt(0)
    s_barrier
    ds_read_b128 a[0:3], v9 offset:24576
    ds_read_b64_tr_b16 a[8:9], v13 offset:49216
    v_mfma_f32_32x32x16_bf16 v[48:63], a[28:31], a[24:27], v[48:63]
    ds_read_b64_tr_b16 a[10:11], v13 offset:49984
    ds_read_b128 a[4:7], v9 offset:28672
    v_mfma_f32_32x32x16_bf16 v[64:79], a[32:35], a[20:23], v[64:79]
    ds_read_b64_tr_b16 a[12:13], v13 offset:49248
    ds_read_b64_tr_b16 a[14:15], v13 offset:50016
    v_mfma_f32_32x32x16_bf16 v[80:95], a[32:35], a[24:27], v[80:95]
    ds_read_b64_tr_b16 a[16:17], v13 offset:49280
    ds_read_b64_tr_b16 a[18:19], v13 offset:50048
    v_mfma_f32_32x32x16_bf16 v[96:111], a[36:39], a[20:23], v[96:111]
    v_mfma_f32_32x32x16_bf16 v[112:127], a[36:39], a[24:27], v[112:127]
    s_waitcnt lgkmcnt(4)
    v_mfma_f32_32x32x16_bf16 v[32:47], a[8:11], a[0:3], v[32:47]
    ds_read_b128 a[20:23], v10 offset:24576
    ds_read_b64_tr_b16 a[28:29], v13 offset:52288
    v_mfma_f32_32x32x16_bf16 v[48:63], a[8:11], a[4:7], v[48:63]
    ds_read_b64_tr_b16 a[30:31], v13 offset:53056
    ds_read_b128 a[24:27], v10 offset:28672
    s_waitcnt lgkmcnt(6)
    v_mfma_f32_32x32x16_bf16 v[64:79], a[12:15], a[0:3], v[64:79]
    ds_read_b64_tr_b16 a[32:33], v13 offset:52320
    ds_read_b64_tr_b16 a[34:35], v13 offset:53088
    v_mfma_f32_32x32x16_bf16 v[80:95], a[12:15], a[4:7], v[80:95]
    ds_read_b64_tr_b16 a[36:37], v13 offset:52352
    ds_read_b64_tr_b16 a[38:39], v13 offset:53120
    s_waitcnt lgkmcnt(8)
    v_mfma_f32_32x32x16_bf16 v[96:111], a[16:19], a[0:3], v[96:111]
    s_mul_i32 s60, s58, 196608
    s_add_u32 m0, s57, 24608
    s_add_u32 s55, s60, 0
    buffer_load_dwordx4 v6, s[32:35], s55 offen lds
    v_mfma_f32_32x32x16_bf16 v[112:127], a[16:19], a[4:7], v[112:127]
    s_add_u32 m0, s57, 25632
    s_add_u32 s55, s60, 0
    buffer_load_dwordx4 v7, s[32:35], s55 offen lds
    s_waitcnt lgkmcnt(4)
    v_mfma_f32_32x32x16_bf16 v[32:47], a[28:31], a[20:23], v[32:47]
    ds_read_b128 a[0:3], v11 offset:24576
    ds_read_b64_tr_b16 a[8:9], v13 offset:55360
    v_mfma_f32_32x32x16_bf16 v[48:63], a[28:31], a[24:27], v[48:63]
    ds_read_b64_tr_b16 a[10:11], v13 offset:56128
    ds_read_b128 a[4:7], v11 offset:28672
    s_waitcnt lgkmcnt(6)
    v_mfma_f32_32x32x16_bf16 v[64:79], a[32:35], a[20:23], v[64:79]
    ds_read_b64_tr_b16 a[12:13], v13 offset:55392
    ds_read_b64_tr_b16 a[14:15], v13 offset:56160
    v_mfma_f32_32x32x16_bf16 v[80:95], a[32:35], a[24:27], v[80:95]
    ds_read_b64_tr_b16 a[16:17], v13 offset:55424
    ds_read_b64_tr_b16 a[18:19], v13 offset:56192
    s_waitcnt lgkmcnt(8)
    v_mfma_f32_32x32x16_bf16 v[96:111], a[36:39], a[20:23], v[96:111]
    s_add_u32 m0, s57, 26656
    s_add_u32 s55, s60, 0
    buffer_load_dwordx4 v8, s[32:35], s55 offen lds
    v_mfma_f32_32x32x16_bf16 v[112:127], a[36:39], a[24:27], v[112:127]
    s_add_u32 m0, s57, 27680
    s_add_u32 s55, s60, 49152
    buffer_load_dwordx4 v6, s[32:35], s55 offen lds
    s_waitcnt lgkmcnt(4)
    v_mfma_f32_32x32x16_bf16 v[32:47], a[8:11], a[0:3], v[32:47]
    ds_read_b128 a[20:23], v12 offset:24576
    ds_read_b64_tr_b16 a[28:29], v13 offset:58432
    v_mfma_f32_32x32x16_bf16 v[48:63], a[8:11], a[4:7], v[48:63]
    ds_read_b64_tr_b16 a[30:31], v13 offset:59200
    ds_read_b128 a[24:27], v12 offset:28672
    s_waitcnt lgkmcnt(6)
    v_mfma_f32_32x32x16_bf16 v[64:79], a[12:15], a[0:3], v[64:79]
    ds_read_b64_tr_b16 a[32:33], v13 offset:58464
    ds_read_b64_tr_b16 a[34:35], v13 offset:59232
    v_mfma_f32_32x32x16_bf16 v[80:95], a[12:15], a[4:7], v[80:95]
    ds_read_b64_tr_b16 a[36:37], v13 offset:58496
    ds_read_b64_tr_b16 a[38:39], v13 offset:59264
    s_waitcnt lgkmcnt(8)
    v_mfma_f32_32x32x16_bf16 v[96:111], a[16:19], a[0:3], v[96:111]
    s_add_u32 m0, s57, 28704
    s_add_u32 s55, s60, 49152
    buffer_load_dwordx4 v7, s[32:35], s55 offen lds
    v_mfma_f32_32x32x16_bf16 v[112:127], a[16:19], a[4:7], v[112:127]
    s_add_u32 m0, s57, 29728
    s_add_u32 s55, s60, 49152
    buffer_load_dwordx4 v8, s[32:35], s55 offen lds
    s_add_u32 s58, s58, 9
    s_cmp_ge_u32 s58, 10
    s_cselect_b32 s54, 10, 0
    s_sub_u32 s58, s58, s54
    s_waitcnt lgkmcnt(4)
    v_mfma_f32_32x32x16_bf16 v[32:47], a[28:31], a[20:23], v[32:47]
    s_waitcnt vmcnt(6) lgkmcnt(0)
    s_barrier
    ds_read_b128 a[0:3], v9 offset:16384
    ds_read_b64_tr_b16 a[8:9], v13 offset:0
    v_mfma_f32_32x32x16_bf16 v[48:63], a[28:31], a[24:27], v[48:63]
    ds_read_b64_tr_b16 a[10:11], v13 offset:768
    ds_read_b128 a[4:7], v9 offset:20480
    v_mfma_f32_32x32x16_bf16 v[64:79], a[32:35], a[20:23], v[64:79]
    ds_read_b64_tr_b16 a[12:13], v13 offset:32
    ds_read_b64_tr_b16 a[14:15], v13 offset:800
    v_mfma_f32_32x32x16_bf16 v[80:95], a[32:35], a[24:27], v[80:95]
    ds_read_b64_tr_b16 a[16:17], v13 offset:64
    ds_read_b64_tr_b16 a[18:19], v13 offset:832
    v_mfma_f32_32x32x16_bf16 v[96:111], a[36:39], a[20:23], v[96:111]
    v_mfma_f32_32x32x16_bf16 v[112:127], a[36:39], a[24:27], v[112:127]
    s_waitcnt lgkmcnt(4)
    v_mfma_f32_32x32x16_bf16 v[32:47], a[8:11], a[0:3], v[32:47]
    ds_read_b128 a[20:23], v10 offset:16384
    ds_read_b64_tr_b16 a[28:29], v13 offset:3072
    v_mfma_f32_32x32x16_bf16 v[48:63], a[8:11], a[4:7], v[48:63]
    ds_read_b64_tr_b16 a[30:31], v13 offset:3840
    ds_read_b128 a[24:27], v10 offset:20480
    s_waitcnt lgkmcnt(6)
    v_mfma_f32_32x32x16_bf16 v[64:79], a[12:15], a[0:3], v[64:79]
    ds_read_b64_tr_b16 a[32:33], v13 offset:3104
    ds_read_b64_tr_b16 a[34:35], v13 offset:3872
    v_mfma_f32_32x32x16_bf16 v[80:95], a[12:15], a[4:7], v[80:95]
    ds_read_b64_tr_b16 a[36:37], v13 offset:3136
    ds_read_b64_tr_b16 a[38:39], v13 offset:3904
    s_waitcnt lgkmcnt(8)
    v_mfma_f32_32x32x16_bf16 v[96:111], a[16:19], a[0:3], v[96:111]
    v_mfma_f32_32x32x16_bf16 v[112:127], a[16:19], a[4:7], v[112:127]
    s_waitcnt lgkmcnt(4)
    v_mfma_f32_32x32x16_bf16 v[32:47], a[28:31], a[20:23], v[32:47]
    ds_read_b128 a[0:3], v11 offset:16384
    ds_read_b64_tr_b16 a[8:9], v13 offset:6144
    v_mfma_f32_32x32x16_bf16 v[48:63], a[28:31], a[24:27], v[48:63]
    ds_read_b64_tr_b16 a[10:11], v13 offset:6912
    ds_read_b128 a[4:7], v11 offset:20480
    s_waitcnt lgkmcnt(6)
    v_mfma_f32_32x32x16_bf16 v[64:79], a[32:35], a[20:23], v[64:79]
    ds_read_b64_tr_b16 a[12:13], v13 offset:6176
    ds_read_b64_tr_b16 a[14:15], v13 offset:6944
    v_mfma_f32_32x32x16_bf16 v[80:95], a[32:35], a[24:27], v[80:95]
    ds_read_b64_tr_b16 a[16:17], v13 offset:6208
    ds_read_b64_tr_b16 a[18:19], v13 offset:6976
    s_waitcnt lgkmcnt(8)
    v_mfma_f32_32x32x16_bf16 v[96:111], a[36:39], a[20:23], v[96:111]
    v_mfma_f32_32x32x16_bf16 v[112:127], a[36:39], a[24:27], v[112:127]
    s_waitcnt lgkmcnt(4)
    v_mfma_f32_32x32x16_bf16 v[32:47], a[8:11], a[0:3], v[32:47]
    ds_read_b128 a[20:23], v12 offset:16384
    ds_read_b64_tr_b16 a[28:29], v13 offset:9216
    v_mfma_f32_32x32x16_bf16 v[48:63], a[8:11], a[4:7], v[48:63]
    ds_read_b64_tr_b16 a[30:31], v13 offset:9984
    ds_read_b128 a[24:27], v12 offset:20480
    s_waitcnt lgkmcnt(6)
    v_mfma_f32_32x32x16_bf16 v[64:79], a[12:15], a[0:3], v[64:79]
    ds_read_b64_tr_b16 a[32:33], v13 offset:9248
    ds_read_b64_tr_b16 a[34:35], v13 offset:10016
    v_mfma_f32_32x32x16_bf16 v[80:95], a[12:15], a[4:7], v[80:95]
    ds_read_b64_tr_b16 a[36:37], v13 offset:9280
    ds_read_b64_tr_b16 a[38:39], v13 offset:10048
    s_waitcnt lgkmcnt(8)
    v_mfma_f32_32x32x16_bf16 v[96:111], a[16:19], a[0:3], v[96:111]
    v_mfma_f32_32x32x16_bf16 v[112:127], a[16:19], a[4:7], v[112:127]
    s_waitcnt lgkmcnt(4)
    v_mfma_f32_32x32x16_bf16 v[32:47], a[28:31], a[20:23], v[32:47]
    s_waitcnt vmcnt(0) lgkmcnt(0)
    s_barrier
    ds_read_b128 a[0:3], v9 offset:8192
    ds_read_b64_tr_b16 a[8:9], v13 offset:24608
    v_mfma_f32_32x32x16_bf16 v[48:63], a[28:31], a[24:27], v[48:63]
    ds_read_b64_tr_b16 a[10:11], v13 offset:25376
    ds_read_b128 a[4:7], v9 offset:12288
    v_mfma_f32_32x32x16_bf16 v[64:79], a[32:35], a[20:23], v[64:79]
    ds_read_b64_tr_b16 a[12:13], v13 offset:24640
    ds_read_b64_tr_b16 a[14:15], v13 offset:25408
    v_mfma_f32_32x32x16_bf16 v[80:95], a[32:35], a[24:27], v[80:95]
    ds_read_b64_tr_b16 a[16:17], v13 offset:24672
    ds_read_b64_tr_b16 a[18:19], v13 offset:25440
    v_mfma_f32_32x32x16_bf16 v[96:111], a[36:39], a[20:23], v[96:111]
    v_mfma_f32_32x32x16_bf16 v[112:127], a[36:39], a[24:27], v[112:127]
    s_waitcnt lgkmcnt(4)
    v_mfma_f32_32x32x16_bf16 v[32:47], a[8:11], a[0:3], v[32:47]
    ds_read_b128 a[20:23], v10 offset:8192
    ds_read_b64_tr_b16 a[28:29], v13 offset:27680
    v_mfma_f32_32x32x16_bf16 v[48:63], a[8:11], a[4:7], v[48:63]
    ds_read_b64_tr_b16 a[30:31], v13 offset:28448
    ds_read_b128 a[24:27], v10 offset:12288
    s_waitcnt lgkmcnt(6)
    v_mfma_f32_32x32x16_bf16 v[64:79], a[12:15], a[0:3], v[64:79]
    ds_read_b64_tr_b16 a[32:33], v13 offset:27712
    ds_read_b64_tr_b16 a[34:35], v13 offset:28480
    v_mfma_f32_32x32x16_bf16 v[80:95], a[12:15], a[4:7], v[80:95]
    ds_read_b64_tr_b16 a[36:37], v13 offset:27744
    ds_read_b64_tr_b16 a[38:39], v13 offset:28512
    s_waitcnt lgkmcnt(8)
    v_mfma_f32_32x32x16_bf16 v[96:111], a[16:19], a[0:3], v[96:111]
    v_mfma_f32_32x32x16_bf16 v[112:127], a[16:19], a[4:7], v[112:127]
    s_waitcnt lgkmcnt(4)
    v_mfma_f32_32x32x16_bf16 v[32:47], a[28:31], a[20:23], v[32:47]
    ds_read_b128 a[0:3], v11 offset:8192
    ds_read_b64_tr_b16 a[8:9], v13 offset:30752
    v_mfma_f32_32x32x16_bf16 v[48:63], a[28:31], a[24:27], v[48:63]
    ds_read_b64_tr_b16 a[10:11], v13 offset:31520
    ds_read_b128 a[4:7], v11 offset:12288
    s_waitcnt lgkmcnt(6)
    v_mfma_f32_32x32x16_bf16 v[64:79], a[32:35], a[20:23], v[64:79]
    ds_read_b64_tr_b16 a[12:13], v13 offset:30784
    ds_read_b64_tr_b16 a[14:15], v13 offset:31552
    v_mfma_f32_32x32x16_bf16 v[80:95], a[32:35], a[24:27], v[80:95]
    ds_read_b64_tr_b16 a[16:17], v13 offset:30816
    ds_read_b64_tr_b16 a[18:19], v13 offset:31584
    s_waitcnt lgkmcnt(8)
    v_mfma_f32_32x32x16_bf16 v[96:111], a[36:39], a[20:23], v[96:111]
    v_mfma_f32_32x32x16_bf16 v[112:127], a[36:39], a[24:27], v[112:127]
    s_waitcnt lgkmcnt(4)
    v_mfma_f32_32x32x16_bf16 v[32:47], a[8:11], a[0:3], v[32:47]
    ds_read_b128 a[20:23], v12 offset:8192
    ds_read_b64_tr_b16 a[28:29], v13 offset:33824
    v_mfma_f32_32x32x16_bf16 v[48:63], a[8:11], a[4:7], v[48:63]
    ds_read_b64_tr_b16 a[30:31], v13 offset:34592
    ds_read_b128 a[24:27], v12 offset:12288
    s_waitcnt lgkmcnt(6)
    v_mfma_f32_32x32x16_bf16 v[64:79], a[12:15], a[0:3], v[64:79]
    ds_read_b64_tr_b16 a[32:33], v13 offset:33856
    ds_read_b64_tr_b16 a[34:35], v13 offset:34624
    v_mfma_f32_32x32x16_bf16 v[80:95], a[12:15], a[4:7], v[80:95]
    ds_read_b64_tr_b16 a[36:37], v13 offset:33888
    ds_read_b64_tr_b16 a[38:39], v13 offset:34656
    s_waitcnt lgkmcnt(8)
    v_mfma_f32_32x32x16_bf16 v[96:111], a[16:19], a[0:3], v[96:111]
    v_mfma_f32_32x32x16_bf16 v[112:127], a[16:19], a[4:7], v[112:127]
    s_waitcnt lgkmcnt(4)
    v_mfma_f32_32x32x16_bf16 v[32:47], a[28:31], a[20:23], v[32:47]
    s_waitcnt lgkmcnt(0)
    s_barrier
    ds_read_b128 a[0:3], v9 offset:0
    ds_read_b64_tr_b16 a[8:9], v13 offset:49216
    v_mfma_f32_32x32x16_bf16 v[48:63], a[28:31], a[24:27], v[48:63]
    ds_read_b64_tr_b16 a[10:11], v13 offset:49984
    ds_read_b128 a[4:7], v9 offset:4096
    v_mfma_f32_32x32x16_bf16 v[64:79], a[32:35], a[20:23], v[64:79]
    ds_read_b64_tr_b16 a[12:13], v13 offset:49248
    ds_read_b64_tr_b16 a[14:15], v13 offset:50016
    v_mfma_f32_32x32x16_bf16 v[80:95], a[32:35], a[24:27], v[80:95]
    ds_read_b64_tr_b16 a[16:17], v13 offset:49280
    ds_read_b64_tr_b16 a[18:19], v13 offset:50048
    v_mfma_f32_32x32x16_bf16 v[96:111], a[36:39], a[20:23], v[96:111]
    v_mfma_f32_32x32x16_bf16 v[112:127], a[36:39], a[24:27], v[112:127]
    s_waitcnt lgkmcnt(4)
    v_mfma_f32_32x32x16_bf16 v[32:47], a[8:11], a[0:3], v[32:47]
    ds_read_b128 a[20:23], v10 offset:0
    ds_read_b64_tr_b16 a[28:29], v13 offset:52288
    v_mfma_f32_32x32x16_bf16 v[48:63], a[8:11], a[4:7], v[48:63]
    ds_read_b64_tr_b16 a[30:31], v13 offset:53056
    ds_read_b128 a[24:27], v10 offset:4096
    s_waitcnt lgkmcnt(6)
    v_mfma_f32_32x32x16_bf16 v[64:79], a[12:15], a[0:3], v[64:79]
    ds_read_b64_tr_b16 a[32:33], v13 offset:52320
    ds_read_b64_tr_b16 a[34:35], v13 offset:53088
    v_mfma_f32_32x32x16_bf16 v[80:95], a[12:15], a[4:7], v[80:95]
    ds_read_b64_tr_b16 a[36:37], v13 offset:52352
    ds_read_b64_tr_b16 a[38:39], v13 offset:53120
    s_waitcnt lgkmcnt(8)
    v_mfma_f32_32x32x16_bf16 v[96:111], a[16:19], a[0:3], v[96:111]
    v_mfma_f32_32x32x16_bf16 v[112:127], a[16:19], a[4:7], v[112:127]
    s_waitcnt lgkmcnt(4)
    v_mfma_f32_32x32x16_bf16 v[32:47], a[28:31], a[20:23], v[32:47]
    ds_read_b128 a[0:3], v11 offset:0
    ds_read_b64_tr_b16 a[8:9], v13 offset:55360
    v_mfma_f32_32x32x16_bf16 v[48:63], a[28:31], a[24:27], v[48:63]
    ds_read_b64_tr_b16 a[10:11], v13 offset:56128
    ds_read_b128 a[4:7], v11 offset:4096
    s_waitcnt lgkmcnt(6)
    v_mfma_f32_32x32x16_bf16 v[64:79], a[32:35], a[20:23], v[64:79]
    ds_read_b64_tr_b16 a[12:13], v13 offset:55392
    ds_read_b64_tr_b16 a[14:15], v13 offset:56160
    v_mfma_f32_32x32x16_bf16 v[80:95], a[32:35], a[24:27], v[80:95]
    ds_read_b64_tr_b16 a[16:17], v13 offset:55424
    ds_read_b64_tr_b16 a[18:19], v13 offset:56192
    s_waitcnt lgkmcnt(8)
    v_mfma_f32_32x32x16_bf16 v[96:111], a[36:39], a[20:23], v[96:111]
    v_mfma_f32_32x32x16_bf16 v[112:127], a[36:39], a[24:27], v[112:127]
    s_waitcnt lgkmcnt(4)
    v_mfma_f32_32x32x16_bf16 v[32:47], a[8:11], a[0:3], v[32:47]
    ds_read_b128 a[20:23], v12 offset:0
    ds_read_b64_tr_b16 a[28:29], v13 offset:58432
    v_mfma_f32_32x32x16_bf16 v[48:63], a[8:11], a[4:7], v[48:63]
    ds_read_b64_tr_b16 a[30:31], v13 offset:59200
    ds_read_b128 a[24:27], v12 offset:4096
    s_waitcnt lgkmcnt(6)
    v_mfma_f32_32x32x16_bf16 v[64:79], a[12:15], a[0:3], v[64:79]
    ds_read_b64_tr_b16 a[32:33], v13 offset:58464
    ds_read_b64_tr_b16 a[34:35], v13 offset:59232
    v_mfma_f32_32x32x16_bf16 v[80:95], a[12:15], a[4:7], v[80:95]
    ds_read_b64_tr_b16 a[36:37], v13 offset:58496
    ds_read_b64_tr_b16 a[38:39], v13 offset:59264
    s_waitcnt lgkmcnt(8)
    v_mfma_f32_32x32x16_bf16 v[96:111], a[16:19], a[0:3], v[96:111]
    v_mfma_f32_32x32x16_bf16 v[112:127], a[16:19], a[4:7], v[112:127]
    s_waitcnt lgkmcnt(4)
    v_mfma_f32_32x32x16_bf16 v[32:47], a[28:31], a[20:23], v[32:47]
    s_waitcnt lgkmcnt(0)
    s_barrier
    ds_read_b128 a[0:3], v9 offset:32768
    ds_read_b64_tr_b16 a[8:9], v13 offset:0
    v_mfma_f32_32x32x16_bf16 v[48:63], a[28:31], a[24:27], v[48:63]
    ds_read_b64_tr_b16 a[10:11], v13 offset:768
    ds_read_b128 a[4:7], v9 offset:36864
    v_mfma_f32_32x32x16_bf16 v[64:79], a[32:35], a[20:23], v[64:79]
    ds_read_b64_tr_b16 a[12:13], v13 offset:32
    ds_read_b64_tr_b16 a[14:15], v13 offset:800
    v_mfma_f32_32x32x16_bf16 v[80:95], a[32:35], a[24:27], v[80:95]
    ds_read_b64_tr_b16 a[16:17], v13 offset:64
    ds_read_b64_tr_b16 a[18:19], v13 offset:832
    v_mfma_f32_32x32x16_bf16 v[96:111], a[36:39], a[20:23], v[96:111]
    v_mfma_f32_32x32x16_bf16 v[112:127], a[36:39], a[24:27], v[112:127]
    s_waitcnt lgkmcnt(4)
    v_mfma_f32_32x32x16_bf16 v[32:47], a[8:11], a[0:3], v[32:47]
    ds_read_b128 a[20:23], v10 offset:32768
    ds_read_b64_tr_b16 a[28:29], v13 offset:3072
    v_mfma_f32_32x32x16_bf16 v[48:63], a[8:11], a[4:7], v[48:63]
    ds_read_b64_tr_b16 a[30:31], v13 offset:3840
    ds_read_b128 a[24:27], v10 offset:36864
    s_waitcnt lgkmcnt(6)
    v_mfma_f32_32x32x16_bf16 v[64:79], a[12:15], a[0:3], v[64:79]
    ds_read_b64_tr_b16 a[32:33], v13 offset:3104
    ds_read_b64_tr_b16 a[34:35], v13 offset:3872
    v_mfma_f32_32x32x16_bf16 v[80:95], a[12:15], a[4:7], v[80:95]
    ds_read_b64_tr_b16 a[36:37], v13 offset:3136
    ds_read_b64_tr_b16 a[38:39], v13 offset:3904
    s_waitcnt lgkmcnt(8)
    v_mfma_f32_32x32x16_bf16 v[96:111], a[16:19], a[0:3], v[96:111]
    buffer_store_dwordx4 v[28:31], v20, s[36:39], 0 offen sc1
    v_mfma_f32_32x32x16_bf16 v[112:127], a[16:19], a[4:7], v[112:127]
    s_mov_b32 s66, 40960
    buffer_store_dwordx4 v[28:31], v20, s[36:39], s66 offen sc1
    s_waitcnt lgkmcnt(4)
    v_mfma_f32_32x32x16_bf16 v[32:47], a[28:31], a[20:23], v[32:47]
    ds_read_b128 a[0:3], v11 offset:32768
    ds_read_b64_tr_b16 a[8:9], v13 offset:6144
    v_mfma_f32_32x32x16_bf16 v[48:63], a[28:31], a[24:27], v[48:63]
    ds_read_b64_tr_b16 a[10:11], v13 offset:6912
    ds_read_b128 a[4:7], v11 offset:36864
    s_waitcnt lgkmcnt(6)
    v_mfma_f32_32x32x16_bf16 v[64:79], a[32:35], a[20:23], v[64:79]
    ds_read_b64_tr_b16 a[12:13], v13 offset:6176
    ds_read_b64_tr_b16 a[14:15], v13 offset:6944
    v_mfma_f32_32x32x16_bf16 v[80:95], a[32:35], a[24:27], v[80:95]
    ds_read_b64_tr_b16 a[16:17], v13 offset:6208
    ds_read_b64_tr_b16 a[18:19], v13 offset:6976
    s_waitcnt lgkmcnt(8)
    v_mfma_f32_32x32x16_bf16 v[96:111], a[36:39], a[20:23], v[96:111]
    buffer_store_dwordx4 v[28:31], v21, s[36:39], 0 offen offset:1024 sc1
    v_mfma_f32_32x32x16_bf16 v[112:127], a[36:39], a[24:27], v[112:127]
    s_waitcnt lgkmcnt(4)
    v_mfma_f32_32x32x16_bf16 v[32:47], a[8:11], a[0:3], v[32:47]
    ds_read_b128 a[20:23], v12 offset:32768
    ds_read_b64_tr_b16 a[28:29], v13 offset:9216
    v_mfma_f32_32x32x16_bf16 v[48:63], a[8:11], a[4:7], v[48:63]
    ds_read_b64_tr_b16 a[30:31], v13 offset:9984
    ds_read_b128 a[24:27], v12 offset:36864
    s_waitcnt lgkmcnt(6)
    v_mfma_f32_32x32x16_bf16 v[64:79], a[12:15], a[0:3], v[64:79]
    ds_read_b64_tr_b16 a[32:33], v13 offset:9248
    ds_read_b64_tr_b16 a[34:35], v13 offset:10016
    v_mfma_f32_32x32x16_bf16 v[80:95], a[12:15], a[4:7], v[80:95]
    ds_read_b64_tr_b16 a[36:37], v13 offset:9280
    ds_read_b64_tr_b16 a[38:39], v13 offset:10048
    s_waitcnt lgkmcnt(8)
    v_mfma_f32_32x32x16_bf16 v[96:111], a[16:19], a[0:3], v[96:111]
    v_mfma_f32_32x32x16_bf16 v[112:127], a[16:19], a[4:7], v[112:127]
    s_waitcnt lgkmcnt(4)
    v_mfma_f32_32x32x16_bf16 v[32:47], a[28:31], a[20:23], v[32:47]
    s_waitcnt lgkmcnt(0)
    s_barrier
    ds_read_b128 a[0:3], v9 offset:24576
    ds_read_b64_tr_b16 a[8:9], v13 offset:24608
    v_mfma_f32_32x32x16_bf16 v[48:63], a[28:31], a[24:27], v[48:63]
    ds_read_b64_tr_b16 a[10:11], v13 offset:25376
    ds_read_b128 a[4:7], v9 offset:28672
    v_mfma_f32_32x32x16_bf16 v[64:79], a[32:35], a[20:23], v[64:79]
    ds_read_b64_tr_b16 a[12:13], v13 offset:24640
    ds_read_b64_tr_b16 a[14:15], v13 offset:25408
    v_mfma_f32_32x32x16_bf16 v[80:95], a[32:35], a[24:27], v[80:95]
    ds_read_b64_tr_b16 a[16:17], v13 offset:24672
    ds_read_b64_tr_b16 a[18:19], v13 offset:25440
    v_mfma_f32_32x32x16_bf16 v[96:111], a[36:39], a[20:23], v[96:111]
    v_mfma_f32_32x32x16_bf16 v[112:127], a[36:39], a[24:27], v[112:127]
    s_waitcnt lgkmcnt(4)
    v_mfma_f32_32x32x16_bf16 v[32:47], a[8:11], a[0:3], v[32:47]
    ds_read_b128 a[20:23], v10 offset:24576
    ds_read_b64_tr_b16 a[28:29], v13 offset:27680
    v_mfma_f32_32x32x16_bf16 v[48:63], a[8:11], a[4:7], v[48:63]
    ds_read_b64_tr_b16 a[30:31], v13 offset:28448
    ds_read_b128 a[24:27], v10 offset:28672
    s_waitcnt lgkmcnt(6)
    v_mfma_f32_32x32x16_bf16 v[64:79], a[12:15], a[0:3], v[64:79]
    ds_read_b64_tr_b16 a[32:33], v13 offset:27712
    ds_read_b64_tr_b16 a[34:35], v13 offset:28480
    v_mfma_f32_32x32x16_bf16 v[80:95], a[12:15], a[4:7], v[80:95]
    ds_read_b64_tr_b16 a[36:37], v13 offset:27744
    ds_read_b64_tr_b16 a[38:39], v13 offset:28512
    s_waitcnt lgkmcnt(8)
    v_mfma_f32_32x32x16_bf16 v[96:111], a[16:19], a[0:3], v[96:111]
    v_mfma_f32_32x32x16_bf16 v[112:127], a[16:19], a[4:7], v[112:127]
    s_waitcnt lgkmcnt(4)
    v_mfma_f32_32x32x16_bf16 v[32:47], a[28:31], a[20:23], v[32:47]
    ds_read_b128 a[0:3], v11 offset:24576
    ds_read_b64_tr_b16 a[8:9], v13 offset:30752
    v_mfma_f32_32x32x16_bf16 v[48:63], a[28:31], a[24:27], v[48:63]
    ds_read_b64_tr_b16 a[10:11], v13 offset:31520
    ds_read_b128 a[4:7], v11 offset:28672
    s_waitcnt lgkmcnt(6)
    v_mfma_f32_32x32x16_bf16 v[64:79], a[32:35], a[20:23], v[64:79]
    ds_read_b64_tr_b16 a[12:13], v13 offset:30784
    ds_read_b64_tr_b16 a[14:15], v13 offset:31552
    v_mfma_f32_32x32x16_bf16 v[80:95], a[32:35], a[24:27], v[80:95]
    ds_read_b64_tr_b16 a[16:17], v13 offset:30816
    ds_read_b64_tr_b16 a[18:19], v13 offset:31584
    s_waitcnt lgkmcnt(8)
    v_mfma_f32_32x32x16_bf16 v[96:111], a[36:39], a[20:23], v[96:111]
    v_mfma_f32_32x32x16_bf16 v[112:127], a[36:39], a[24:27], v[112:127]
    s_waitcnt lgkmcnt(4)
    v_mfma_f32_32x32x16_bf16 v[32:47], a[8:11], a[0:3], v[32:47]
    ds_read_b128 a[20:23], v12 offset:24576
    ds_read_b64_tr_b16 a[28:29], v13 offset:33824
    v_mfma_f32_32x32x16_bf16 v[48:63], a[8:11], a[4:7], v[48:63]
    ds_read_b64_tr_b16 a[30:31], v13 offset:34592
    ds_read_b128 a[24:27], v12 offset:28672
    s_waitcnt lgkmcnt(6)
    v_mfma_f32_32x32x16_bf16 v[64:79], a[12:15], a[0:3], v[64:79]
    ds_read_b64_tr_b16 a[32:33], v13 offset:33856
    ds_read_b64_tr_b16 a[34:35], v13 offset:34624
    v_mfma_f32_32x32x16_bf16 v[80:95], a[12:15], a[4:7], v[80:95]
    ds_read_b64_tr_b16 a[36:37], v13 offset:33888
    ds_read_b64_tr_b16 a[38:39], v13 offset:34656
    s_waitcnt lgkmcnt(8)
    v_mfma_f32_32x32x16_bf16 v[96:111], a[16:19], a[0:3], v[96:111]
    v_mfma_f32_32x32x16_bf16 v[112:127], a[16:19], a[4:7], v[112:127]
    s_waitcnt lgkmcnt(4)
    v_mfma_f32_32x32x16_bf16 v[32:47], a[28:31], a[20:23], v[32:47]
    s_waitcnt lgkmcnt(0)
    s_barrier
    ds_read_b128 a[0:3], v9 offset:16384
    ds_read_b64_tr_b16 a[8:9], v13 offset:49216
    v_mfma_f32_32x32x16_bf16 v[48:63], a[28:31], a[24:27], v[48:63]
    ds_read_b64_tr_b16 a[10:11], v13 offset:49984
    ds_read_b128 a[4:7], v9 offset:20480
    v_mfma_f32_32x32x16_bf16 v[64:79], a[32:35], a[20:23], v[64:79]
    ds_read_b64_tr_b16 a[12:13], v13 offset:49248
    ds_read_b64_tr_b16 a[14:15], v13 offset:50016
    v_mfma_f32_32x32x16_bf16 v[80:95], a[32:35], a[24:27], v[80:95]
    ds_read_b64_tr_b16 a[16:17], v13 offset:49280
    ds_read_b64_tr_b16 a[18:19], v13 offset:50048
    v_mfma_f32_32x32x16_bf16 v[96:111], a[36:39], a[20:23], v[96:111]
    v_mfma_f32_32x32x16_bf16 v[112:127], a[36:39], a[24:27], v[112:127]
    s_waitcnt lgkmcnt(4)
    v_mfma_f32_32x32x16_bf16 v[32:47], a[8:11], a[0:3], v[32:47]
    ds_read_b128 a[20:23], v10 offset:16384
    ds_read_b64_tr_b16 a[28:29], v13 offset:52288
    v_mfma_f32_32x32x16_bf16 v[48:63], a[8:11], a[4:7], v[48:63]
    ds_read_b64_tr_b16 a[30:31], v13 offset:53056
    ds_read_b128 a[24:27], v10 offset:20480
    s_waitcnt lgkmcnt(6)
    v_mfma_f32_32x32x16_bf16 v[64:79], a[12:15], a[0:3], v[64:79]
    ds_read_b64_tr_b16 a[32:33], v13 offset:52320
    ds_read_b64_tr_b16 a[34:35], v13 offset:53088
    v_mfma_f32_32x32x16_bf16 v[80:95], a[12:15], a[4:7], v[80:95]
    ds_read_b64_tr_b16 a[36:37], v13 offset:52352
    ds_read_b64_tr_b16 a[38:39], v13 offset:53120
    s_waitcnt lgkmcnt(8)
    v_mfma_f32_32x32x16_bf16 v[96:111], a[16:19], a[0:3], v[96:111]
    v_mfma_f32_32x32x16_bf16 v[112:127], a[16:19], a[4:7], v[112:127]
    s_waitcnt lgkmcnt(4)
    v_mfma_f32_32x32x16_bf16 v[32:47], a[28:31], a[20:23], v[32:47]
    ds_read_b128 a[0:3], v11 offset:16384
    ds_read_b64_tr_b16 a[8:9], v13 offset:55360
    v_mfma_f32_32x32x16_bf16 v[48:63], a[28:31], a[24:27], v[48:63]
    ds_read_b64_tr_b16 a[10:11], v13 offset:56128
    ds_read_b128 a[4:7], v11 offset:20480
    s_waitcnt lgkmcnt(6)
    v_mfma_f32_32x32x16_bf16 v[64:79], a[32:35], a[20:23], v[64:79]
    ds_read_b64_tr_b16 a[12:13], v13 offset:55392
    ds_read_b64_tr_b16 a[14:15], v13 offset:56160
    v_mfma_f32_32x32x16_bf16 v[80:95], a[32:35], a[24:27], v[80:95]
    ds_read_b64_tr_b16 a[16:17], v13 offset:55424
    ds_read_b64_tr_b16 a[18:19], v13 offset:56192
    s_waitcnt lgkmcnt(8)
    v_mfma_f32_32x32x16_bf16 v[96:111], a[36:39], a[20:23], v[96:111]
    v_mfma_f32_32x32x16_bf16 v[112:127], a[36:39], a[24:27], v[112:127]
    s_waitcnt lgkmcnt(4)
    v_mfma_f32_32x32x16_bf16 v[32:47], a[8:11], a[0:3], v[32:47]
    ds_read_b128 a[20:23], v12 offset:16384
    ds_read_b64_tr_b16 a[28:29], v13 offset:58432
    v_mfma_f32_32x32x16_bf16 v[48:63], a[8:11], a[4:7], v[48:63]
    ds_read_b64_tr_b16 a[30:31], v13 offset:59200
    ds_read_b128 a[24:27], v12 offset:20480
    s_waitcnt lgkmcnt(6)
    v_mfma_f32_32x32x16_bf16 v[64:79], a[12:15], a[0:3], v[64:79]
    ds_read_b64_tr_b16 a[32:33], v13 offset:58464
    ds_read_b64_tr_b16 a[34:35], v13 offset:59232
    v_mfma_f32_32x32x16_bf16 v[80:95], a[12:15], a[4:7], v[80:95]
    ds_read_b64_tr_b16 a[36:37], v13 offset:58496
    ds_read_b64_tr_b16 a[38:39], v13 offset:59264
    s_waitcnt lgkmcnt(8)
    v_mfma_f32_32x32x16_bf16 v[96:111], a[16:19], a[0:3], v[96:111]
    v_mfma_f32_32x32x16_bf16 v[112:127], a[16:19], a[4:7], v[112:127]
    s_waitcnt lgkmcnt(4)
    v_mfma_f32_32x32x16_bf16 v[32:47], a[28:31], a[20:23], v[32:47]
    s_waitcnt lgkmcnt(0)
    s_barrier
    ds_read_b128 a[0:3], v9 offset:8192
    ds_read_b64_tr_b16 a[8:9], v13 offset:0
    v_mfma_f32_32x32x16_bf16 v[48:63], a[28:31], a[24:27], v[48:63]
    ds_read_b64_tr_b16 a[10:11], v13 offset:768
    ds_read_b128 a[4:7], v9 offset:12288
    v_mfma_f32_32x32x16_bf16 v[64:79], a[32:35], a[20:23], v[64:79]
    ds_read_b64_tr_b16 a[12:13], v13 offset:32
    ds_read_b64_tr_b16 a[14:15], v13 offset:800
    v_mfma_f32_32x32x16_bf16 v[80:95], a[32:35], a[24:27], v[80:95]
    ds_read_b64_tr_b16 a[16:17], v13 offset:64
    ds_read_b64_tr_b16 a[18:19], v13 offset:832
    v_mfma_f32_32x32x16_bf16 v[96:111], a[36:39], a[20:23], v[96:111]
    v_mfma_f32_32x32x16_bf16 v[112:127], a[36:39], a[24:27], v[112:127]
    s_waitcnt lgkmcnt(4)
    v_mfma_f32_32x32x16_bf16 v[32:47], a[8:11], a[0:3], v[32:47]
    ds_read_b128 a[20:23], v10 offset:8192
    ds_read_b64_tr_b16 a[28:29], v13 offset:3072
    v_mfma_f32_32x32x16_bf16 v[48:63], a[8:11], a[4:7], v[48:63]
    ds_read_b64_tr_b16 a[30:31], v13 offset:3840
    ds_read_b128 a[24:27], v10 offset:12288
    s_waitcnt lgkmcnt(6)
    v_mfma_f32_32x32x16_bf16 v[64:79], a[12:15], a[0:3], v[64:79]
    ds_read_b64_tr_b16 a[32:33], v13 offset:3104
    ds_read_b64_tr_b16 a[34:35], v13 offset:3872
    v_mfma_f32_32x32x16_bf16 v[80:95], a[12:15], a[4:7], v[80:95]
    ds_read_b64_tr_b16 a[36:37], v13 offset:3136
    ds_read_b64_tr_b16 a[38:39], v13 offset:3904
    s_waitcnt lgkmcnt(8)
    v_mfma_f32_32x32x16_bf16 v[96:111], a[16:19], a[0:3], v[96:111]
    v_mfma_f32_32x32x16_bf16 v[112:127], a[16:19], a[4:7], v[112:127]
    s_waitcnt lgkmcnt(4)
    v_mfma_f32_32x32x16_bf16 v[32:47], a[28:31], a[20:23], v[32:47]
    ds_read_b128 a[0:3], v11 offset:8192
    ds_read_b64_tr_b16 a[8:9], v13 offset:6144
    v_mfma_f32_32x32x16_bf16 v[48:63], a[28:31], a[24:27], v[48:63]
    ds_read_b64_tr_b16 a[10:11], v13 offset:6912
    ds_read_b128 a[4:7], v11 offset:12288
    s_waitcnt lgkmcnt(6)
    v_mfma_f32_32x32x16_bf16 v[64:79], a[32:35], a[20:23], v[64:79]
    ds_read_b64_tr_b16 a[12:13], v13 offset:6176
    ds_read_b64_tr_b16 a[14:15], v13 offset:6944
    v_mfma_f32_32x32x16_bf16 v[80:95], a[32:35], a[24:27], v[80:95]
    ds_read_b64_tr_b16 a[16:17], v13 offset:6208
    ds_read_b64_tr_b16 a[18:19], v13 offset:6976
    s_waitcnt lgkmcnt(8)
    v_mfma_f32_32x32x16_bf16 v[96:111], a[36:39], a[20:23], v[96:111]
    v_mfma_f32_32x32x16_bf16 v[112:127], a[36:39], a[24:27], v[112:127]
    s_waitcnt lgkmcnt(4)
    v_mfma_f32_32x32x16_bf16 v[32:47], a[8:11], a[0:3], v[32:47]
    ds_read_b128 a[20:23], v12 offset:8192
    ds_read_b64_tr_b16 a[28:29], v13 offset:9216
    v_mfma_f32_32x32x16_bf16 v[48:63], a[8:11], a[4:7], v[48:63]
    ds_read_b64_tr_b16 a[30:31], v13 offset:9984
    ds_read_b128 a[24:27], v12 offset:12288
    s_waitcnt lgkmcnt(6)
    v_mfma_f32_32x32x16_bf16 v[64:79], a[12:15], a[0:3], v[64:79]
    ds_read_b64_tr_b16 a[32:33], v13 offset:9248
    ds_read_b64_tr_b16 a[34:35], v13 offset:10016
    v_mfma_f32_32x32x16_bf16 v[80:95], a[12:15], a[4:7], v[80:95]
    ds_read_b64_tr_b16 a[36:37], v13 offset:9280
    ds_read_b64_tr_b16 a[38:39], v13 offset:10048
    s_waitcnt lgkmcnt(8)
    v_mfma_f32_32x32x16_bf16 v[96:111], a[16:19], a[0:3], v[96:111]
    v_mfma_f32_32x32x16_bf16 v[112:127], a[16:19], a[4:7], v[112:127]
    s_waitcnt lgkmcnt(4)
    v_mfma_f32_32x32x16_bf16 v[32:47], a[28:31], a[20:23], v[32:47]
    s_waitcnt lgkmcnt(0)
    s_barrier
    ds_read_b128 a[0:3], v9 offset:0
    ds_read_b64_tr_b16 a[8:9], v13 offset:24608
    v_mfma_f32_32x32x16_bf16 v[48:63], a[28:31], a[24:27], v[48:63]
    ds_read_b64_tr_b16 a[10:11], v13 offset:25376
    ds_read_b128 a[4:7], v9 offset:4096
    v_mfma_f32_32x32x16_bf16 v[64:79], a[32:35], a[20:23], v[64:79]
    ds_read_b64_tr_b16 a[12:13], v13 offset:24640
    ds_read_b64_tr_b16 a[14:15], v13 offset:25408
    v_mfma_f32_32x32x16_bf16 v[80:95], a[32:35], a[24:27], v[80:95]
    ds_read_b64_tr_b16 a[16:17], v13 offset:24672
    ds_read_b64_tr_b16 a[18:19], v13 offset:25440
    v_mfma_f32_32x32x16_bf16 v[96:111], a[36:39], a[20:23], v[96:111]
    v_mfma_f32_32x32x16_bf16 v[112:127], a[36:39], a[24:27], v[112:127]
    s_waitcnt lgkmcnt(4)
    v_mfma_f32_32x32x16_bf16 v[32:47], a[8:11], a[0:3], v[32:47]
    ds_read_b128 a[20:23], v10 offset:0
    ds_read_b64_tr_b16 a[28:29], v13 offset:27680
    v_mfma_f32_32x32x16_bf16 v[48:63], a[8:11], a[4:7], v[48:63]
    ds_read_b64_tr_b16 a[30:31], v13 offset:28448
    ds_read_b128 a[24:27], v10 offset:4096
    s_waitcnt lgkmcnt(6)
    v_mfma_f32_32x32x16_bf16 v[64:79], a[12:15], a[0:3], v[64:79]
    ds_read_b64_tr_b16 a[32:33], v13 offset:27712
    ds_read_b64_tr_b16 a[34:35], v13 offset:28480
    v_mfma_f32_32x32x16_bf16 v[80:95], a[12:15], a[4:7], v[80:95]
    ds_read_b64_tr_b16 a[36:37], v13 offset:27744
    ds_read_b64_tr_b16 a[38:39], v13 offset:28512
    s_waitcnt lgkmcnt(8)
    v_mfma_f32_32x32x16_bf16 v[96:111], a[16:19], a[0:3], v[96:111]
    v_mfma_f32_32x32x16_bf16 v[112:127], a[16:19], a[4:7], v[112:127]
    s_waitcnt lgkmcnt(4)
    v_mfma_f32_32x32x16_bf16 v[32:47], a[28:31], a[20:23], v[32:47]
    ds_read_b128 a[0:3], v11 offset:0
    ds_read_b64_tr_b16 a[8:9], v13 offset:30752
    v_mfma_f32_32x32x16_bf16 v[48:63], a[28:31], a[24:27], v[48:63]
    ds_read_b64_tr_b16 a[10:11], v13 offset:31520
    ds_read_b128 a[4:7], v11 offset:4096
    s_waitcnt lgkmcnt(6)
    v_mfma_f32_32x32x16_bf16 v[64:79], a[32:35], a[20:23], v[64:79]
    ds_read_b64_tr_b16 a[12:13], v13 offset:30784
    ds_read_b64_tr_b16 a[14:15], v13 offset:31552
    v_mfma_f32_32x32x16_bf16 v[80:95], a[32:35], a[24:27], v[80:95]
    ds_read_b64_tr_b16 a[16:17], v13 offset:30816
    ds_read_b64_tr_b16 a[18:19], v13 offset:31584
    s_waitcnt lgkmcnt(8)
    v_mfma_f32_32x32x16_bf16 v[96:111], a[36:39], a[20:23], v[96:111]
    v_mfma_f32_32x32x16_bf16 v[112:127], a[36:39], a[24:27], v[112:127]
    s_waitcnt lgkmcnt(4)
    v_mfma_f32_32x32x16_bf16 v[32:47], a[8:11], a[0:3], v[32:47]
    ds_read_b128 a[20:23], v12 offset:0
    ds_read_b64_tr_b16 a[28:29], v13 offset:33824
    v_mfma_f32_32x32x16_bf16 v[48:63], a[8:11], a[4:7], v[48:63]
    ds_read_b64_tr_b16 a[30:31], v13 offset:34592
    ds_read_b128 a[24:27], v12 offset:4096
    s_waitcnt lgkmcnt(6)
    v_mfma_f32_32x32x16_bf16 v[64:79], a[12:15], a[0:3], v[64:79]
    ds_read_b64_tr_b16 a[32:33], v13 offset:33856
    ds_read_b64_tr_b16 a[34:35], v13 offset:34624
    v_mfma_f32_32x32x16_bf16 v[80:95], a[12:15], a[4:7], v[80:95]
    ds_read_b64_tr_b16 a[36:37], v13 offset:33888
    ds_read_b64_tr_b16 a[38:39], v13 offset:34656
    s_waitcnt lgkmcnt(8)
    v_mfma_f32_32x32x16_bf16 v[96:111], a[16:19], a[0:3], v[96:111]
    v_mfma_f32_32x32x16_bf16 v[112:127], a[16:19], a[4:7], v[112:127]
    s_waitcnt lgkmcnt(4)
    v_mfma_f32_32x32x16_bf16 v[32:47], a[28:31], a[20:23], v[32:47]
    v_mfma_f32_32x32x16_bf16 v[48:63], a[28:31], a[24:27], v[48:63]
    s_waitcnt lgkmcnt(2)
    v_mfma_f32_32x32x16_bf16 v[64:79], a[32:35], a[20:23], v[64:79]
    v_mfma_f32_32x32x16_bf16 v[80:95], a[32:35], a[24:27], v[80:95]
    s_waitcnt lgkmcnt(0)
    v_mfma_f32_32x32x16_bf16 v[96:111], a[36:39], a[20:23], v[96:111]
    v_mfma_f32_32x32x16_bf16 v[112:127], a[36:39], a[24:27], v[112:127]
    s_setprio 2
    s_lshl_b32 s52, s46, 1
    s_add_u32 s52, s52, s26
    s_mul_i32 s66, s52, 196608
    s_lshl_b32 s52, s62, 1
    s_add_u32 s52, s52, s27
    s_mul_i32 s52, s52, 3072
    s_add_u32 s66, s66, s52
    s_add_u32 s66, s66, 11534336
    s_add_u32 s67, s66, 98304
    v_lshlrev_b32 v9, 4, v1
    v_mov_b32 v10, 0xbfb8aa3b
    v_mov_b32 v11, 0xbfb8aa3b
    v_mov_b32 v12, 1.0
    v_mov_b32 v13, 1.0
    v_pk_mul_f32 v[16:17], v[32:33], v[10:11]
    v_pk_mul_f32 v[18:19], v[34:35], v[10:11]
    v_pk_mul_f32 v[20:21], v[36:37], v[10:11]
    v_pk_mul_f32 v[22:23], v[38:39], v[10:11]
    v_exp_f32 v16, v16
    v_exp_f32 v17, v17
    v_exp_f32 v18, v18
    v_exp_f32 v19, v19
    v_exp_f32 v20, v20
    v_exp_f32 v21, v21
    v_exp_f32 v22, v22
    v_exp_f32 v23, v23
    v_pk_mul_f32 v[32:33], v[32:33], v[40:41]
    v_pk_mul_f32 v[34:35], v[34:35], v[42:43]
    v_pk_mul_f32 v[36:37], v[36:37], v[44:45]
    v_pk_mul_f32 v[38:39], v[38:39], v[46:47]
    v_pk_add_f32 v[16:17], v[16:17], v[12:13]
    v_pk_add_f32 v[18:19], v[18:19], v[12:13]
    v_pk_add_f32 v[20:21], v[20:21], v[12:13]
    v_pk_add_f32 v[22:23], v[22:23], v[12:13]
    v_rcp_f32 v16, v16
    v_rcp_f32 v17, v17
    v_rcp_f32 v18, v18
    v_rcp_f32 v19, v19
    v_rcp_f32 v20, v20
    v_rcp_f32 v21, v21
    v_rcp_f32 v22, v22
    v_rcp_f32 v23, v23
    s_nop 0
    v_pk_mul_f32 v[32:33], v[32:33], v[16:17]
    v_pk_mul_f32 v[34:35], v[34:35], v[18:19]
    v_pk_mul_f32 v[36:37], v[36:37], v[20:21]
    v_pk_mul_f32 v[38:39], v[38:39], v[22:23]
    v_cvt_pk_bf16_f32 v24, v32, v33
    v_cvt_pk_bf16_f32 v25, v34, v35
    v_cvt_pk_bf16_f32 v26, v36, v37
    v_cvt_pk_bf16_f32 v27, v38, v39
    buffer_store_dwordx4 v[24:27], v9, s[36:39], s66 offen offset:0 sc1
    v_pk_mul_f32 v[16:17], v[48:49], v[10:11]
    v_pk_mul_f32 v[18:19], v[50:51], v[10:11]
    v_pk_mul_f32 v[20:21], v[52:53], v[10:11]
    v_pk_mul_f32 v[22:23], v[54:55], v[10:11]
    v_exp_f32 v16, v16
    v_exp_f32 v17, v17
    v_exp_f32 v18, v18
    v_exp_f32 v19, v19
    v_exp_f32 v20, v20
    v_exp_f32 v21, v21
    v_exp_f32 v22, v22
    v_exp_f32 v23, v23
    v_pk_mul_f32 v[48:49], v[48:49], v[56:57]
    v_pk_mul_f32 v[50:51], v[50:51], v[58:59]
    v_pk_mul_f32 v[52:53], v[52:53], v[60:61]
    v_pk_mul_f32 v[54:55], v[54:55], v[62:63]
    v_pk_add_f32 v[16:17], v[16:17], v[12:13]
    v_pk_add_f32 v[18:19], v[18:19], v[12:13]
    v_pk_add_f32 v[20:21], v[20:21], v[12:13]
    v_pk_add_f32 v[22:23], v[22:23], v[12:13]
    v_rcp_f32 v16, v16
    v_rcp_f32 v17, v17
    v_rcp_f32 v18, v18
    v_rcp_f32 v19, v19
    v_rcp_f32 v20, v20
    v_rcp_f32 v21, v21
    v_rcp_f32 v22, v22
    v_rcp_f32 v23, v23
    s_nop 0
    v_pk_mul_f32 v[48:49], v[48:49], v[16:17]
    v_pk_mul_f32 v[50:51], v[50:51], v[18:19]
    v_pk_mul_f32 v[52:53], v[52:53], v[20:21]
    v_pk_mul_f32 v[54:55], v[54:55], v[22:23]
    v_cvt_pk_bf16_f32 v28, v48, v49
    v_cvt_pk_bf16_f32 v29, v50, v51
    v_cvt_pk_bf16_f32 v30, v52, v53
    v_cvt_pk_bf16_f32 v31, v54, v55
    buffer_store_dwordx4 v[28:31], v9, s[36:39], s67 offen offset:0 sc1
    v_pk_mul_f32 v[16:17], v[64:65], v[10:11]
    v_pk_mul_f32 v[18:19], v[66:67], v[10:11]
    v_pk_mul_f32 v[20:21], v[68:69], v[10:11]
    v_pk_mul_f32 v[22:23], v[70:71], v[10:11]
    v_exp_f32 v16, v16
    v_exp_f32 v17, v17
    v_exp_f32 v18, v18
    v_exp_f32 v19, v19
    v_exp_f32 v20, v20
    v_exp_f32 v21, v21
    v_exp_f32 v22, v22
    v_exp_f32 v23, v23
    v_pk_mul_f32 v[64:65], v[64:65], v[72:73]
    v_pk_mul_f32 v[66:67], v[66:67], v[74:75]
    v_pk_mul_f32 v[68:69], v[68:69], v[76:77]
    v_pk_mul_f32 v[70:71], v[70:71], v[78:79]
    v_pk_add_f32 v[16:17], v[16:17], v[12:13]
    v_pk_add_f32 v[18:19], v[18:19], v[12:13]
    v_pk_add_f32 v[20:21], v[20:21], v[12:13]
    v_pk_add_f32 v[22:23], v[22:23], v[12:13]
    v_rcp_f32 v16, v16
    v_rcp_f32 v17, v17
    v_rcp_f32 v18, v18
    v_rcp_f32 v19, v19
    v_rcp_f32 v20, v20
    v_rcp_f32 v21, v21
    v_rcp_f32 v22, v22
    v_rcp_f32 v23, v23
    s_nop 0
    v_pk_mul_f32 v[64:65], v[64:65], v[16:17]
    v_pk_mul_f32 v[66:67], v[66:67], v[18:19]
    v_pk_mul_f32 v[68:69], v[68:69], v[20:21]
    v_pk_mul_f32 v[70:71], v[70:71], v[22:23]
    v_cvt_pk_bf16_f32 v24, v64, v65
    v_cvt_pk_bf16_f32 v25, v66, v67
    v_cvt_pk_bf16_f32 v26, v68, v69
    v_cvt_pk_bf16_f32 v27, v70, v71
    buffer_store_dwordx4 v[24:27], v9, s[36:39], s66 offen offset:1024 sc1
    v_pk_mul_f32 v[16:17], v[80:81], v[10:11]
    v_pk_mul_f32 v[18:19], v[82:83], v[10:11]
    v_pk_mul_f32 v[20:21], v[84:85], v[10:11]
    v_pk_mul_f32 v[22:23], v[86:87], v[10:11]
    v_exp_f32 v16, v16
    v_exp_f32 v17, v17
    v_exp_f32 v18, v18
    v_exp_f32 v19, v19
    v_exp_f32 v20, v20
    v_exp_f32 v21, v21
    v_exp_f32 v22, v22
    v_exp_f32 v23, v23
    v_pk_mul_f32 v[80:81], v[80:81], v[88:89]
    v_pk_mul_f32 v[82:83], v[82:83], v[90:91]
    v_pk_mul_f32 v[84:85], v[84:85], v[92:93]
    v_pk_mul_f32 v[86:87], v[86:87], v[94:95]
    v_pk_add_f32 v[16:17], v[16:17], v[12:13]
    v_pk_add_f32 v[18:19], v[18:19], v[12:13]
    v_pk_add_f32 v[20:21], v[20:21], v[12:13]
    v_pk_add_f32 v[22:23], v[22:23], v[12:13]
    v_rcp_f32 v16, v16
    v_rcp_f32 v17, v17
    v_rcp_f32 v18, v18
    v_rcp_f32 v19, v19
    v_rcp_f32 v20, v20
    v_rcp_f32 v21, v21
    v_rcp_f32 v22, v22
    v_rcp_f32 v23, v23
    s_nop 0
    v_pk_mul_f32 v[80:81], v[80:81], v[16:17]
    v_pk_mul_f32 v[82:83], v[82:83], v[18:19]
    v_pk_mul_f32 v[84:85], v[84:85], v[20:21]
    v_pk_mul_f32 v[86:87], v[86:87], v[22:23]
    v_cvt_pk_bf16_f32 v28, v80, v81
    v_cvt_pk_bf16_f32 v29, v82, v83
    v_cvt_pk_bf16_f32 v30, v84, v85
    v_cvt_pk_bf16_f32 v31, v86, v87
    buffer_store_dwordx4 v[28:31], v9, s[36:39], s67 offen offset:1024 sc1
    v_pk_mul_f32 v[16:17], v[96:97], v[10:11]
    v_pk_mul_f32 v[18:19], v[98:99], v[10:11]
    v_pk_mul_f32 v[20:21], v[100:101], v[10:11]
    v_pk_mul_f32 v[22:23], v[102:103], v[10:11]
    v_exp_f32 v16, v16
    v_exp_f32 v17, v17
    v_exp_f32 v18, v18
    v_exp_f32 v19, v19
    v_exp_f32 v20, v20
    v_exp_f32 v21, v21
    v_exp_f32 v22, v22
    v_exp_f32 v23, v23
    v_pk_mul_f32 v[96:97], v[96:97], v[104:105]
    v_pk_mul_f32 v[98:99], v[98:99], v[106:107]
    v_pk_mul_f32 v[100:101], v[100:101], v[108:109]
    v_pk_mul_f32 v[102:103], v[102:103], v[110:111]
    v_pk_add_f32 v[16:17], v[16:17], v[12:13]
    v_pk_add_f32 v[18:19], v[18:19], v[12:13]
    v_pk_add_f32 v[20:21], v[20:21], v[12:13]
    v_pk_add_f32 v[22:23], v[22:23], v[12:13]
    v_rcp_f32 v16, v16
    v_rcp_f32 v17, v17
    v_rcp_f32 v18, v18
    v_rcp_f32 v19, v19
    v_rcp_f32 v20, v20
    v_rcp_f32 v21, v21
    v_rcp_f32 v22, v22
    v_rcp_f32 v23, v23
    s_nop 0
    v_pk_mul_f32 v[96:97], v[96:97], v[16:17]
    v_pk_mul_f32 v[98:99], v[98:99], v[18:19]
    v_pk_mul_f32 v[100:101], v[100:101], v[20:21]
    v_pk_mul_f32 v[102:103], v[102:103], v[22:23]
    v_cvt_pk_bf16_f32 v24, v96, v97
    v_cvt_pk_bf16_f32 v25, v98, v99
    v_cvt_pk_bf16_f32 v26, v100, v101
    v_cvt_pk_bf16_f32 v27, v102, v103
    buffer_store_dwordx4 v[24:27], v9, s[36:39], s66 offen offset:2048 sc1
    v_pk_mul_f32 v[16:17], v[112:113], v[10:11]
    v_pk_mul_f32 v[18:19], v[114:115], v[10:11]
    v_pk_mul_f32 v[20:21], v[116:117], v[10:11]
    v_pk_mul_f32 v[22:23], v[118:119], v[10:11]
    v_exp_f32 v16, v16
    v_exp_f32 v17, v17
    v_exp_f32 v18, v18
    v_exp_f32 v19, v19
    v_exp_f32 v20, v20
    v_exp_f32 v21, v21
    v_exp_f32 v22, v22
    v_exp_f32 v23, v23
    v_pk_mul_f32 v[112:113], v[112:113], v[120:121]
    v_pk_mul_f32 v[114:115], v[114:115], v[122:123]
    v_pk_mul_f32 v[116:117], v[116:117], v[124:125]
    v_pk_mul_f32 v[118:119], v[118:119], v[126:127]
    v_pk_add_f32 v[16:17], v[16:17], v[12:13]
    v_pk_add_f32 v[18:19], v[18:19], v[12:13]
    v_pk_add_f32 v[20:21], v[20:21], v[12:13]
    v_pk_add_f32 v[22:23], v[22:23], v[12:13]
    v_rcp_f32 v16, v16
    v_rcp_f32 v17, v17
    v_rcp_f32 v18, v18
    v_rcp_f32 v19, v19
    v_rcp_f32 v20, v20
    v_rcp_f32 v21, v21
    v_rcp_f32 v22, v22
    v_rcp_f32 v23, v23
    s_nop 0
    v_pk_mul_f32 v[112:113], v[112:113], v[16:17]
    v_pk_mul_f32 v[114:115], v[114:115], v[18:19]
    v_pk_mul_f32 v[116:117], v[116:117], v[20:21]
    v_pk_mul_f32 v[118:119], v[118:119], v[22:23]
    v_cvt_pk_bf16_f32 v28, v112, v113
    v_cvt_pk_bf16_f32 v29, v114, v115
    v_cvt_pk_bf16_f32 v30, v116, v117
    v_cvt_pk_bf16_f32 v31, v118, v119
    buffer_store_dwordx4 v[28:31], v9, s[36:39], s67 offen offset:2048 sc1
    s_and_b32 s52, s2, 7
    s_lshl_b32 s52, s52, 2
    s_bfe_u32 s53, s2, 0x20003
    s_add_u32 s53, s52, s53
    s_lshr_b32 s67, s2, 5
    s_lshl_b32 s67, s67, 8
    s_lshl_b32 s53, s53, 3
    s_add_u32 s67, s67, s53
    s_add_u32 s67, s67, 11079680
    s_lshr_b32 s62, s46, 1
    s_lshl_b32 s56, s46, 2
    s_add_u32 s56, s56, s47
    v_lshlrev_b32 v4, 4, v1
    s_mul_i32 s52, s48, 320
    v_accvgpr_read_b32 v5, a40
    v_accvgpr_read_b32 v6, a41
    v_accvgpr_read_b32 v7, a42
    v_accvgpr_read_b32 v8, a43
    v_accvgpr_read_b32 v9, a44
    v_accvgpr_read_b32 v10, a45
    v_accvgpr_read_b32 v11, a46
    v_accvgpr_read_b32 v12, a47
    v_accvgpr_read_b32 v13, a48
    v_accvgpr_read_b32 v14, a49
    v_accvgpr_read_b32 v15, a50
    s_mul_i32 s58, s45, 21504
    s_add_u32 s58, s58, 73728
    s_mul_i32 s59, s56, 98304
    s_mul_i32 s53, s45, 6144
    s_add_u32 s59, s59, s53
    s_add_u32 s59, s59, 11534336
    s_mul_i32 s60, s45, 122880
    s_add_u32 s60, s60, s52
    s_mul_i32 s57, s45, 204800
    s_add_u32 s57, s57, s52
    s_mov_b32 s32, s16
    s_mov_b32 s33, s17
    s_mov_b32 s34, 1966080
    s_mov_b32 s35, 0x20000
    s_mov_b32 s40, s8
    s_mov_b32 s41, s9
    s_mov_b32 s42, 819200
    s_mov_b32 s43, 0x20000
    s_lshr_b32 s53, s2, 3
    s_lshl_b32 s53, s53, 2
    s_add_u32 s53, s53, s45
    v_lshlrev_b32 v22, 7, v1
    s_mul_i32 s54, s53, 6400
    s_mov_b32 exec_hi, 0x3ffff
    buffer_load_dword v23, v22, s[40:43], s54 offen
    s_mov_b32 exec_hi, -1
    v_lshlrev_b32 v16, 5, v2
    v_add_u32 v16, 160000, v16
    ds_read_b128 v[104:107], v16
    ds_read_b128 v[108:111], v16 offset:16
    v_lshlrev_b32 v16, 2, v2
    v_add_u32 v16, 159872, v16
    s_waitcnt lgkmcnt(0)
    v_pk_add_f32 v[104:105], v[104:105], v[106:107]
    v_pk_add_f32 v[108:109], v[108:109], v[110:111]
    v_pk_add_f32 v[104:105], v[104:105], v[108:109]
    v_add_f32 v18, v104, v105
    v_max_f32 v18, 0xc2200000, v18
    v_mul_f32 v18, 0xbfb8aa3b, v18
    v_exp_f32 v18, v18
    v_accvgpr_read_b32 v120, a51
    v_accvgpr_read_b32 v121, a52
    v_accvgpr_read_b32 v122, a53
    ds_write_b32 v16, v18
    v_accvgpr_write_b32 a127, v18
    ds_read_b32 v120, v120
    ds_read_b32 v121, v121
    ds_read_b32 v122, v122
    s_waitcnt lgkmcnt(0)
    v_add_f32 v120, 1.0, v120
    v_add_f32 v121, 1.0, v121
    v_add_f32 v122, 1.0, v122
    v_rcp_f32 v120, v120
    v_rcp_f32 v121, v121
    v_rcp_f32 v122, v122
    s_mul_i32 s52, s56, 40960
    s_add_u32 s52, s52, 17825792
    s_mul_i32 s63, s45, 10240
    s_add_u32 s63, s63, s52
    s_add_u32 s64, s63, 5120
    s_and_b32 s66, s46, 7
    s_mul_i32 s52, s48, 3
    s_lshr_b32 s52, s52, 1
    s_add_u32 s66, s66, s52
    s_cmp_ge_u32 s66, 6
    s_cselect_b32 s52, 6, 0
    s_sub_u32 s66, s66, s52
    s_mul_i32 s65, s47, 24
    s_lshl_b32 s52, s47, 2
    s_add_u32 s52, s52, s48
    s_lshl_b32 s52, s52, 3
    s_lshl_b32 s53, s46, 7
    s_add_u32 s52, s52, s53
    s_add_u32 s52, s52, 11077632
    s_waitcnt vmcnt(1)
    v_mov_b32 v16, 159744
    v_mov_b32 v17, 1
    s_mov_b64 exec, 1
    ds_add_rtn_u32 v17, v16, v17
    s_mov_b64 exec, -1
    s_waitcnt lgkmcnt(0)
    v_readfirstlane_b32 s54, v17
    s_cmp_lg_u32 s54, 3
    s_cbranch_scc1 Lsg_1
    v_mov_b32 v16, s50
    v_mov_b32 v17, s51
    v_mov_b32 v18, 0
    s_mov_b64 exec, 1
    buffer_store_dwordx2 v[16:17], v18, s[36:39], s52 offen sc1
    s_mov_b64 exec, -1
    v_mov_b32 v16, s50
    v_mov_b32 v17, s51
    v_mov_b32 v18, 0
    s_mov_b64 exec, 1
    buffer_store_dwordx2 v[16:17], v18, s[36:39], s67 offen sc1
    s_mov_b64 exec, -1
Lsg_1:
    v_mov_b32 v16, 159744
Lw_2:
    ds_read_b32 v17, v16
    s_waitcnt lgkmcnt(0)
    v_readfirstlane_b32 s54, v17
    s_cmp_ge_u32 s54, 4
    s_cbranch_scc1 Lwd_3
    s_sleep 4
    s_branch Lw_2
Lwd_3:
    s_lshl_b32 s52, s46, 7
    s_add_u32 s52, s52, 11077632
    s_lshl_b32 s53, s47, 5
    s_add_u32 s53, s53, s52
    s_waitcnt lgkmcnt(0)
    s_cmp_lg_u32 s45, 0
    s_cbranch_scc1 Lgo_4
    v_lshlrev_b32 v20, 4, v1
    s_mov_b32 exec_lo, 0x3
    s_mov_b32 exec_hi, 0x0
    s_mov_b32 s49, 0x40000
Lp_6:
    buffer_load_dwordx4 v[16:19], v20, s[36:39], s53 offen sc1
    s_waitcnt vmcnt(0)
    v_cmp_ne_u64 vcc, s[50:51], v[16:17]
    v_cmp_ne_u64 s[68:69], s[50:51], v[18:19]
    s_sub_u32 s49, s49, 1
    s_cbranch_scc1 Lpd_7
    s_or_b64 vcc, vcc, s[68:69]
    s_cbranch_scc0 Lpd_7
    s_sleep 8
    s_branch Lp_6
Lpd_7:
    s_mov_b64 exec, -1
    v_mov_b32 v16, 159812
    v_mov_b32 v17, 1
    s_mov_b64 exec, 1
    ds_add_u32 v16, v17
    s_mov_b64 exec, -1
    s_branch Lgd_5
Lgo_4:
    v_mov_b32 v16, 159812
Lw_8:
    ds_read_b32 v17, v16
    s_waitcnt lgkmcnt(0)
    v_readfirstlane_b32 s54, v17
    s_cmp_ge_u32 s54, 1
    s_cbranch_scc1 Lwd_9
    s_sleep 4
    s_branch Lw_8
Lwd_9:
Lgd_5:
    s_setprio 0
    s_add_u32 s61, s66, s65
    s_lshl_b32 s55, s61, 10
    s_add_u32 s55, s55, s59
    s_mul_i32 s61, s61, 20480
    buffer_load_dwordx4 v[104:107], v4, s[36:39], s55 offen sc1
    s_add_u32 s66, s66, 1
    s_cmp_eq_u32 s66, 6
    s_cselect_b32 s66, 0, s66
    s_add_u32 m0, s58, 0
    s_add_u32 s61, s61, s60
    s_waitcnt vmcnt(4)
    buffer_load_dwordx4 v5, s[32:35], s61 offen lds
    s_add_u32 m0, s58, 1024
    s_waitcnt vmcnt(4)
    buffer_load_dwordx4 v6, s[32:35], s61 offen lds
    s_add_u32 m0, s58, 2048
    s_waitcnt vmcnt(4)
    buffer_load_dwordx4 v7, s[32:35], s61 offen lds
    s_add_u32 m0, s58, 3072
    s_waitcnt vmcnt(4)
    buffer_load_dwordx4 v8, s[32:35], s61 offen lds
    s_add_u32 m0, s58, 4096
    s_waitcnt vmcnt(4)
    buffer_load_dwordx4 v9, s[32:35], s61 offen lds
    s_add_u32 s61, s66, s65
    s_lshl_b32 s55, s61, 10
    s_add_u32 s55, s55, s59
    s_mul_i32 s61, s61, 20480
    buffer_load_dwordx4 v[108:111], v4, s[36:39], s55 offen sc1
    s_add_u32 s66, s66, 1
    s_cmp_eq_u32 s66, 6
    s_cselect_b32 s66, 0, s66
    s_add_u32 m0, s58, 5120
    s_add_u32 s61, s61, s60
    s_waitcnt vmcnt(4)
    buffer_load_dwordx4 v5, s[32:35], s61 offen lds
    s_add_u32 m0, s58, 6144
    s_waitcnt vmcnt(4)
    buffer_load_dwordx4 v6, s[32:35], s61 offen lds
    s_add_u32 m0, s58, 7168
    s_waitcnt vmcnt(4)
    buffer_load_dwordx4 v7, s[32:35], s61 offen lds
    s_add_u32 m0, s58, 8192
    s_waitcnt vmcnt(4)
    buffer_load_dwordx4 v8, s[32:35], s61 offen lds
    s_add_u32 m0, s58, 9216
    s_waitcnt vmcnt(4)
    buffer_load_dwordx4 v9, s[32:35], s61 offen lds
    s_add_u32 s61, s66, s65
    s_lshl_b32 s55, s61, 10
    s_add_u32 s55, s55, s59
    s_mul_i32 s61, s61, 20480
    buffer_load_dwordx4 v[112:115], v4, s[36:39], s55 offen sc1
    s_add_u32 s66, s66, 1
    s_cmp_eq_u32 s66, 6
    s_cselect_b32 s66, 0, s66
    s_add_u32 m0, s58, 10240
    s_add_u32 s61, s61, s60
    s_waitcnt vmcnt(4)
    buffer_load_dwordx4 v5, s[32:35], s61 offen lds
    s_add_u32 m0, s58, 11264
    s_waitcnt vmcnt(4)
    buffer_load_dwordx4 v6, s[32:35], s61 offen lds
    s_add_u32 m0, s58, 12288
    s_waitcnt vmcnt(4)
    buffer_load_dwordx4 v7, s[32:35], s61 offen lds
    s_add_u32 m0, s58, 13312
    s_waitcnt vmcnt(4)
    buffer_load_dwordx4 v8, s[32:35], s61 offen lds
    s_add_u32 m0, s58, 14336
    s_waitcnt vmcnt(4)
    buffer_load_dwordx4 v9, s[32:35], s61 offen lds
    s_waitcnt vmcnt(12)
    ds_read_b64_tr_b16 a[0:1], v15 offset:0
    ds_read_b64_tr_b16 a[2:3], v15 offset:2560
    ds_read_b64_tr_b16 a[4:5], v15 offset:64
    ds_read_b64_tr_b16 a[6:7], v15 offset:2624
    ds_read_b64_tr_b16 a[8:9], v15 offset:128
    ds_read_b64_tr_b16 a[10:11], v15 offset:2688
    ds_read_b64_tr_b16 a[12:13], v15 offset:192
    ds_read_b64_tr_b16 a[14:15], v15 offset:2752
    ds_read_b64_tr_b16 a[16:17], v15 offset:256
    ds_read_b64_tr_b16 a[18:19], v15 offset:2816
    s_waitcnt vmcnt(6) lgkmcnt(0)
    v_mfma_f32_32x32x16_bf16 v[24:39], a[0:3], v[104:107], 0
    ds_read_b64_tr_b16 a[20:21], v15 offset:5120
    ds_read_b64_tr_b16 a[22:23], v15 offset:7680
    ds_read_b64_tr_b16 a[24:25], v15 offset:5184
    ds_read_b64_tr_b16 a[26:27], v15 offset:7744
    v_mfma_f32_32x32x16_bf16 v[40:55], a[4:7], v[104:107], 0
    ds_read_b64_tr_b16 a[28:29], v15 offset:5248
    ds_read_b64_tr_b16 a[30:31], v15 offset:7808
    ds_read_b64_tr_b16 a[32:33], v15 offset:5312
    ds_read_b64_tr_b16 a[34:35], v15 offset:7872
    v_mfma_f32_32x32x16_bf16 v[56:71], a[8:11], v[104:107], 0
    ds_read_b64_tr_b16 a[36:37], v15 offset:5376
    ds_read_b64_tr_b16 a[38:39], v15 offset:7936
    s_add_u32 s61, s66, s65
    s_lshl_b32 s55, s61, 10
    s_add_u32 s55, s55, s59
    s_mul_i32 s61, s61, 20480
    buffer_load_dwordx4 v[116:119], v4, s[36:39], s55 offen sc1
    s_add_u32 s66, s66, 1
    s_cmp_eq_u32 s66, 6
    s_cselect_b32 s66, 0, s66
    s_add_u32 m0, s58, 15360
    s_add_u32 s61, s61, s60
    s_waitcnt vmcnt(4)
    buffer_load_dwordx4 v5, s[32:35], s61 offen lds
    v_mfma_f32_32x32x16_bf16 v[72:87], a[12:15], v[104:107], 0
    s_add_u32 m0, s58, 16384
    s_waitcnt vmcnt(4)
    buffer_load_dwordx4 v6, s[32:35], s61 offen lds
    s_add_u32 m0, s58, 17408
    s_waitcnt vmcnt(4)
    buffer_load_dwordx4 v7, s[32:35], s61 offen lds
    s_add_u32 m0, s58, 18432
    s_waitcnt vmcnt(4)
    buffer_load_dwordx4 v8, s[32:35], s61 offen lds
    s_add_u32 m0, s58, 19456
    s_waitcnt vmcnt(4)
    buffer_load_dwordx4 v9, s[32:35], s61 offen lds
    v_mfma_f32_32x32x16_bf16 v[88:103], a[16:19], v[104:107], 0
    s_mov_b64 exec, 0xff
    buffer_load_dwordx4 v[20:23], v4, s[36:39], s52 offen sc1
    s_mov_b64 exec, -1
    s_waitcnt vmcnt(6) lgkmcnt(0)
    v_mfma_f32_32x32x16_bf16 v[24:39], a[20:23], v[108:111], v[24:39]
    ds_read_b64_tr_b16 a[0:1], v15 offset:10240
    ds_read_b64_tr_b16 a[2:3], v15 offset:12800
    ds_read_b64_tr_b16 a[4:5], v15 offset:10304
    ds_read_b64_tr_b16 a[6:7], v15 offset:12864
    v_mfma_f32_32x32x16_bf16 v[40:55], a[24:27], v[108:111], v[40:55]
    ds_read_b64_tr_b16 a[8:9], v15 offset:10368
    ds_read_b64_tr_b16 a[10:11], v15 offset:12928
    ds_read_b64_tr_b16 a[12:13], v15 offset:10432
    ds_read_b64_tr_b16 a[14:15], v15 offset:12992
    v_mfma_f32_32x32x16_bf16 v[56:71], a[28:31], v[108:111], v[56:71]
    ds_read_b64_tr_b16 a[16:17], v15 offset:10496
    ds_read_b64_tr_b16 a[18:19], v15 offset:13056
    s_add_u32 s61, s66, s65
    s_lshl_b32 s55, s61, 10
    s_add_u32 s55, s55, s59
    s_mul_i32 s61, s61, 20480
    buffer_load_dwordx4 v[104:107], v4, s[36:39], s55 offen sc1
    s_add_u32 s66, s66, 1
    s_cmp_eq_u32 s66, 6
    s_cselect_b32 s66, 0, s66
    s_add_u32 m0, s58, 0
    s_add_u32 s61, s61, s60
    s_waitcnt vmcnt(4)
    buffer_load_dwordx4 v5, s[32:35], s61 offen lds
    v_mfma_f32_32x32x16_bf16 v[72:87], a[32:35], v[108:111], v[72:87]
    s_add_u32 m0, s58, 1024
    s_waitcnt vmcnt(4)
    buffer_load_dwordx4 v6, s[32:35], s61 offen lds
    s_add_u32 m0, s58, 2048
    s_waitcnt vmcnt(4)
    buffer_load_dwordx4 v7, s[32:35], s61 offen lds
    s_add_u32 m0, s58, 3072
    s_waitcnt vmcnt(4)
    buffer_load_dwordx4 v8, s[32:35], s61 offen lds
    s_add_u32 m0, s58, 4096
    s_waitcnt vmcnt(4)
    buffer_load_dwordx4 v9, s[32:35], s61 offen lds
    v_mfma_f32_32x32x16_bf16 v[88:103], a[36:39], v[108:111], v[88:103]
    s_waitcnt vmcnt(6) lgkmcnt(0)
    v_mfma_f32_32x32x16_bf16 v[24:39], a[0:3], v[112:115], v[24:39]
    ds_read_b64_tr_b16 a[20:21], v15 offset:15360
    ds_read_b64_tr_b16 a[22:23], v15 offset:17920
    ds_read_b64_tr_b16 a[24:25], v15 offset:15424
    ds_read_b64_tr_b16 a[26:27], v15 offset:17984
    v_mfma_f32_32x32x16_bf16 v[40:55], a[4:7], v[112:115], v[40:55]
    ds_read_b64_tr_b16 a[28:29], v15 offset:15488
    ds_read_b64_tr_b16 a[30:31], v15 offset:18048
    ds_read_b64_tr_b16 a[32:33], v15 offset:15552
    ds_read_b64_tr_b16 a[34:35], v15 offset:18112
    v_mfma_f32_32x32x16_bf16 v[56:71], a[8:11], v[112:115], v[56:71]
    ds_read_b64_tr_b16 a[36:37], v15 offset:15616
    ds_read_b64_tr_b16 a[38:39], v15 offset:18176
    s_add_u32 s61, s66, s65
    s_lshl_b32 s55, s61, 10
    s_add_u32 s55, s55, s59
    s_mul_i32 s61, s61, 20480
    buffer_load_dwordx4 v[108:111], v4, s[36:39], s55 offen sc1
    s_add_u32 s66, s66, 1
    s_cmp_eq_u32 s66, 6
    s_cselect_b32 s66, 0, s66
    s_add_u32 s65, s65, 24
    s_cmp_eq_u32 s65, 96
    s_cselect_b32 s65, 0, s65
    s_add_u32 m0, s58, 5120
    s_add_u32 s61, s61, s60
    s_waitcnt vmcnt(4)
    buffer_load_dwordx4 v5, s[32:35], s61 offen lds
    v_mfma_f32_32x32x16_bf16 v[72:87], a[12:15], v[112:115], v[72:87]
    s_add_u32 m0, s58, 6144
    s_waitcnt vmcnt(4)
    buffer_load_dwordx4 v6, s[32:35], s61 offen lds
    s_add_u32 m0, s58, 7168
    s_waitcnt vmcnt(4)
    buffer_load_dwordx4 v7, s[32:35], s61 offen lds
    s_add_u32 m0, s58, 8192
    s_waitcnt vmcnt(4)
    buffer_load_dwordx4 v8, s[32:35], s61 offen lds
    s_add_u32 m0, s58, 9216
    s_waitcnt vmcnt(4)
    buffer_load_dwordx4 v9, s[32:35], s61 offen lds
    v_mfma_f32_32x32x16_bf16 v[88:103], a[16:19], v[112:115], v[88:103]
    s_waitcnt vmcnt(6) lgkmcnt(0)
    s_setprio 2
    s_mov_b64 exec, 0xff
    v_cmp_ne_u64 vcc, s[50:51], v[20:21]
    v_cmp_ne_u64 s[68:69], s[50:51], v[22:23]
    s_mov_b64 exec, -1
    s_or_b64 vcc, vcc, s[68:69]
    s_cbranch_scc0 L_G_hall
    v_lshlrev_b32 v20, 4, v1
    s_mov_b32 exec_lo, 0xff
    s_mov_b32 exec_hi, 0x0
    s_mov_b32 s49, 0x40000
Lp_10:
    buffer_load_dwordx4 v[16:19], v20, s[36:39], s52 offen sc1
    s_waitcnt vmcnt(0)
    v_cmp_ne_u64 vcc, s[50:51], v[16:17]
    v_cmp_ne_u64 s[68:69], s[50:51], v[18:19]
    s_sub_u32 s49, s49, 1
    s_cbranch_scc1 Lpd_11
    s_or_b64 vcc, vcc, s[68:69]
    s_cbranch_scc0 Lpd_11
    s_sleep 16
    s_branch Lp_10
Lpd_11:
    s_mov_b64 exec, -1
L_G_hall:
    s_setprio 0
    v_mfma_f32_32x32x16_bf16 v[24:39], a[20:23], v[116:119], v[24:39]
    ds_read_b64_tr_b16 a[0:1], v15 offset:0
    ds_read_b64_tr_b16 a[2:3], v15 offset:2560
    ds_read_b64_tr_b16 a[4:5], v15 offset:64
    ds_read_b64_tr_b16 a[6:7], v15 offset:2624
    v_mfma_f32_32x32x16_bf16 v[40:55], a[24:27], v[116:119], v[40:55]
    ds_read_b64_tr_b16 a[8:9], v15 offset:128
    ds_read_b64_tr_b16 a[10:11], v15 offset:2688
    ds_read_b64_tr_b16 a[12:13], v15 offset:192
    ds_read_b64_tr_b16 a[14:15], v15 offset:2752
    v_mfma_f32_32x32x16_bf16 v[56:71], a[28:31], v[116:119], v[56:71]
    ds_read_b64_tr_b16 a[16:17], v15 offset:256
    ds_read_b64_tr_b16 a[18:19], v15 offset:2816
    s_add_u32 s61, s66, s65
    s_lshl_b32 s55, s61, 10
    s_add_u32 s55, s55, s59
    s_mul_i32 s61, s61, 20480
    buffer_load_dwordx4 v[112:115], v4, s[36:39], s55 offen sc1
    s_add_u32 s66, s66, 1
    s_cmp_eq_u32 s66, 6
    s_cselect_b32 s66, 0, s66
    s_add_u32 m0, s58, 10240
    s_add_u32 s61, s61, s60
    s_waitcnt vmcnt(4)
    buffer_load_dwordx4 v5, s[32:35], s61 offen lds
    v_mfma_f32_32x32x16_bf16 v[72:87], a[32:35], v[116:119], v[72:87]
    s_add_u32 m0, s58, 11264
    s_waitcnt vmcnt(4)
    buffer_load_dwordx4 v6, s[32:35], s61 offen lds
    s_add_u32 m0, s58, 12288
    s_waitcnt vmcnt(4)
    buffer_load_dwordx4 v7, s[32:35], s61 offen lds
    s_add_u32 m0, s58, 13312
    s_waitcnt vmcnt(4)
    buffer_load_dwordx4 v8, s[32:35], s61 offen lds
    s_add_u32 m0, s58, 14336
    s_waitcnt vmcnt(4)
    buffer_load_dwordx4 v9, s[32:35], s61 offen lds
    v_mfma_f32_32x32x16_bf16 v[88:103], a[36:39], v[116:119], v[88:103]
    s_waitcnt vmcnt(6) lgkmcnt(0)
    v_mfma_f32_32x32x16_bf16 v[24:39], a[0:3], v[104:107], v[24:39]
    ds_read_b64_tr_b16 a[20:21], v15 offset:5120
    ds_read_b64_tr_b16 a[22:23], v15 offset:7680
    ds_read_b64_tr_b16 a[24:25], v15 offset:5184
    ds_read_b64_tr_b16 a[26:27], v15 offset:7744
    v_mfma_f32_32x32x16_bf16 v[40:55], a[4:7], v[104:107], v[40:55]
    ds_read_b64_tr_b16 a[28:29], v15 offset:5248
    ds_read_b64_tr_b16 a[30:31], v15 offset:7808
    ds_read_b64_tr_b16 a[32:33], v15 offset:5312
    ds_read_b64_tr_b16 a[34:35], v15 offset:7872
    v_mfma_f32_32x32x16_bf16 v[56:71], a[8:11], v[104:107], v[56:71]
    ds_read_b64_tr_b16 a[36:37], v15 offset:5376
    ds_read_b64_tr_b16 a[38:39], v15 offset:7936
    s_add_u32 s61, s66, s65
    s_lshl_b32 s55, s61, 10
    s_add_u32 s55, s55, s59
    s_mul_i32 s61, s61, 20480
    buffer_load_dwordx4 v[116:119], v4, s[36:39], s55 offen sc1
    s_add_u32 s66, s66, 1
    s_cmp_eq_u32 s66, 6
    s_cselect_b32 s66, 0, s66
    s_add_u32 m0, s58, 15360
    s_add_u32 s61, s61, s60
    s_waitcnt vmcnt(4)
    buffer_load_dwordx4 v5, s[32:35], s61 offen lds
    v_mfma_f32_32x32x16_bf16 v[72:87], a[12:15], v[104:107], v[72:87]
    s_add_u32 m0, s58, 16384
    s_waitcnt vmcnt(4)
    buffer_load_dwordx4 v6, s[32:35], s61 offen lds
    s_add_u32 m0, s58, 17408
    s_waitcnt vmcnt(4)
    buffer_load_dwordx4 v7, s[32:35], s61 offen lds
    s_add_u32 m0, s58, 18432
    s_waitcnt vmcnt(4)
    buffer_load_dwordx4 v8, s[32:35], s61 offen lds
    s_add_u32 m0, s58, 19456
    s_waitcnt vmcnt(4)
    buffer_load_dwordx4 v9, s[32:35], s61 offen lds
    v_mfma_f32_32x32x16_bf16 v[88:103], a[16:19], v[104:107], v[88:103]
    s_waitcnt vmcnt(6) lgkmcnt(0)
    v_mfma_f32_32x32x16_bf16 v[24:39], a[20:23], v[108:111], v[24:39]
    ds_read_b64_tr_b16 a[0:1], v15 offset:10240
    ds_read_b64_tr_b16 a[2:3], v15 offset:12800
    ds_read_b64_tr_b16 a[4:5], v15 offset:10304
    ds_read_b64_tr_b16 a[6:7], v15 offset:12864
    v_mfma_f32_32x32x16_bf16 v[40:55], a[24:27], v[108:111], v[40:55]
    ds_read_b64_tr_b16 a[8:9], v15 offset:10368
    ds_read_b64_tr_b16 a[10:11], v15 offset:12928
    ds_read_b64_tr_b16 a[12:13], v15 offset:10432
    ds_read_b64_tr_b16 a[14:15], v15 offset:12992
    v_mfma_f32_32x32x16_bf16 v[56:71], a[28:31], v[108:111], v[56:71]
    ds_read_b64_tr_b16 a[16:17], v15 offset:10496
    ds_read_b64_tr_b16 a[18:19], v15 offset:13056
    s_add_u32 s61, s66, s65
    s_lshl_b32 s55, s61, 10
    s_add_u32 s55, s55, s59
    s_mul_i32 s61, s61, 20480
    buffer_load_dwordx4 v[104:107], v4, s[36:39], s55 offen sc1
    s_add_u32 s66, s66, 1
    s_cmp_eq_u32 s66, 6
    s_cselect_b32 s66, 0, s66
    s_add_u32 m0, s58, 0
    s_add_u32 s61, s61, s60
    s_waitcnt vmcnt(4)
    buffer_load_dwordx4 v5, s[32:35], s61 offen lds
    v_mfma_f32_32x32x16_bf16 v[72:87], a[32:35], v[108:111], v[72:87]
    s_add_u32 m0, s58, 1024
    s_waitcnt vmcnt(4)
    buffer_load_dwordx4 v6, s[32:35], s61 offen lds
    s_add_u32 m0, s58, 2048
    s_waitcnt vmcnt(4)
    buffer_load_dwordx4 v7, s[32:35], s61 offen lds
    s_add_u32 m0, s58, 3072
    s_waitcnt vmcnt(4)
    buffer_load_dwordx4 v8, s[32:35], s61 offen lds
    s_add_u32 m0, s58, 4096
    s_waitcnt vmcnt(4)
    buffer_load_dwordx4 v9, s[32:35], s61 offen lds
    v_mfma_f32_32x32x16_bf16 v[88:103], a[36:39], v[108:111], v[88:103]
    s_waitcnt vmcnt(6) lgkmcnt(0)
    v_mfma_f32_32x32x16_bf16 v[24:39], a[0:3], v[112:115], v[24:39]
    ds_read_b64_tr_b16 a[20:21], v15 offset:15360
    ds_read_b64_tr_b16 a[22:23], v15 offset:17920
    ds_read_b64_tr_b16 a[24:25], v15 offset:15424
    ds_read_b64_tr_b16 a[26:27], v15 offset:17984
    v_mfma_f32_32x32x16_bf16 v[40:55], a[4:7], v[112:115], v[40:55]
    ds_read_b64_tr_b16 a[28:29], v15 offset:15488
    ds_read_b64_tr_b16 a[30:31], v15 offset:18048
    ds_read_b64_tr_b16 a[32:33], v15 offset:15552
    ds_read_b64_tr_b16 a[34:35], v15 offset:18112
    v_mfma_f32_32x32x16_bf16 v[56:71], a[8:11], v[112:115], v[56:71]
    ds_read_b64_tr_b16 a[36:37], v15 offset:15616
    ds_read_b64_tr_b16 a[38:39], v15 offset:18176
    s_add_u32 m0, s58, 5120
    s_add_u32 s61, s57, 0
    s_waitcnt vmcnt(4)
    buffer_load_dwordx4 v5, s[40:43], s61 offen lds
    s_add_u32 m0, s58, 6144
    s_waitcnt vmcnt(4)
    buffer_load_dwordx4 v6, s[40:43], s61 offen lds
    v_mfma_f32_32x32x16_bf16 v[72:87], a[12:15], v[112:115], v[72:87]
    s_add_u32 m0, s58, 7168
    s_waitcnt vmcnt(4)
    buffer_load_dwordx4 v7, s[40:43], s61 offen lds
    s_add_u32 m0, s58, 8192
    s_waitcnt vmcnt(4)
    buffer_load_dwordx4 v8, s[40:43], s61 offen lds
    s_add_u32 m0, s58, 9216
    s_waitcnt vmcnt(4)
    buffer_load_dwordx4 v9, s[40:43], s61 offen lds
    v_mfma_f32_32x32x16_bf16 v[88:103], a[16:19], v[112:115], v[88:103]
    s_waitcnt vmcnt(5) lgkmcnt(0)
    v_mfma_f32_32x32x16_bf16 v[24:39], a[20:23], v[116:119], v[24:39]
    ds_read_b64_tr_b16 a[0:1], v15 offset:0
    ds_read_b64_tr_b16 a[2:3], v15 offset:2560
    ds_read_b64_tr_b16 a[4:5], v15 offset:64
    ds_read_b64_tr_b16 a[6:7], v15 offset:2624
    v_mfma_f32_32x32x16_bf16 v[40:55], a[24:27], v[116:119], v[40:55]
    ds_read_b64_tr_b16 a[8:9], v15 offset:128
    ds_read_b64_tr_b16 a[10:11], v15 offset:2688
    ds_read_b64_tr_b16 a[12:13], v15 offset:192
    ds_read_b64_tr_b16 a[14:15], v15 offset:2752
    v_mfma_f32_32x32x16_bf16 v[56:71], a[28:31], v[116:119], v[56:71]
    ds_read_b64_tr_b16 a[16:17], v15 offset:256
    ds_read_b64_tr_b16 a[18:19], v15 offset:2816
    s_add_u32 s61, s66, s65
    s_lshl_b32 s55, s61, 10
    s_add_u32 s55, s55, s59
    s_mul_i32 s61, s61, 20480
    buffer_load_dwordx4 v[112:115], v4, s[36:39], s55 offen sc1
    s_add_u32 s66, s66, 1
    s_cmp_eq_u32 s66, 6
    s_cselect_b32 s66, 0, s66
    s_add_u32 m0, s58, 10240
    s_add_u32 s61, s61, s60
    s_waitcnt vmcnt(4)
    buffer_load_dwordx4 v5, s[32:35], s61 offen lds
    v_mfma_f32_32x32x16_bf16 v[72:87], a[32:35], v[116:119], v[72:87]
    s_add_u32 m0, s58, 11264
    s_waitcnt vmcnt(4)
    buffer_load_dwordx4 v6, s[32:35], s61 offen lds
    s_add_u32 m0, s58, 12288
    s_waitcnt vmcnt(4)
    buffer_load_dwordx4 v7, s[32:35], s61 offen lds
    s_add_u32 m0, s58, 13312
    s_waitcnt vmcnt(4)
    buffer_load_dwordx4 v8, s[32:35], s61 offen lds
    s_add_u32 m0, s58, 14336
    s_waitcnt vmcnt(4)
    buffer_load_dwordx4 v9, s[32:35], s61 offen lds
    v_mfma_f32_32x32x16_bf16 v[88:103], a[36:39], v[116:119], v[88:103]
    s_waitcnt vmcnt(6) lgkmcnt(0)
    v_mfma_f32_32x32x16_bf16 v[24:39], a[0:3], v[104:107], v[24:39]
    ds_read_b64_tr_b16 a[40:41], v15 offset:5120
    ds_read_b64_tr_b16 a[42:43], v15 offset:7680
    ds_read_b64_tr_b16 a[44:45], v15 offset:5184
    ds_read_b64_tr_b16 a[46:47], v15 offset:7744
    v_mfma_f32_32x32x16_bf16 v[40:55], a[4:7], v[104:107], v[40:55]
    ds_read_b64_tr_b16 a[48:49], v15 offset:5248
    ds_read_b64_tr_b16 a[50:51], v15 offset:7808
    ds_read_b64_tr_b16 a[52:53], v15 offset:5312
    ds_read_b64_tr_b16 a[54:55], v15 offset:7872
    v_mfma_f32_32x32x16_bf16 v[56:71], a[8:11], v[104:107], v[56:71]
    ds_read_b64_tr_b16 a[56:57], v15 offset:5376
    ds_read_b64_tr_b16 a[58:59], v15 offset:7936
    s_add_u32 s61, s66, s65
    s_lshl_b32 s55, s61, 10
    s_add_u32 s55, s55, s59
    s_mul_i32 s61, s61, 20480
    buffer_load_dwordx4 v[116:119], v4, s[36:39], s55 offen sc1
    s_add_u32 s66, s66, 1
    s_cmp_eq_u32 s66, 6
    s_cselect_b32 s66, 0, s66
    s_add_u32 m0, s58, 15360
    s_add_u32 s61, s61, s60
    s_waitcnt vmcnt(4)
    buffer_load_dwordx4 v5, s[32:35], s61 offen lds
    v_mfma_f32_32x32x16_bf16 v[72:87], a[12:15], v[104:107], v[72:87]
    s_add_u32 m0, s58, 16384
    s_waitcnt vmcnt(4)
    buffer_load_dwordx4 v6, s[32:35], s61 offen lds
    s_add_u32 m0, s58, 17408
    s_waitcnt vmcnt(4)
    buffer_load_dwordx4 v7, s[32:35], s61 offen lds
    s_add_u32 m0, s58, 18432
    s_waitcnt vmcnt(4)
    buffer_load_dwordx4 v8, s[32:35], s61 offen lds
    s_add_u32 m0, s58, 19456
    s_waitcnt vmcnt(4)
    buffer_load_dwordx4 v9, s[32:35], s61 offen lds
    v_mfma_f32_32x32x16_bf16 v[88:103], a[16:19], v[104:107], v[88:103]
    s_waitcnt vmcnt(6) lgkmcnt(0)
    ds_read_b64_tr_b16 a[20:21], v15 offset:10240
    ds_read_b64_tr_b16 a[22:23], v15 offset:12800
    ds_read_b64_tr_b16 a[24:25], v15 offset:10304
    ds_read_b64_tr_b16 a[26:27], v15 offset:12864
    ds_read_b64_tr_b16 a[28:29], v15 offset:10368
    ds_read_b64_tr_b16 a[30:31], v15 offset:12928
    ds_read_b64_tr_b16 a[32:33], v15 offset:10432
    ds_read_b64_tr_b16 a[34:35], v15 offset:12992
    ds_read_b64_tr_b16 a[36:37], v15 offset:10496
    ds_read_b64_tr_b16 a[38:39], v15 offset:13056
    s_add_u32 m0, s58, 0
    s_add_u32 s61, s57, 25600
    s_waitcnt vmcnt(4)
    buffer_load_dwordx4 v5, s[40:43], s61 offen lds
    s_add_u32 m0, s58, 1024
    s_waitcnt vmcnt(4)
    buffer_load_dwordx4 v6, s[40:43], s61 offen lds
    s_add_u32 m0, s58, 2048
    s_waitcnt vmcnt(4)
    buffer_load_dwordx4 v7, s[40:43], s61 offen lds
    s_add_u32 m0, s58, 3072
    s_waitcnt vmcnt(4)
    buffer_load_dwordx4 v8, s[40:43], s61 offen lds
    s_add_u32 m0, s58, 4096
    s_waitcnt vmcnt(4)
    buffer_load_dwordx4 v9, s[40:43], s61 offen lds
    s_waitcnt vmcnt(5) lgkmcnt(0)
    v_mfma_f32_32x32x16_bf16 v[24:39], a[20:23], v[112:115], v[24:39]
    ds_read_b64_tr_b16 a[0:1], v15 offset:15360
    ds_read_b64_tr_b16 a[2:3], v15 offset:17920
    ds_read_b64_tr_b16 a[4:5], v15 offset:15424
    ds_read_b64_tr_b16 a[6:7], v15 offset:17984
    v_mfma_f32_32x32x16_bf16 v[40:55], a[24:27], v[112:115], v[40:55]
    ds_read_b64_tr_b16 a[8:9], v15 offset:15488
    ds_read_b64_tr_b16 a[10:11], v15 offset:18048
    ds_read_b64_tr_b16 a[12:13], v15 offset:15552
    ds_read_b64_tr_b16 a[14:15], v15 offset:18112
    v_mfma_f32_32x32x16_bf16 v[56:71], a[28:31], v[112:115], v[56:71]
    ds_read_b64_tr_b16 a[16:17], v15 offset:15616
    ds_read_b64_tr_b16 a[18:19], v15 offset:18176
    s_add_u32 s61, s66, s65
    s_lshl_b32 s55, s61, 10
    s_add_u32 s55, s55, s59
    s_mul_i32 s61, s61, 20480
    buffer_load_dwordx4 v[108:111], v4, s[36:39], s55 offen sc1
    s_add_u32 s66, s66, 1
    s_cmp_eq_u32 s66, 6
    s_cselect_b32 s66, 0, s66
    s_add_u32 s65, s65, 24
    s_cmp_eq_u32 s65, 96
    s_cselect_b32 s65, 0, s65
    s_add_u32 m0, s58, 5120
    s_add_u32 s61, s61, s60
    s_waitcnt vmcnt(4)
    buffer_load_dwordx4 v5, s[32:35], s61 offen lds
    v_mfma_f32_32x32x16_bf16 v[72:87], a[32:35], v[112:115], v[72:87]
    s_add_u32 m0, s58, 6144
    s_waitcnt vmcnt(4)
    buffer_load_dwordx4 v6, s[32:35], s61 offen lds
    s_add_u32 m0, s58, 7168
    s_waitcnt vmcnt(4)
    buffer_load_dwordx4 v7, s[32:35], s61 offen lds
    s_add_u32 m0, s58, 8192
    s_waitcnt vmcnt(4)
    buffer_load_dwordx4 v8, s[32:35], s61 offen lds
    s_add_u32 m0, s58, 9216
    s_waitcnt vmcnt(4)
    buffer_load_dwordx4 v9, s[32:35], s61 offen lds
    v_mfma_f32_32x32x16_bf16 v[88:103], a[36:39], v[112:115], v[88:103]
    s_waitcnt vmcnt(6) lgkmcnt(0)
    v_mfma_f32_32x32x16_bf16 v[24:39], a[0:3], v[116:119], v[24:39]
    ds_read_b64_tr_b16 a[60:61], v15 offset:0
    ds_read_b64_tr_b16 a[62:63], v15 offset:2560
    ds_read_b64_tr_b16 a[64:65], v15 offset:64
    ds_read_b64_tr_b16 a[66:67], v15 offset:2624
    v_mfma_f32_32x32x16_bf16 v[40:55], a[4:7], v[116:119], v[40:55]
    ds_read_b64_tr_b16 a[68:69], v15 offset:128
    ds_read_b64_tr_b16 a[70:71], v15 offset:2688
    ds_read_b64_tr_b16 a[72:73], v15 offset:192
    ds_read_b64_tr_b16 a[74:75], v15 offset:2752
    v_mfma_f32_32x32x16_bf16 v[56:71], a[8:11], v[116:119], v[56:71]
    ds_read_b64_tr_b16 a[76:77], v15 offset:256
    ds_read_b64_tr_b16 a[78:79], v15 offset:2816
    s_add_u32 s61, s66, s65
    s_lshl_b32 s55, s61, 10
    s_add_u32 s55, s55, s59
    s_mul_i32 s61, s61, 20480
    buffer_load_dwordx4 v[112:115], v4, s[36:39], s55 offen sc1
    s_add_u32 s66, s66, 1
    s_cmp_eq_u32 s66, 6
    s_cselect_b32 s66, 0, s66
    s_add_u32 m0, s58, 10240
    s_add_u32 s61, s61, s60
    s_waitcnt vmcnt(4)
    buffer_load_dwordx4 v5, s[32:35], s61 offen lds
    v_mfma_f32_32x32x16_bf16 v[72:87], a[12:15], v[116:119], v[72:87]
    s_add_u32 m0, s58, 11264
    s_waitcnt vmcnt(4)
    buffer_load_dwordx4 v6, s[32:35], s61 offen lds
    s_add_u32 m0, s58, 12288
    s_waitcnt vmcnt(4)
    buffer_load_dwordx4 v7, s[32:35], s61 offen lds
    s_add_u32 m0, s58, 13312
    s_waitcnt vmcnt(4)
    buffer_load_dwordx4 v8, s[32:35], s61 offen lds
    s_add_u32 m0, s58, 14336
    s_waitcnt vmcnt(4)
    buffer_load_dwordx4 v9, s[32:35], s61 offen lds
    v_mfma_f32_32x32x16_bf16 v[88:103], a[16:19], v[116:119], v[88:103]
    s_lshl_b32 s52, s62, 8
    s_lshl_b32 s53, s45, 6
    s_add_u32 s52, s52, s53
    s_add_u32 s52, s52, 11079680
    s_mov_b64 exec, 0xf
    buffer_load_dwordx4 v[20:23], v4, s[36:39], s52 offen sc1
    s_mov_b64 exec, -1
    s_waitcnt vmcnt(6) lgkmcnt(0)
    ds_read_b64_tr_b16 a[20:21], v15 offset:5120
    ds_read_b64_tr_b16 a[22:23], v15 offset:7680
    ds_read_b64_tr_b16 a[24:25], v15 offset:5184
    ds_read_b64_tr_b16 a[26:27], v15 offset:7744
    ds_read_b64_tr_b16 a[28:29], v15 offset:5248
    ds_read_b64_tr_b16 a[30:31], v15 offset:7808
    ds_read_b64_tr_b16 a[32:33], v15 offset:5312
    ds_read_b64_tr_b16 a[34:35], v15 offset:7872
    ds_read_b64_tr_b16 a[36:37], v15 offset:5376
    ds_read_b64_tr_b16 a[38:39], v15 offset:7936
    s_add_u32 m0, s58, 15360
    s_add_u32 s61, s57, 51200
    s_waitcnt vmcnt(4)
    buffer_load_dwordx4 v5, s[40:43], s61 offen lds
    s_add_u32 m0, s58, 16384
    s_waitcnt vmcnt(4)
    buffer_load_dwordx4 v6, s[40:43], s61 offen lds
    s_add_u32 m0, s58, 17408
    s_waitcnt vmcnt(4)
    buffer_load_dwordx4 v7, s[40:43], s61 offen lds
    s_add_u32 m0, s58, 18432
    s_waitcnt vmcnt(4)
    buffer_load_dwordx4 v8, s[40:43], s61 offen lds
    s_add_u32 m0, s58, 19456
    s_waitcnt vmcnt(4)
    buffer_load_dwordx4 v9, s[40:43], s61 offen lds
    s_waitcnt vmcnt(5) lgkmcnt(0)
    v_mfma_f32_32x32x16_bf16 v[24:39], a[20:23], v[108:111], v[24:39]
    ds_read_b64_tr_b16 a[0:1], v15 offset:10240
    ds_read_b64_tr_b16 a[2:3], v15 offset:12800
    ds_read_b64_tr_b16 a[4:5], v15 offset:10304
    ds_read_b64_tr_b16 a[6:7], v15 offset:12864
    v_mfma_f32_32x32x16_bf16 v[40:55], a[24:27], v[108:111], v[40:55]
    ds_read_b64_tr_b16 a[8:9], v15 offset:10368
    ds_read_b64_tr_b16 a[10:11], v15 offset:12928
    ds_read_b64_tr_b16 a[12:13], v15 offset:10432
    ds_read_b64_tr_b16 a[14:15], v15 offset:12992
    v_mfma_f32_32x32x16_bf16 v[56:71], a[28:31], v[108:111], v[56:71]
    ds_read_b64_tr_b16 a[16:17], v15 offset:10496
    ds_read_b64_tr_b16 a[18:19], v15 offset:13056
    s_add_u32 s61, s66, s65
    s_lshl_b32 s55, s61, 10
    s_add_u32 s55, s55, s59
    s_mul_i32 s61, s61, 20480
    buffer_load_dwordx4 v[104:107], v4, s[36:39], s55 offen sc1
    s_add_u32 s66, s66, 1
    s_cmp_eq_u32 s66, 6
    s_cselect_b32 s66, 0, s66
    s_add_u32 m0, s58, 0
    s_add_u32 s61, s61, s60
    s_waitcnt vmcnt(4)
    buffer_load_dwordx4 v5, s[32:35], s61 offen lds
    v_mfma_f32_32x32x16_bf16 v[72:87], a[32:35], v[108:111], v[72:87]
    s_add_u32 m0, s58, 1024
    s_waitcnt vmcnt(4)
    buffer_load_dwordx4 v6, s[32:35], s61 offen lds
    s_add_u32 m0, s58, 2048
    s_waitcnt vmcnt(4)
    buffer_load_dwordx4 v7, s[32:35], s61 offen lds
    s_add_u32 m0, s58, 3072
    s_waitcnt vmcnt(4)
    buffer_load_dwordx4 v8, s[32:35], s61 offen lds
    s_add_u32 m0, s58, 4096
    s_waitcnt vmcnt(4)
    buffer_load_dwordx4 v9, s[32:35], s61 offen lds
    v_mfma_f32_32x32x16_bf16 v[88:103], a[36:39], v[108:111], v[88:103]
    s_waitcnt vmcnt(6) lgkmcnt(0)
    v_mfma_f32_32x32x16_bf16 v[24:39], a[0:3], v[112:115], v[24:39]
    ds_read_b64_tr_b16 a[80:81], v15 offset:15360
    ds_read_b64_tr_b16 a[82:83], v15 offset:17920
    ds_read_b64_tr_b16 a[84:85], v15 offset:15424
    ds_read_b64_tr_b16 a[86:87], v15 offset:17984
    v_mfma_f32_32x32x16_bf16 v[40:55], a[4:7], v[112:115], v[40:55]
    ds_read_b64_tr_b16 a[88:89], v15 offset:15488
    ds_read_b64_tr_b16 a[90:91], v15 offset:18048
    ds_read_b64_tr_b16 a[92:93], v15 offset:15552
    ds_read_b64_tr_b16 a[94:95], v15 offset:18112
    v_mfma_f32_32x32x16_bf16 v[56:71], a[8:11], v[112:115], v[56:71]
    ds_read_b64_tr_b16 a[96:97], v15 offset:15616
    ds_read_b64_tr_b16 a[98:99], v15 offset:18176
    s_add_u32 s61, s66, s65
    s_lshl_b32 s55, s61, 10
    s_add_u32 s55, s55, s59
    s_mul_i32 s61, s61, 20480
    buffer_load_dwordx4 v[108:111], v4, s[36:39], s55 offen sc1
    s_add_u32 s66, s66, 1
    s_cmp_eq_u32 s66, 6
    s_cselect_b32 s66, 0, s66
    s_add_u32 m0, s58, 5120
    s_add_u32 s61, s61, s60
    s_waitcnt vmcnt(4)
    buffer_load_dwordx4 v5, s[32:35], s61 offen lds
    v_mfma_f32_32x32x16_bf16 v[72:87], a[12:15], v[112:115], v[72:87]
    s_add_u32 m0, s58, 6144
    s_waitcnt vmcnt(4)
    buffer_load_dwordx4 v6, s[32:35], s61 offen lds
    s_add_u32 m0, s58, 7168
    s_waitcnt vmcnt(4)
    buffer_load_dwordx4 v7, s[32:35], s61 offen lds
    s_add_u32 m0, s58, 8192
    s_waitcnt vmcnt(4)
    buffer_load_dwordx4 v8, s[32:35], s61 offen lds
    s_add_u32 m0, s58, 9216
    s_waitcnt vmcnt(4)
    buffer_load_dwordx4 v9, s[32:35], s61 offen lds
    v_mfma_f32_32x32x16_bf16 v[88:103], a[16:19], v[112:115], v[88:103]
    s_waitcnt vmcnt(6) lgkmcnt(0)
    ds_read_b64_tr_b16 a[20:21], v15 offset:0
    ds_read_b64_tr_b16 a[22:23], v15 offset:2560
    ds_read_b64_tr_b16 a[24:25], v15 offset:64
    ds_read_b64_tr_b16 a[26:27], v15 offset:2624
    ds_read_b64_tr_b16 a[28:29], v15 offset:128
    ds_read_b64_tr_b16 a[30:31], v15 offset:2688
    ds_read_b64_tr_b16 a[32:33], v15 offset:192
    ds_read_b64_tr_b16 a[34:35], v15 offset:2752
    ds_read_b64_tr_b16 a[36:37], v15 offset:256
    ds_read_b64_tr_b16 a[38:39], v15 offset:2816
    s_add_u32 m0, s58, 10240
    s_add_u32 s61, s57, 76800
    s_waitcnt vmcnt(4)
    buffer_load_dwordx4 v5, s[40:43], s61 offen lds
    s_add_u32 m0, s58, 11264
    s_waitcnt vmcnt(4)
    buffer_load_dwordx4 v6, s[40:43], s61 offen lds
    s_add_u32 m0, s58, 12288
    s_waitcnt vmcnt(4)
    buffer_load_dwordx4 v7, s[40:43], s61 offen lds
    s_add_u32 m0, s58, 13312
    s_waitcnt vmcnt(4)
    buffer_load_dwordx4 v8, s[40:43], s61 offen lds
    s_add_u32 m0, s58, 14336
    s_waitcnt vmcnt(4)
    buffer_load_dwordx4 v9, s[40:43], s61 offen lds
    s_waitcnt vmcnt(5) lgkmcnt(0)
    v_mfma_f32_32x32x16_bf16 v[24:39], a[20:23], v[104:107], v[24:39]
    ds_read_b64_tr_b16 a[0:1], v15 offset:5120
    ds_read_b64_tr_b16 a[2:3], v15 offset:7680
    ds_read_b64_tr_b16 a[4:5], v15 offset:5184
    ds_read_b64_tr_b16 a[6:7], v15 offset:7744
    v_mfma_f32_32x32x16_bf16 v[40:55], a[24:27], v[104:107], v[40:55]
    ds_read_b64_tr_b16 a[8:9], v15 offset:5248
    ds_read_b64_tr_b16 a[10:11], v15 offset:7808
    ds_read_b64_tr_b16 a[12:13], v15 offset:5312
    ds_read_b64_tr_b16 a[14:15], v15 offset:7872
    v_mfma_f32_32x32x16_bf16 v[56:71], a[28:31], v[104:107], v[56:71]
    ds_read_b64_tr_b16 a[16:17], v15 offset:5376
    ds_read_b64_tr_b16 a[18:19], v15 offset:7936
    s_add_u32 s61, s66, s65
    s_lshl_b32 s55, s61, 10
    s_add_u32 s55, s55, s59
    s_mul_i32 s61, s61, 20480
    buffer_load_dwordx4 v[116:119], v4, s[36:39], s55 offen sc1
    s_add_u32 s66, s66, 1
    s_cmp_eq_u32 s66, 6
    s_cselect_b32 s66, 0, s66
    s_add_u32 m0, s58, 15360
    s_add_u32 s61, s61, s60
    s_waitcnt vmcnt(4)
    buffer_load_dwordx4 v5, s[32:35], s61 offen lds
    v_mfma_f32_32x32x16_bf16 v[72:87], a[32:35], v[104:107], v[72:87]
    s_add_u32 m0, s58, 16384
    s_waitcnt vmcnt(4)
    buffer_load_dwordx4 v6, s[32:35], s61 offen lds
    s_add_u32 m0, s58, 17408
    s_waitcnt vmcnt(4)
    buffer_load_dwordx4 v7, s[32:35], s61 offen lds
    s_add_u32 m0, s58, 18432
    s_waitcnt vmcnt(4)
    buffer_load_dwordx4 v8, s[32:35], s61 offen lds
    s_add_u32 m0, s58, 19456
    s_waitcnt vmcnt(4)
    buffer_load_dwordx4 v9, s[32:35], s61 offen lds
    v_mfma_f32_32x32x16_bf16 v[88:103], a[36:39], v[104:107], v[88:103]
    s_waitcnt vmcnt(6) lgkmcnt(0)
    v_mfma_f32_32x32x16_bf16 v[24:39], a[0:3], v[108:111], v[24:39]
    ds_read_b64_tr_b16 a[100:101], v15 offset:10240
    ds_read_b64_tr_b16 a[102:103], v15 offset:12800
    ds_read_b64_tr_b16 a[104:105], v15 offset:10304
    ds_read_b64_tr_b16 a[106:107], v15 offset:12864
    v_mfma_f32_32x32x16_bf16 v[40:55], a[4:7], v[108:111], v[40:55]
    ds_read_b64_tr_b16 a[108:109], v15 offset:10368
    ds_read_b64_tr_b16 a[110:111], v15 offset:12928
    ds_read_b64_tr_b16 a[112:113], v15 offset:10432
    ds_read_b64_tr_b16 a[114:115], v15 offset:12992
    v_mfma_f32_32x32x16_bf16 v[56:71], a[8:11], v[108:111], v[56:71]
    ds_read_b64_tr_b16 a[116:117], v15 offset:10496
    ds_read_b64_tr_b16 a[118:119], v15 offset:13056
    s_add_u32 s61, s66, s65
    s_lshl_b32 s55, s61, 10
    s_add_u32 s55, s55, s59
    s_mul_i32 s61, s61, 20480
    buffer_load_dwordx4 v[104:107], v4, s[36:39], s55 offen sc1
    s_add_u32 s66, s66, 1
    s_cmp_eq_u32 s66, 6
    s_cselect_b32 s66, 0, s66
    s_add_u32 m0, s58, 0
    s_add_u32 s61, s61, s60
    s_waitcnt vmcnt(4)
    buffer_load_dwordx4 v5, s[32:35], s61 offen lds
    v_mfma_f32_32x32x16_bf16 v[72:87], a[12:15], v[108:111], v[72:87]
    s_add_u32 m0, s58, 1024
    s_waitcnt vmcnt(4)
    buffer_load_dwordx4 v6, s[32:35], s61 offen lds
    s_add_u32 m0, s58, 2048
    s_waitcnt vmcnt(4)
    buffer_load_dwordx4 v7, s[32:35], s61 offen lds
    s_add_u32 m0, s58, 3072
    s_waitcnt vmcnt(4)
    buffer_load_dwordx4 v8, s[32:35], s61 offen lds
    s_add_u32 m0, s58, 4096
    s_waitcnt vmcnt(4)
    buffer_load_dwordx4 v9, s[32:35], s61 offen lds
    v_mfma_f32_32x32x16_bf16 v[88:103], a[16:19], v[108:111], v[88:103]
    s_waitcnt vmcnt(6) lgkmcnt(0)
    ds_read_b64_tr_b16 a[20:21], v15 offset:15360
    ds_read_b64_tr_b16 a[22:23], v15 offset:17920
    ds_read_b64_tr_b16 a[24:25], v15 offset:15424
    ds_read_b64_tr_b16 a[26:27], v15 offset:17984
    ds_read_b64_tr_b16 a[28:29], v15 offset:15488
    ds_read_b64_tr_b16 a[30:31], v15 offset:18048
    ds_read_b64_tr_b16 a[32:33], v15 offset:15552
    ds_read_b64_tr_b16 a[34:35], v15 offset:18112
    ds_read_b64_tr_b16 a[36:37], v15 offset:15616
    ds_read_b64_tr_b16 a[38:39], v15 offset:18176
    s_add_u32 s61, s66, s65
    s_lshl_b32 s55, s61, 10
    s_add_u32 s55, s55, s59
    s_mul_i32 s61, s61, 20480
    buffer_load_dwordx4 v[108:111], v4, s[36:39], s55 offen sc1
    s_add_u32 s66, s66, 1
    s_cmp_eq_u32 s66, 6
    s_cselect_b32 s66, 0, s66
    s_add_u32 s65, s65, 24
    s_cmp_eq_u32 s65, 96
    s_cselect_b32 s65, 0, s65
    s_add_u32 m0, s58, 5120
    s_add_u32 s61, s61, s60
    s_waitcnt vmcnt(4)
    buffer_load_dwordx4 v5, s[32:35], s61 offen lds
    s_add_u32 m0, s58, 6144
    s_waitcnt vmcnt(4)
    buffer_load_dwordx4 v6, s[32:35], s61 offen lds
    s_add_u32 m0, s58, 7168
    s_waitcnt vmcnt(4)
    buffer_load_dwordx4 v7, s[32:35], s61 offen lds
    s_add_u32 m0, s58, 8192
    s_waitcnt vmcnt(4)
    buffer_load_dwordx4 v8, s[32:35], s61 offen lds
    s_add_u32 m0, s58, 9216
    s_waitcnt vmcnt(4)
    buffer_load_dwordx4 v9, s[32:35], s61 offen lds
    s_waitcnt vmcnt(6) lgkmcnt(0)
    v_mfma_f32_32x32x16_bf16 v[24:39], a[20:23], v[116:119], v[24:39]
    ds_read_b64_tr_b16 a[0:1], v15 offset:0
    ds_read_b64_tr_b16 a[2:3], v15 offset:2560
    ds_read_b64_tr_b16 a[4:5], v15 offset:64
    ds_read_b64_tr_b16 a[6:7], v15 offset:2624
    v_mfma_f32_32x32x16_bf16 v[40:55], a[24:27], v[116:119], v[40:55]
    ds_read_b64_tr_b16 a[8:9], v15 offset:128
    ds_read_b64_tr_b16 a[10:11], v15 offset:2688
    ds_read_b64_tr_b16 a[12:13], v15 offset:192
    ds_read_b64_tr_b16 a[14:15], v15 offset:2752
    v_mfma_f32_32x32x16_bf16 v[56:71], a[28:31], v[116:119], v[56:71]
    ds_read_b64_tr_b16 a[16:17], v15 offset:256
    ds_read_b64_tr_b16 a[18:19], v15 offset:2816
    s_add_u32 s61, s66, s65
    s_lshl_b32 s55, s61, 10
    s_add_u32 s55, s55, s59
    s_mul_i32 s61, s61, 20480
    buffer_load_dwordx4 v[112:115], v4, s[36:39], s55 offen sc1
    s_add_u32 s66, s66, 1
    s_cmp_eq_u32 s66, 6
    s_cselect_b32 s66, 0, s66
    s_add_u32 m0, s58, 10240
    s_add_u32 s61, s61, s60
    s_waitcnt vmcnt(4)
    buffer_load_dwordx4 v5, s[32:35], s61 offen lds
    v_mfma_f32_32x32x16_bf16 v[72:87], a[32:35], v[116:119], v[72:87]
    s_add_u32 m0, s58, 11264
    s_waitcnt vmcnt(4)
    buffer_load_dwordx4 v6, s[32:35], s61 offen lds
    s_add_u32 m0, s58, 12288
    s_waitcnt vmcnt(4)
    buffer_load_dwordx4 v7, s[32:35], s61 offen lds
    s_add_u32 m0, s58, 13312
    s_waitcnt vmcnt(4)
    buffer_load_dwordx4 v8, s[32:35], s61 offen lds
    s_add_u32 m0, s58, 14336
    s_waitcnt vmcnt(4)
    buffer_load_dwordx4 v9, s[32:35], s61 offen lds
    v_mfma_f32_32x32x16_bf16 v[88:103], a[36:39], v[116:119], v[88:103]
    s_waitcnt vmcnt(6) lgkmcnt(0)
    v_mfma_f32_32x32x16_bf16 v[24:39], a[0:3], v[104:107], v[24:39]
    ds_read_b64_tr_b16 a[20:21], v15 offset:5120
    ds_read_b64_tr_b16 a[22:23], v15 offset:7680
    ds_read_b64_tr_b16 a[24:25], v15 offset:5184
    ds_read_b64_tr_b16 a[26:27], v15 offset:7744
    v_mfma_f32_32x32x16_bf16 v[40:55], a[4:7], v[104:107], v[40:55]
    ds_read_b64_tr_b16 a[28:29], v15 offset:5248
    ds_read_b64_tr_b16 a[30:31], v15 offset:7808
    ds_read_b64_tr_b16 a[32:33], v15 offset:5312
    ds_read_b64_tr_b16 a[34:35], v15 offset:7872
    v_mfma_f32_32x32x16_bf16 v[56:71], a[8:11], v[104:107], v[56:71]
    ds_read_b64_tr_b16 a[36:37], v15 offset:5376
    ds_read_b64_tr_b16 a[38:39], v15 offset:7936
    s_add_u32 s61, s66, s65
    s_lshl_b32 s55, s61, 10
    s_add_u32 s55, s55, s59
    s_mul_i32 s61, s61, 20480
    buffer_load_dwordx4 v[116:119], v4, s[36:39], s55 offen sc1
    s_add_u32 s66, s66, 1
    s_cmp_eq_u32 s66, 6
    s_cselect_b32 s66, 0, s66
    s_add_u32 m0, s58, 15360
    s_add_u32 s61, s61, s60
    s_waitcnt vmcnt(63)
    buffer_load_dwordx4 v5, s[32:35], s61 offen lds
    v_mfma_f32_32x32x16_bf16 v[72:87], a[12:15], v[104:107], v[72:87]
    s_add_u32 m0, s58, 16384
    s_waitcnt vmcnt(63)
    buffer_load_dwordx4 v6, s[32:35], s61 offen lds
    s_add_u32 m0, s58, 17408
    s_waitcnt vmcnt(63)
    buffer_load_dwordx4 v7, s[32:35], s61 offen lds
    s_add_u32 m0, s58, 18432
    s_waitcnt vmcnt(63)
    buffer_load_dwordx4 v8, s[32:35], s61 offen lds
    s_add_u32 m0, s58, 19456
    s_waitcnt vmcnt(63)
    buffer_load_dwordx4 v9, s[32:35], s61 offen lds
    v_mfma_f32_32x32x16_bf16 v[88:103], a[16:19], v[104:107], v[88:103]
    s_waitcnt vmcnt(6) lgkmcnt(0)
    v_mfma_f32_32x32x16_bf16 v[24:39], a[20:23], v[108:111], v[24:39]
    ds_read_b64_tr_b16 a[0:1], v15 offset:10240
    ds_read_b64_tr_b16 a[2:3], v15 offset:12800
    ds_read_b64_tr_b16 a[4:5], v15 offset:10304
    ds_read_b64_tr_b16 a[6:7], v15 offset:12864
    v_mfma_f32_32x32x16_bf16 v[40:55], a[24:27], v[108:111], v[40:55]
    ds_read_b64_tr_b16 a[8:9], v15 offset:10368
    ds_read_b64_tr_b16 a[10:11], v15 offset:12928
    ds_read_b64_tr_b16 a[12:13], v15 offset:10432
    ds_read_b64_tr_b16 a[14:15], v15 offset:12992
    v_mfma_f32_32x32x16_bf16 v[56:71], a[28:31], v[108:111], v[56:71]
    ds_read_b64_tr_b16 a[16:17], v15 offset:10496
    ds_read_b64_tr_b16 a[18:19], v15 offset:13056
    s_add_u32 s61, s66, s65
    s_lshl_b32 s55, s61, 10
    s_add_u32 s55, s55, s59
    s_mul_i32 s61, s61, 20480
    buffer_load_dwordx4 v[104:107], v4, s[36:39], s55 offen sc1
    s_add_u32 s66, s66, 1
    s_cmp_eq_u32 s66, 6
    s_cselect_b32 s66, 0, s66
    s_add_u32 m0, s58, 0
    s_add_u32 s61, s61, s60
    s_waitcnt vmcnt(63)
    buffer_load_dwordx4 v5, s[32:35], s61 offen lds
    v_mfma_f32_32x32x16_bf16 v[72:87], a[32:35], v[108:111], v[72:87]
    s_add_u32 m0, s58, 1024
    s_waitcnt vmcnt(63)
    buffer_load_dwordx4 v6, s[32:35], s61 offen lds
    s_add_u32 m0, s58, 2048
    s_waitcnt vmcnt(63)
    buffer_load_dwordx4 v7, s[32:35], s61 offen lds
    s_add_u32 m0, s58, 3072
    s_waitcnt vmcnt(63)
    buffer_load_dwordx4 v8, s[32:35], s61 offen lds
    s_add_u32 m0, s58, 4096
    s_waitcnt vmcnt(63)
    buffer_load_dwordx4 v9, s[32:35], s61 offen lds
    v_mfma_f32_32x32x16_bf16 v[88:103], a[36:39], v[108:111], v[88:103]
    s_waitcnt vmcnt(6) lgkmcnt(0)
    v_mfma_f32_32x32x16_bf16 v[24:39], a[0:3], v[112:115], v[24:39]
    ds_read_b64_tr_b16 a[20:21], v15 offset:15360
    ds_read_b64_tr_b16 a[22:23], v15 offset:17920
    ds_read_b64_tr_b16 a[24:25], v15 offset:15424
    ds_read_b64_tr_b16 a[26:27], v15 offset:17984
    v_mfma_f32_32x32x16_bf16 v[40:55], a[4:7], v[112:115], v[40:55]
    ds_read_b64_tr_b16 a[28:29], v15 offset:15488
    ds_read_b64_tr_b16 a[30:31], v15 offset:18048
    ds_read_b64_tr_b16 a[32:33], v15 offset:15552
    ds_read_b64_tr_b16 a[34:35], v15 offset:18112
    v_mfma_f32_32x32x16_bf16 v[56:71], a[8:11], v[112:115], v[56:71]
    ds_read_b64_tr_b16 a[36:37], v15 offset:15616
    ds_read_b64_tr_b16 a[38:39], v15 offset:18176
    s_add_u32 s61, s66, s65
    s_lshl_b32 s55, s61, 10
    s_add_u32 s55, s55, s59
    s_mul_i32 s61, s61, 20480
    buffer_load_dwordx4 v[108:111], v4, s[36:39], s55 offen sc1
    s_add_u32 s66, s66, 1
    s_cmp_eq_u32 s66, 6
    s_cselect_b32 s66, 0, s66
    s_add_u32 m0, s58, 5120
    s_add_u32 s61, s61, s60
    s_waitcnt vmcnt(63)
    buffer_load_dwordx4 v5, s[32:35], s61 offen lds
    v_mfma_f32_32x32x16_bf16 v[72:87], a[12:15], v[112:115], v[72:87]
    s_add_u32 m0, s58, 6144
    s_waitcnt vmcnt(63)
    buffer_load_dwordx4 v6, s[32:35], s61 offen lds
    s_add_u32 m0, s58, 7168
    s_waitcnt vmcnt(63)
    buffer_load_dwordx4 v7, s[32:35], s61 offen lds
    s_add_u32 m0, s58, 8192
    s_waitcnt vmcnt(63)
    buffer_load_dwordx4 v8, s[32:35], s61 offen lds
    s_add_u32 m0, s58, 9216
    s_waitcnt vmcnt(63)
    buffer_load_dwordx4 v9, s[32:35], s61 offen lds
    v_mfma_f32_32x32x16_bf16 v[88:103], a[16:19], v[112:115], v[88:103]
    s_waitcnt vmcnt(6) lgkmcnt(0)
    v_mfma_f32_32x32x16_bf16 v[24:39], a[20:23], v[116:119], v[24:39]
    ds_read_b64_tr_b16 a[0:1], v15 offset:0
    ds_read_b64_tr_b16 a[2:3], v15 offset:2560
    ds_read_b64_tr_b16 a[4:5], v15 offset:64
    ds_read_b64_tr_b16 a[6:7], v15 offset:2624
    v_mfma_f32_32x32x16_bf16 v[40:55], a[24:27], v[116:119], v[40:55]
    ds_read_b64_tr_b16 a[8:9], v15 offset:128
    ds_read_b64_tr_b16 a[10:11], v15 offset:2688
    ds_read_b64_tr_b16 a[12:13], v15 offset:192
    ds_read_b64_tr_b16 a[14:15], v15 offset:2752
    v_mfma_f32_32x32x16_bf16 v[56:71], a[28:31], v[116:119], v[56:71]
    ds_read_b64_tr_b16 a[16:17], v15 offset:256
    ds_read_b64_tr_b16 a[18:19], v15 offset:2816
    s_add_u32 s61, s66, s65
    s_lshl_b32 s55, s61, 10
    s_add_u32 s55, s55, s59
    s_mul_i32 s61, s61, 20480
    buffer_load_dwordx4 v[112:115], v4, s[36:39], s55 offen sc1
    s_add_u32 s66, s66, 1
    s_cmp_eq_u32 s66, 6
    s_cselect_b32 s66, 0, s66
    s_add_u32 m0, s58, 10240
    s_add_u32 s61, s61, s60
    s_waitcnt vmcnt(63)
    buffer_load_dwordx4 v5, s[32:35], s61 offen lds
    v_mfma_f32_32x32x16_bf16 v[72:87], a[32:35], v[116:119], v[72:87]
    s_add_u32 m0, s58, 11264
    s_waitcnt vmcnt(63)
    buffer_load_dwordx4 v6, s[32:35], s61 offen lds
    s_add_u32 m0, s58, 12288
    s_waitcnt vmcnt(63)
    buffer_load_dwordx4 v7, s[32:35], s61 offen lds
    s_add_u32 m0, s58, 13312
    s_waitcnt vmcnt(63)
    buffer_load_dwordx4 v8, s[32:35], s61 offen lds
    s_add_u32 m0, s58, 14336
    s_waitcnt vmcnt(63)
    buffer_load_dwordx4 v9, s[32:35], s61 offen lds
    v_mfma_f32_32x32x16_bf16 v[88:103], a[36:39], v[116:119], v[88:103]
    s_waitcnt vmcnt(6) lgkmcnt(0)
    v_mfma_f32_32x32x16_bf16 v[24:39], a[0:3], v[104:107], v[24:39]
    ds_read_b64_tr_b16 a[20:21], v15 offset:5120
    ds_read_b64_tr_b16 a[22:23], v15 offset:7680
    ds_read_b64_tr_b16 a[24:25], v15 offset:5184
    ds_read_b64_tr_b16 a[26:27], v15 offset:7744
    v_mfma_f32_32x32x16_bf16 v[40:55], a[4:7], v[104:107], v[40:55]
    ds_read_b64_tr_b16 a[28:29], v15 offset:5248
    ds_read_b64_tr_b16 a[30:31], v15 offset:7808
    ds_read_b64_tr_b16 a[32:33], v15 offset:5312
    ds_read_b64_tr_b16 a[34:35], v15 offset:7872
    v_mfma_f32_32x32x16_bf16 v[56:71], a[8:11], v[104:107], v[56:71]
    ds_read_b64_tr_b16 a[36:37], v15 offset:5376
    ds_read_b64_tr_b16 a[38:39], v15 offset:7936
    s_add_u32 s61, s66, s65
    s_lshl_b32 s55, s61, 10
    s_add_u32 s55, s55, s59
    s_mul_i32 s61, s61, 20480
    buffer_load_dwordx4 v[116:119], v4, s[36:39], s55 offen sc1
    s_add_u32 s66, s66, 1
    s_cmp_eq_u32 s66, 6
    s_cselect_b32 s66, 0, s66
    s_add_u32 s65, s65, 24
    s_cmp_eq_u32 s65, 96
    s_cselect_b32 s65, 0, s65
    s_add_u32 m0, s58, 15360
    s_add_u32 s61, s61, s60
    s_waitcnt vmcnt(63)
    buffer_load_dwordx4 v5, s[32:35], s61 offen lds
    v_mfma_f32_32x32x16_bf16 v[72:87], a[12:15], v[104:107], v[72:87]
    s_add_u32 m0, s58, 16384
    s_waitcnt vmcnt(63)
    buffer_load_dwordx4 v6, s[32:35], s61 offen lds
    s_add_u32 m0, s58, 17408
    s_waitcnt vmcnt(63)
    buffer_load_dwordx4 v7, s[32:35], s61 offen lds
    s_add_u32 m0, s58, 18432
    s_waitcnt vmcnt(63)
    buffer_load_dwordx4 v8, s[32:35], s61 offen lds
    s_add_u32 m0, s58, 19456
    s_waitcnt vmcnt(63)
    buffer_load_dwordx4 v9, s[32:35], s61 offen lds
    v_mfma_f32_32x32x16_bf16 v[88:103], a[16:19], v[104:107], v[88:103]
    s_waitcnt vmcnt(6) lgkmcnt(0)
    v_mfma_f32_32x32x16_bf16 v[24:39], a[20:23], v[108:111], v[24:39]
    ds_read_b64_tr_b16 a[0:1], v15 offset:10240
    ds_read_b64_tr_b16 a[2:3], v15 offset:12800
    ds_read_b64_tr_b16 a[4:5], v15 offset:10304
    ds_read_b64_tr_b16 a[6:7], v15 offset:12864
    v_mfma_f32_32x32x16_bf16 v[40:55], a[24:27], v[108:111], v[40:55]
    ds_read_b64_tr_b16 a[8:9], v15 offset:10368
    ds_read_b64_tr_b16 a[10:11], v15 offset:12928
    ds_read_b64_tr_b16 a[12:13], v15 offset:10432
    ds_read_b64_tr_b16 a[14:15], v15 offset:12992
    v_mfma_f32_32x32x16_bf16 v[56:71], a[28:31], v[108:111], v[56:71]
    ds_read_b64_tr_b16 a[16:17], v15 offset:10496
    ds_read_b64_tr_b16 a[18:19], v15 offset:13056
    s_add_u32 m0, s58, 0
    s_add_u32 s61, s57, 102400
    s_waitcnt vmcnt(63)
    buffer_load_dwordx4 v5, s[40:43], s61 offen lds
    s_add_u32 m0, s58, 1024
    s_waitcnt vmcnt(63)
    buffer_load_dwordx4 v6, s[40:43], s61 offen lds
    v_mfma_f32_32x32x16_bf16 v[72:87], a[32:35], v[108:111], v[72:87]
    s_add_u32 m0, s58, 2048
    s_waitcnt vmcnt(63)
    buffer_load_dwordx4 v7, s[40:43], s61 offen lds
    s_add_u32 m0, s58, 3072
    s_waitcnt vmcnt(63)
    buffer_load_dwordx4 v8, s[40:43], s61 offen lds
    s_add_u32 m0, s58, 4096
    s_waitcnt vmcnt(63)
    buffer_load_dwordx4 v9, s[40:43], s61 offen lds
    v_mfma_f32_32x32x16_bf16 v[88:103], a[36:39], v[108:111], v[88:103]
    s_waitcnt vmcnt(5) lgkmcnt(0)
    v_mfma_f32_32x32x16_bf16 v[24:39], a[0:3], v[112:115], v[24:39]
    ds_read_b64_tr_b16 a[20:21], v15 offset:15360
    ds_read_b64_tr_b16 a[22:23], v15 offset:17920
    ds_read_b64_tr_b16 a[24:25], v15 offset:15424
    ds_read_b64_tr_b16 a[26:27], v15 offset:17984
    v_mfma_f32_32x32x16_bf16 v[40:55], a[4:7], v[112:115], v[40:55]
    ds_read_b64_tr_b16 a[28:29], v15 offset:15488
    ds_read_b64_tr_b16 a[30:31], v15 offset:18048
    ds_read_b64_tr_b16 a[32:33], v15 offset:15552
    ds_read_b64_tr_b16 a[34:35], v15 offset:18112
    v_mfma_f32_32x32x16_bf16 v[56:71], a[8:11], v[112:115], v[56:71]
    ds_read_b64_tr_b16 a[36:37], v15 offset:15616
    ds_read_b64_tr_b16 a[38:39], v15 offset:18176
    s_add_u32 m0, s58, 5120
    s_add_u32 s61, s57, 128000
    s_waitcnt vmcnt(63)
    buffer_load_dwordx4 v5, s[40:43], s61 offen lds
    s_add_u32 m0, s58, 6144
    s_waitcnt vmcnt(63)
    buffer_load_dwordx4 v6, s[40:43], s61 offen lds
    v_mfma_f32_32x32x16_bf16 v[72:87], a[12:15], v[112:115], v[72:87]
    s_add_u32 m0, s58, 7168
    s_waitcnt vmcnt(63)
    buffer_load_dwordx4 v7, s[40:43], s61 offen lds
    s_add_u32 m0, s58, 8192
    s_waitcnt vmcnt(63)
    buffer_load_dwordx4 v8, s[40:43], s61 offen lds
    s_add_u32 m0, s58, 9216
    s_waitcnt vmcnt(63)
    buffer_load_dwordx4 v9, s[40:43], s61 offen lds
    v_mfma_f32_32x32x16_bf16 v[88:103], a[16:19], v[112:115], v[88:103]
    s_waitcnt vmcnt(5) lgkmcnt(0)
    v_mfma_f32_32x32x16_bf16 v[24:39], a[20:23], v[116:119], v[24:39]
    ds_read_b64_tr_b16 a[0:1], v15 offset:0
    ds_read_b64_tr_b16 a[2:3], v15 offset:2560
    ds_read_b64_tr_b16 a[4:5], v15 offset:64
    ds_read_b64_tr_b16 a[6:7], v15 offset:2624
    v_mfma_f32_32x32x16_bf16 v[40:55], a[24:27], v[116:119], v[40:55]
    ds_read_b64_tr_b16 a[8:9], v15 offset:128
    ds_read_b64_tr_b16 a[10:11], v15 offset:2688
    ds_read_b64_tr_b16 a[12:13], v15 offset:192
    ds_read_b64_tr_b16 a[14:15], v15 offset:2752
    v_mfma_f32_32x32x16_bf16 v[56:71], a[28:31], v[116:119], v[56:71]
    ds_read_b64_tr_b16 a[16:17], v15 offset:256
    ds_read_b64_tr_b16 a[18:19], v15 offset:2816
    s_add_u32 m0, s58, 10240
    s_add_u32 s61, s57, 153600
    s_waitcnt vmcnt(63)
    buffer_load_dwordx4 v5, s[40:43], s61 offen lds
    s_add_u32 m0, s58, 11264
    s_waitcnt vmcnt(63)
    buffer_load_dwordx4 v6, s[40:43], s61 offen lds
    v_mfma_f32_32x32x16_bf16 v[72:87], a[32:35], v[116:119], v[72:87]
    s_add_u32 m0, s58, 12288
    s_waitcnt vmcnt(63)
    buffer_load_dwordx4 v7, s[40:43], s61 offen lds
    s_add_u32 m0, s58, 13312
    s_waitcnt vmcnt(63)
    buffer_load_dwordx4 v8, s[40:43], s61 offen lds
    s_add_u32 m0, s58, 14336
    s_waitcnt vmcnt(63)
    buffer_load_dwordx4 v9, s[40:43], s61 offen lds
    v_mfma_f32_32x32x16_bf16 v[88:103], a[36:39], v[116:119], v[88:103]
    s_setprio 2
    s_add_u32 m0, s58, 15360
    s_add_u32 s61, s57, 179200
    s_waitcnt vmcnt(63)
    buffer_load_dwordx4 v5, s[40:43], s61 offen lds
    s_add_u32 m0, s58, 16384
    s_waitcnt vmcnt(63)
    buffer_load_dwordx4 v6, s[40:43], s61 offen lds
    s_add_u32 m0, s58, 17408
    s_waitcnt vmcnt(63)
    buffer_load_dwordx4 v7, s[40:43], s61 offen lds
    s_add_u32 m0, s58, 18432
    s_waitcnt vmcnt(63)
    buffer_load_dwordx4 v8, s[40:43], s61 offen lds
    s_add_u32 m0, s58, 19456
    s_waitcnt vmcnt(63)
    buffer_load_dwordx4 v9, s[40:43], s61 offen lds
    s_waitcnt vmcnt(10) lgkmcnt(0)
    ds_read_b64_tr_b16 a[20:21], v15 offset:5120
    ds_read_b64_tr_b16 a[22:23], v15 offset:7680
    ds_read_b64_tr_b16 a[24:25], v15 offset:5184
    ds_read_b64_tr_b16 a[26:27], v15 offset:7744
    ds_read_b64_tr_b16 a[28:29], v15 offset:5248
    ds_read_b64_tr_b16 a[30:31], v15 offset:7808
    ds_read_b64_tr_b16 a[32:33], v15 offset:5312
    ds_read_b64_tr_b16 a[34:35], v15 offset:7872
    ds_read_b64_tr_b16 a[36:37], v15 offset:5376
    ds_read_b64_tr_b16 a[38:39], v15 offset:7936
    s_add_u32 m0, s58, 0
    s_add_u32 s61, s57, 20480
    s_waitcnt vmcnt(63)
    buffer_load_dwordx4 v10, s[40:43], s61 offen lds
    s_add_u32 m0, s58, 1024
    s_waitcnt vmcnt(63)
    buffer_load_dwordx4 v11, s[40:43], s61 offen lds
    s_add_u32 m0, s58, 2048
    s_waitcnt vmcnt(63)
    buffer_load_dwordx4 v12, s[40:43], s61 offen lds
    s_add_u32 m0, s58, 3072
    s_waitcnt vmcnt(63)
    buffer_load_dwordx4 v13, s[40:43], s61 offen lds
    s_add_u32 m0, s58, 4096
    s_waitcnt vmcnt(63)
    buffer_load_dwordx4 v14, s[40:43], s61 offen lds
    v_accvgpr_read_b32 v18, a127
    v_accvgpr_read_b32 v19, a127
    v_pk_mul_f32 v[24:25], v[24:25], v[18:19]
    v_pk_mul_f32 v[26:27], v[26:27], v[18:19]
    v_pk_mul_f32 v[28:29], v[28:29], v[18:19]
    v_pk_mul_f32 v[30:31], v[30:31], v[18:19]
    v_pk_mul_f32 v[32:33], v[32:33], v[18:19]
    v_pk_mul_f32 v[34:35], v[34:35], v[18:19]
    v_pk_mul_f32 v[36:37], v[36:37], v[18:19]
    v_pk_mul_f32 v[38:39], v[38:39], v[18:19]
    v_pk_mul_f32 v[40:41], v[40:41], v[18:19]
    v_pk_mul_f32 v[42:43], v[42:43], v[18:19]
    v_pk_mul_f32 v[44:45], v[44:45], v[18:19]
    v_pk_mul_f32 v[46:47], v[46:47], v[18:19]
    v_pk_mul_f32 v[48:49], v[48:49], v[18:19]
    v_pk_mul_f32 v[50:51], v[50:51], v[18:19]
    v_pk_mul_f32 v[52:53], v[52:53], v[18:19]
    v_pk_mul_f32 v[54:55], v[54:55], v[18:19]
    v_pk_mul_f32 v[56:57], v[56:57], v[18:19]
    v_pk_mul_f32 v[58:59], v[58:59], v[18:19]
    v_pk_mul_f32 v[60:61], v[60:61], v[18:19]
    v_pk_mul_f32 v[62:63], v[62:63], v[18:19]
    v_pk_mul_f32 v[64:65], v[64:65], v[18:19]
    v_pk_mul_f32 v[66:67], v[66:67], v[18:19]
    v_pk_mul_f32 v[68:69], v[68:69], v[18:19]
    v_pk_mul_f32 v[70:71], v[70:71], v[18:19]
    v_pk_mul_f32 v[72:73], v[72:73], v[18:19]
    v_pk_mul_f32 v[74:75], v[74:75], v[18:19]
    v_pk_mul_f32 v[76:77], v[76:77], v[18:19]
    v_pk_mul_f32 v[78:79], v[78:79], v[18:19]
    v_pk_mul_f32 v[80:81], v[80:81], v[18:19]
    v_pk_mul_f32 v[82:83], v[82:83], v[18:19]
    v_pk_mul_f32 v[84:85], v[84:85], v[18:19]
    v_pk_mul_f32 v[86:87], v[86:87], v[18:19]
    v_pk_mul_f32 v[88:89], v[88:89], v[18:19]
    v_pk_mul_f32 v[90:91], v[90:91], v[18:19]
    v_pk_mul_f32 v[92:93], v[92:93], v[18:19]
    v_pk_mul_f32 v[94:95], v[94:95], v[18:19]
    v_pk_mul_f32 v[96:97], v[96:97], v[18:19]
    v_pk_mul_f32 v[98:99], v[98:99], v[18:19]
    v_pk_mul_f32 v[100:101], v[100:101], v[18:19]
    v_pk_mul_f32 v[102:103], v[102:103], v[18:19]
    s_waitcnt lgkmcnt(0)
    s_add_u32 m0, s58, 5120
    s_add_u32 s61, s57, 122880
    s_waitcnt vmcnt(63)
    buffer_load_dwordx4 v10, s[40:43], s61 offen lds
    s_add_u32 m0, s58, 6144
    s_waitcnt vmcnt(63)
    buffer_load_dwordx4 v11, s[40:43], s61 offen lds
    s_add_u32 m0, s58, 7168
    s_waitcnt vmcnt(63)
    buffer_load_dwordx4 v12, s[40:43], s61 offen lds
    s_add_u32 m0, s58, 8192
    s_waitcnt vmcnt(63)
    buffer_load_dwordx4 v13, s[40:43], s61 offen lds
    s_add_u32 m0, s58, 9216
    s_waitcnt vmcnt(63)
    buffer_load_dwordx4 v14, s[40:43], s61 offen lds
    v_mov_b32 v5, v120
    v_mov_b32 v6, v121
    v_mov_b32 v7, v122
    v_mul_u32_u24 v14, 1280, v3
    v_lshl_add_u32 v14, v2, 3, v14
    s_mov_b32 s32, s20
    s_mov_b32 s33, s21
    s_mov_b32 s34, 2621440
    s_mov_b32 s35, 0x20000
    s_mul_i32 s59, s56, 40960
    s_mul_i32 s53, s48, 320
    s_add_u32 s59, s59, s53
    s_mov_b64 exec, 0xf
    v_cmp_ne_u64 vcc, s[50:51], v[20:21]
    v_cmp_ne_u64 s[68:69], s[50:51], v[22:23]
    s_mov_b64 exec, -1
    s_or_b64 vcc, vcc, s[68:69]
    s_cbranch_scc0 L_G_marked
    v_lshlrev_b32 v20, 4, v1
    s_mov_b32 exec_lo, 0xf
    s_mov_b32 exec_hi, 0x0
    s_mov_b32 s49, 0x40000
Lp_12:
    buffer_load_dwordx4 v[16:19], v20, s[36:39], s52 offen sc1
    s_waitcnt vmcnt(0)
    v_cmp_ne_u64 vcc, s[50:51], v[16:17]
    v_cmp_ne_u64 s[68:69], s[50:51], v[18:19]
    s_sub_u32 s49, s49, 1
    s_cbranch_scc1 Lpd_13
    s_or_b64 vcc, vcc, s[68:69]
    s_cbranch_scc0 Lpd_13
    s_sleep 16
    s_branch Lp_12
Lpd_13:
    s_mov_b64 exec, -1
L_G_marked:
    s_add_u32 s60, s52, 4096
    s_mov_b32 s66, 0x3ff
    s_mov_b32 s65, 0x3ff
    s_mov_b32 s49, 0x20000
    v_mov_b32 v12, 159752
Lw_14:
    ds_read_b32 v13, v12
    s_waitcnt lgkmcnt(0)
    v_readfirstlane_b32 s54, v13
    s_cmp_ge_u32 s54, 4
    s_cbranch_scc1 Lwd_15
    s_sleep 8
    s_branch Lw_14
Lwd_15:
    v_mov_b32 v12, 159756
Lw_16:
    ds_read_b32 v13, v12
    s_waitcnt lgkmcnt(0)
    v_readfirstlane_b32 s54, v13
    s_cmp_ge_u32 s54, 4
    s_cbranch_scc1 Lwd_17
    s_sleep 2
    s_branch Lw_16
Lwd_17:
    buffer_load_dwordx4 v[104:107], v4, s[36:39], s63 offen offset:0 sc1
    buffer_load_dwordx4 v[108:111], v4, s[36:39], s63 offen offset:1280 sc1
    buffer_load_dwordx4 v[112:115], v4, s[36:39], s63 offen offset:2560 sc1
    buffer_load_dwordx4 v[116:119], v4, s[36:39], s63 offen offset:3840 sc1
    buffer_load_dwordx4 v[120:123], v4, s[36:39], s64 offen offset:0 sc1
    buffer_load_dwordx4 v[124:127], v4, s[36:39], s64 offen offset:1280 sc1
    buffer_load_dwordx4 v[0:3], v4, s[36:39], s64 offen offset:2560 sc1
    buffer_load_dwordx4 v[8:11], v4, s[36:39], s64 offen offset:3840 sc1
    buffer_load_dwordx2 v[16:17], v14, s[36:39], s63 offen offset:1024 sc1
    buffer_load_dwordx2 v[18:19], v14, s[36:39], s63 offen offset:3584 sc1
    buffer_load_dwordx2 v[20:21], v14, s[36:39], s64 offen offset:1024 sc1
    buffer_load_dwordx2 v[22:23], v14, s[36:39], s64 offen offset:3584 sc1
    s_waitcnt vmcnt(11)
    v_max3_u32 v12, v104, v105, v106
    v_max_u32 v12, v12, v107
    v_cmp_eq_u32 vcc, -1, v12
    s_cmp_lg_u64 vcc, 0
    s_cbranch_scc1 L_G_cont
    s_waitcnt lgkmcnt(4)
    v_mfma_f32_32x32x16_bf16 v[24:39], a[40:43], v[104:107], v[24:39]
    v_mfma_f32_32x32x16_bf16 v[40:55], a[44:47], v[104:107], v[40:55]
    ds_read_b64_tr_b16 a[40:41], v15 offset:10240
    ds_read_b64_tr_b16 a[42:43], v15 offset:12800
    v_mfma_f32_32x32x16_bf16 v[56:71], a[48:51], v[104:107], v[56:71]
    ds_read_b64_tr_b16 a[44:45], v15 offset:10304
    ds_read_b64_tr_b16 a[46:47], v15 offset:12864
    s_waitcnt vmcnt(10)
    v_max3_u32 v12, v108, v109, v110
    v_max_u32 v12, v12, v111
    v_cmp_eq_u32 vcc, -1, v12
    v_mfma_f32_32x32x16_bf16 v[72:87], a[52:55], v[104:107], v[72:87]
    ds_read_b64_tr_b16 a[48:49], v15 offset:10368
    ds_read_b64_tr_b16 a[50:51], v15 offset:12928
    v_mfma_f32_32x32x16_bf16 v[88:103], a[56:59], v[104:107], v[88:103]
    ds_read_b64_tr_b16 a[52:53], v15 offset:10432
    ds_read_b64_tr_b16 a[54:55], v15 offset:12992
    s_bitset0_b32 s66, 0
    ds_read_b64_tr_b16 a[56:57], v15 offset:10496
    ds_read_b64_tr_b16 a[58:59], v15 offset:13056
    s_cmp_lg_u64 vcc, 0
    s_cbranch_scc1 L_G_cont
    s_waitcnt lgkmcnt(4)
    v_mfma_f32_32x32x16_bf16 v[24:39], a[60:63], v[108:111], v[24:39]
    v_mfma_f32_32x32x16_bf16 v[40:55], a[64:67], v[108:111], v[40:55]
    ds_read_b64_tr_b16 a[60:61], v15 offset:15360
    ds_read_b64_tr_b16 a[62:63], v15 offset:17920
    v_mfma_f32_32x32x16_bf16 v[56:71], a[68:71], v[108:111], v[56:71]
    ds_read_b64_tr_b16 a[64:65], v15 offset:15424
    ds_read_b64_tr_b16 a[66:67], v15 offset:17984
    s_waitcnt vmcnt(9)
    v_max3_u32 v12, v112, v113, v114
    v_max_u32 v12, v12, v115
    v_cmp_eq_u32 vcc, -1, v12
    v_mfma_f32_32x32x16_bf16 v[72:87], a[72:75], v[108:111], v[72:87]
    ds_read_b64_tr_b16 a[68:69], v15 offset:15488
    ds_read_b64_tr_b16 a[70:71], v15 offset:18048
    v_mfma_f32_32x32x16_bf16 v[88:103], a[76:79], v[108:111], v[88:103]
    ds_read_b64_tr_b16 a[72:73], v15 offset:15552
    ds_read_b64_tr_b16 a[74:75], v15 offset:18112
    s_bitset0_b32 s66, 1
    ds_read_b64_tr_b16 a[76:77], v15 offset:15616
    ds_read_b64_tr_b16 a[78:79], v15 offset:18176
    s_cmp_lg_u64 vcc, 0
    s_cbranch_scc1 L_G_cont
    s_waitcnt lgkmcnt(4)
    v_mfma_f32_32x32x16_bf16 v[24:39], a[80:83], v[112:115], v[24:39]
    v_mfma_f32_32x32x16_bf16 v[40:55], a[84:87], v[112:115], v[40:55]
    ds_read_b64_tr_b16 a[80:81], v15 offset:0
    ds_read_b64_tr_b16 a[82:83], v15 offset:2560
    v_mfma_f32_32x32x16_bf16 v[56:71], a[88:91], v[112:115], v[56:71]
    ds_read_b64_tr_b16 a[84:85], v15 offset:64
    ds_read_b64_tr_b16 a[86:87], v15 offset:2624
    s_waitcnt vmcnt(8)
    v_max3_u32 v12, v116, v117, v118
    v_max_u32 v12, v12, v119
    v_cmp_eq_u32 vcc, -1, v12
    v_mfma_f32_32x32x16_bf16 v[72:87], a[92:95], v[112:115], v[72:87]
    ds_read_b64_tr_b16 a[88:89], v15 offset:128
    ds_read_b64_tr_b16 a[90:91], v15 offset:2688
    v_mfma_f32_32x32x16_bf16 v[88:103], a[96:99], v[112:115], v[88:103]
    ds_read_b64_tr_b16 a[92:93], v15 offset:192
    ds_read_b64_tr_b16 a[94:95], v15 offset:2752
    s_bitset0_b32 s66, 2
    ds_read_b64_tr_b16 a[96:97], v15 offset:256
    ds_read_b64_tr_b16 a[98:99], v15 offset:2816
    s_cmp_lg_u64 vcc, 0
    s_cbranch_scc1 L_G_cont
    s_waitcnt lgkmcnt(4)
    v_mfma_f32_32x32x16_bf16 v[24:39], a[100:103], v[116:119], v[24:39]
    v_mfma_f32_32x32x16_bf16 v[40:55], a[104:107], v[116:119], v[40:55]
    ds_read_b64_tr_b16 a[100:101], v15 offset:5120
    ds_read_b64_tr_b16 a[102:103], v15 offset:7680
    v_mfma_f32_32x32x16_bf16 v[56:71], a[108:111], v[116:119], v[56:71]
    ds_read_b64_tr_b16 a[104:105], v15 offset:5184
    ds_read_b64_tr_b16 a[106:107], v15 offset:7744
    s_waitcnt vmcnt(7)
    v_max3_u32 v12, v120, v121, v122
    v_max_u32 v12, v12, v123
    v_cmp_eq_u32 vcc, -1, v12
    v_mfma_f32_32x32x16_bf16 v[72:87], a[112:115], v[116:119], v[72:87]
    ds_read_b64_tr_b16 a[108:109], v15 offset:5248
    ds_read_b64_tr_b16 a[110:111], v15 offset:7808
    v_mfma_f32_32x32x16_bf16 v[88:103], a[116:119], v[116:119], v[88:103]
    ds_read_b64_tr_b16 a[112:113], v15 offset:5312
    ds_read_b64_tr_b16 a[114:115], v15 offset:7872
    s_bitset0_b32 s66, 3
    ds_read_b64_tr_b16 a[116:117], v15 offset:5376
    ds_read_b64_tr_b16 a[118:119], v15 offset:7936
    s_cmp_lg_u64 vcc, 0
    s_cbranch_scc1 L_G_cont
    v_mfma_f32_32x32x16_bf16 v[24:39], a[0:3], v[120:123], v[24:39]
    v_mfma_f32_32x32x16_bf16 v[40:55], a[4:7], v[120:123], v[40:55]
    v_mfma_f32_32x32x16_bf16 v[56:71], a[8:11], v[120:123], v[56:71]
    s_waitcnt vmcnt(6)
    v_max3_u32 v12, v124, v125, v126
    v_max_u32 v12, v12, v127
    v_cmp_eq_u32 vcc, -1, v12
    v_mfma_f32_32x32x16_bf16 v[72:87], a[12:15], v[120:123], v[72:87]
    v_mfma_f32_32x32x16_bf16 v[88:103], a[16:19], v[120:123], v[88:103]
    s_bitset0_b32 s66, 4
    s_cmp_lg_u64 vcc, 0
    s_cbranch_scc1 L_G_cont
    v_mfma_f32_32x32x16_bf16 v[24:39], a[20:23], v[124:127], v[24:39]
    v_mfma_f32_32x32x16_bf16 v[40:55], a[24:27], v[124:127], v[40:55]
    v_mfma_f32_32x32x16_bf16 v[56:71], a[28:31], v[124:127], v[56:71]
    s_waitcnt vmcnt(5)
    v_max3_u32 v12, v0, v1, v2
    v_max_u32 v12, v12, v3
    v_cmp_eq_u32 vcc, -1, v12
    v_mfma_f32_32x32x16_bf16 v[72:87], a[32:35], v[124:127], v[72:87]
    v_mfma_f32_32x32x16_bf16 v[88:103], a[36:39], v[124:127], v[88:103]
    s_bitset0_b32 s66, 5
    s_cmp_lg_u64 vcc, 0
    s_cbranch_scc1 L_G_cont
    s_waitcnt lgkmcnt(0)
    v_mfma_f32_32x32x16_bf16 v[24:39], a[40:43], v[0:3], v[24:39]
    v_mfma_f32_32x32x16_bf16 v[40:55], a[44:47], v[0:3], v[40:55]
    v_mfma_f32_32x32x16_bf16 v[56:71], a[48:51], v[0:3], v[56:71]
    s_waitcnt vmcnt(4)
    v_max3_u32 v12, v8, v9, v10
    v_max_u32 v12, v12, v11
    v_cmp_eq_u32 vcc, -1, v12
    v_mfma_f32_32x32x16_bf16 v[72:87], a[52:55], v[0:3], v[72:87]
    v_mfma_f32_32x32x16_bf16 v[88:103], a[56:59], v[0:3], v[88:103]
    s_bitset0_b32 s66, 6
    s_cmp_lg_u64 vcc, 0
    s_cbranch_scc1 L_G_cont
    v_mfma_f32_32x32x16_bf16 v[24:39], a[60:63], v[8:11], v[24:39]
    v_mfma_f32_32x32x16_bf16 v[40:55], a[64:67], v[8:11], v[40:55]
    v_mfma_f32_32x32x16_bf16 v[56:71], a[68:71], v[8:11], v[56:71]
    s_waitcnt vmcnt(2)
    v_max3_u32 v12, v16, v17, v18
    v_max_u32 v12, v12, v19
    v_cmp_eq_u32 vcc, -1, v12
    v_mfma_f32_32x32x16_bf16 v[72:87], a[72:75], v[8:11], v[72:87]
    v_mfma_f32_32x32x16_bf16 v[88:103], a[76:79], v[8:11], v[88:103]
    s_bitset0_b32 s66, 7
    s_cmp_lg_u64 vcc, 0
    s_cbranch_scc1 L_G_cont
    v_mfma_f32_32x32x16_bf16 v[24:39], a[80:83], v[16:19], v[24:39]
    v_mfma_f32_32x32x16_bf16 v[40:55], a[84:87], v[16:19], v[40:55]
    v_mfma_f32_32x32x16_bf16 v[56:71], a[88:91], v[16:19], v[56:71]
    s_waitcnt vmcnt(0)
    v_max3_u32 v12, v20, v21, v22
    v_max_u32 v12, v12, v23
    v_cmp_eq_u32 vcc, -1, v12
    v_mfma_f32_32x32x16_bf16 v[72:87], a[92:95], v[16:19], v[72:87]
    v_mfma_f32_32x32x16_bf16 v[88:103], a[96:99], v[16:19], v[88:103]
    s_bitset0_b32 s66, 8
    s_cmp_lg_u64 vcc, 0
    s_cbranch_scc1 L_G_cont
    v_mfma_f32_32x32x16_bf16 v[24:39], a[100:103], v[20:23], v[24:39]
    v_mfma_f32_32x32x16_bf16 v[40:55], a[104:107], v[20:23], v[40:55]
    v_mfma_f32_32x32x16_bf16 v[56:71], a[108:111], v[20:23], v[56:71]
    v_mfma_f32_32x32x16_bf16 v[72:87], a[112:115], v[20:23], v[72:87]
    v_mfma_f32_32x32x16_bf16 v[88:103], a[116:119], v[20:23], v[88:103]
    s_bitset0_b32 s66, 9
L_G_swept:
    v_accvgpr_read_b32 v8, a120
    v_accvgpr_read_b32 v9, a121
    v_accvgpr_read_b32 v10, a122
    v_accvgpr_read_b32 v11, a123
    v_accvgpr_read_b32 v12, a124
    v_accvgpr_read_b32 v13, a125
    v_accvgpr_read_b32 v14, a126
    s_nop 4
    ds_write_b128 v14, v[24:27] offset:0
    ds_write_b128 v14, v[28:31] offset:32
    ds_write_b128 v14, v[32:35] offset:64
    ds_write_b128 v14, v[36:39] offset:96
    ds_write_b128 v14, v[40:43] offset:128
    ds_write_b128 v14, v[44:47] offset:160
    ds_write_b128 v14, v[48:51] offset:192
    ds_write_b128 v14, v[52:55] offset:224
    ds_write_b128 v14, v[56:59] offset:256
    ds_write_b128 v14, v[60:63] offset:288
    ds_write_b128 v14, v[64:67] offset:320
    ds_write_b128 v14, v[68:71] offset:352
    ds_write_b128 v14, v[72:75] offset:384
    ds_write_b128 v14, v[76:79] offset:416
    ds_write_b128 v14, v[80:83] offset:448
    ds_write_b128 v14, v[84:87] offset:480
    ds_write_b128 v14, v[88:91] offset:512
    ds_write_b128 v14, v[92:95] offset:544
    ds_write_b128 v14, v[96:99] offset:576
    ds_write_b128 v14, v[100:103] offset:608
    s_waitcnt lgkmcnt(0)
    v_mov_b32 v16, 159760
    v_mov_b32 v17, 1
    s_mov_b64 exec, 1
    ds_add_u32 v16, v17
    s_mov_b64 exec, -1
    v_mov_b32 v16, 159760
Lw_18:
    ds_read_b32 v17, v16
    s_waitcnt lgkmcnt(0)
    v_readfirstlane_b32 s54, v17
    s_cmp_ge_u32 s54, 4
    s_cbranch_scc1 Lwd_19
    s_sleep 1
    s_branch Lw_18
Lwd_19:
    ds_read_b128 v[24:27], v8 offset:0
    ds_read_b128 v[28:31], v8 offset:16
    ds_read_b128 v[32:35], v8 offset:21504
    ds_read_b128 v[36:39], v8 offset:21520
    ds_read_b128 v[40:43], v8 offset:43008
    ds_read_b128 v[44:47], v8 offset:43024
    ds_read_b128 v[48:51], v8 offset:64512
    ds_read_b128 v[52:55], v8 offset:64528
    ds_read_b128 v[56:59], v9 offset:0
    ds_read_b128 v[60:63], v9 offset:16
    ds_read_b128 v[64:67], v9 offset:21504
    ds_read_b128 v[68:71], v9 offset:21520
    ds_read_b128 v[72:75], v9 offset:43008
    ds_read_b128 v[76:79], v9 offset:43024
    ds_read_b128 v[80:83], v9 offset:64512
    s_waitcnt lgkmcnt(14)
    ds_read_b128 v[84:87], v9 offset:64528
    s_waitcnt lgkmcnt(8)
    v_mov_b32 v20, v5
    v_mov_b32 v21, v5
    v_pk_add_f32 v[24:25], v[24:25], v[32:33]
    v_pk_add_f32 v[26:27], v[26:27], v[34:35]
    v_pk_add_f32 v[28:29], v[28:29], v[36:37]
    v_pk_add_f32 v[30:31], v[30:31], v[38:39]
    v_pk_add_f32 v[40:41], v[40:41], v[48:49]
    v_pk_add_f32 v[42:43], v[42:43], v[50:51]
    v_pk_add_f32 v[44:45], v[44:45], v[52:53]
    v_pk_add_f32 v[46:47], v[46:47], v[54:55]
    v_pk_add_f32 v[24:25], v[24:25], v[40:41]
    v_pk_add_f32 v[26:27], v[26:27], v[42:43]
    v_pk_add_f32 v[28:29], v[28:29], v[44:45]
    v_pk_add_f32 v[30:31], v[30:31], v[46:47]
    v_pk_mul_f32 v[24:25], v[24:25], v[20:21]
    v_pk_mul_f32 v[26:27], v[26:27], v[20:21]
    v_pk_mul_f32 v[28:29], v[28:29], v[20:21]
    v_pk_mul_f32 v[30:31], v[30:31], v[20:21]
    v_cvt_pk_bf16_f32 v32, v24, v25
    v_cvt_pk_bf16_f32 v33, v26, v27
    v_cvt_pk_bf16_f32 v34, v28, v29
    v_cvt_pk_bf16_f32 v35, v30, v31
    buffer_store_dwordx4 v[32:35], v11, s[32:35], s59 offen
    ds_read_b128 v[88:91], v10 offset:0
    ds_read_b128 v[92:95], v10 offset:16
    ds_read_b128 v[96:99], v10 offset:21504
    ds_read_b128 v[100:103], v10 offset:21520
    ds_read_b128 v[104:107], v10 offset:43008
    ds_read_b128 v[108:111], v10 offset:43024
    ds_read_b128 v[112:115], v10 offset:64512
    s_waitcnt lgkmcnt(14)
    ds_read_b128 v[116:119], v10 offset:64528
    s_waitcnt lgkmcnt(8)
    v_mov_b32 v20, v6
    v_mov_b32 v21, v6
    v_pk_add_f32 v[56:57], v[56:57], v[64:65]
    v_pk_add_f32 v[58:59], v[58:59], v[66:67]
    v_pk_add_f32 v[60:61], v[60:61], v[68:69]
    v_pk_add_f32 v[62:63], v[62:63], v[70:71]
    v_pk_add_f32 v[72:73], v[72:73], v[80:81]
    v_pk_add_f32 v[74:75], v[74:75], v[82:83]
    v_pk_add_f32 v[76:77], v[76:77], v[84:85]
    v_pk_add_f32 v[78:79], v[78:79], v[86:87]
    v_pk_add_f32 v[56:57], v[56:57], v[72:73]
    v_pk_add_f32 v[58:59], v[58:59], v[74:75]
    v_pk_add_f32 v[60:61], v[60:61], v[76:77]
    v_pk_add_f32 v[62:63], v[62:63], v[78:79]
    v_pk_mul_f32 v[56:57], v[56:57], v[20:21]
    v_pk_mul_f32 v[58:59], v[58:59], v[20:21]
    v_pk_mul_f32 v[60:61], v[60:61], v[20:21]
    v_pk_mul_f32 v[62:63], v[62:63], v[20:21]
    v_cvt_pk_bf16_f32 v64, v56, v57
    v_cvt_pk_bf16_f32 v65, v58, v59
    v_cvt_pk_bf16_f32 v66, v60, v61
    v_cvt_pk_bf16_f32 v67, v62, v63
    buffer_store_dwordx4 v[64:67], v12, s[32:35], s59 offen
    s_cmp_ge_u32 s45, 2
    s_cbranch_scc1 L_G_done
    s_waitcnt lgkmcnt(0)
    v_mov_b32 v20, v7
    v_mov_b32 v21, v7
    v_pk_add_f32 v[88:89], v[88:89], v[96:97]
    v_pk_add_f32 v[90:91], v[90:91], v[98:99]
    v_pk_add_f32 v[92:93], v[92:93], v[100:101]
    v_pk_add_f32 v[94:95], v[94:95], v[102:103]
    v_pk_add_f32 v[104:105], v[104:105], v[112:113]
    v_pk_add_f32 v[106:107], v[106:107], v[114:115]
    v_pk_add_f32 v[108:109], v[108:109], v[116:117]
    v_pk_add_f32 v[110:111], v[110:111], v[118:119]
    v_pk_add_f32 v[88:89], v[88:89], v[104:105]
    v_pk_add_f32 v[90:91], v[90:91], v[106:107]
    v_pk_add_f32 v[92:93], v[92:93], v[108:109]
    v_pk_add_f32 v[94:95], v[94:95], v[110:111]
    v_pk_mul_f32 v[88:89], v[88:89], v[20:21]
    v_pk_mul_f32 v[90:91], v[90:91], v[20:21]
    v_pk_mul_f32 v[92:93], v[92:93], v[20:21]
    v_pk_mul_f32 v[94:95], v[94:95], v[20:21]
    v_cvt_pk_bf16_f32 v96, v88, v89
    v_cvt_pk_bf16_f32 v97, v90, v91
    v_cvt_pk_bf16_f32 v98, v92, v93
    v_cvt_pk_bf16_f32 v99, v94, v95
    buffer_store_dwordx4 v[96:99], v13, s[32:35], s59 offen
L_G_done:
    s_endpgm
L_G_next:
    s_mov_b32 s65, s66
L_G_sweep:
    s_bitcmp0_b32 s65, 0
    s_cbranch_scc1 Ltl_20
    buffer_load_dwordx4 v[104:107], v4, s[36:39], s63 offen offset:0 sc1
Ltl_20:
    s_bitcmp0_b32 s65, 1
    s_cbranch_scc1 Ltl_21
    buffer_load_dwordx4 v[108:111], v4, s[36:39], s63 offen offset:1280 sc1
Ltl_21:
    s_bitcmp0_b32 s65, 2
    s_cbranch_scc1 Ltl_22
    buffer_load_dwordx4 v[112:115], v4, s[36:39], s63 offen offset:2560 sc1
Ltl_22:
    s_bitcmp0_b32 s65, 3
    s_cbranch_scc1 Ltl_23
    buffer_load_dwordx4 v[116:119], v4, s[36:39], s63 offen offset:3840 sc1
Ltl_23:
    s_bitcmp0_b32 s65, 4
    s_cbranch_scc1 Ltl_24
    buffer_load_dwordx4 v[120:123], v4, s[36:39], s64 offen offset:0 sc1
Ltl_24:
    s_bitcmp0_b32 s65, 5
    s_cbranch_scc1 Ltl_25
    buffer_load_dwordx4 v[124:127], v4, s[36:39], s64 offen offset:1280 sc1
Ltl_25:
    s_bitcmp0_b32 s65, 6
    s_cbranch_scc1 Ltl_26
    buffer_load_dwordx4 v[0:3], v4, s[36:39], s64 offen offset:2560 sc1
Ltl_26:
    s_bitcmp0_b32 s65, 7
    s_cbranch_scc1 Ltl_27
    buffer_load_dwordx4 v[8:11], v4, s[36:39], s64 offen offset:3840 sc1
Ltl_27:
    s_bitcmp0_b32 s65, 8
    s_cbranch_scc1 Ltl_28
    buffer_load_dwordx2 v[16:17], v14, s[36:39], s63 offen offset:1024 sc1
    buffer_load_dwordx2 v[18:19], v14, s[36:39], s63 offen offset:3584 sc1
Ltl_28:
    s_bitcmp0_b32 s65, 9
    s_cbranch_scc1 Ltl_29
    buffer_load_dwordx2 v[20:21], v14, s[36:39], s64 offen offset:1024 sc1
    buffer_load_dwordx2 v[22:23], v14, s[36:39], s64 offen offset:3584 sc1
Ltl_29:
    s_sub_u32 s49, s49, 1
    s_max_i32 s49, s49, 0
    s_cmp_eq_u32 s65, 0x3ff
    s_cbranch_scc1 L_G_full
L_G_cont:
    s_and_b32 s65, s65, s66
    s_waitcnt vmcnt(0)
L_G_full:
    s_waitcnt vmcnt(11)
    s_bitcmp0_b32 s65, 0
    s_cbranch_scc1 Lts_30
    v_max3_u32 v12, v104, v105, v106
    v_max_u32 v12, v12, v107
    v_cmp_eq_u32 vcc, -1, v12
    s_cmp_eq_u32 s49, 0
    s_cbranch_scc1 Ltg_31
    s_cmp_lg_u64 vcc, 0
    s_cbranch_scc1 Lts_30
Ltg_31:
    s_setprio 0
    v_mfma_f32_32x32x16_bf16 v[24:39], a[40:43], v[104:107], v[24:39]
    v_mfma_f32_32x32x16_bf16 v[40:55], a[44:47], v[104:107], v[40:55]
    v_mfma_f32_32x32x16_bf16 v[56:71], a[48:51], v[104:107], v[56:71]
    v_mfma_f32_32x32x16_bf16 v[72:87], a[52:55], v[104:107], v[72:87]
    v_mfma_f32_32x32x16_bf16 v[88:103], a[56:59], v[104:107], v[88:103]
    s_setprio 2
    s_bitset0_b32 s66, 0
    s_waitcnt lgkmcnt(5)
    ds_read_b64_tr_b16 a[40:41], v15 offset:10240
    ds_read_b64_tr_b16 a[42:43], v15 offset:12800
    ds_read_b64_tr_b16 a[44:45], v15 offset:10304
    ds_read_b64_tr_b16 a[46:47], v15 offset:12864
    ds_read_b64_tr_b16 a[48:49], v15 offset:10368
    ds_read_b64_tr_b16 a[50:51], v15 offset:12928
    ds_read_b64_tr_b16 a[52:53], v15 offset:10432
    ds_read_b64_tr_b16 a[54:55], v15 offset:12992
    ds_read_b64_tr_b16 a[56:57], v15 offset:10496
    ds_read_b64_tr_b16 a[58:59], v15 offset:13056
Lts_30:
    s_waitcnt vmcnt(10)
    s_bitcmp0_b32 s65, 1
    s_cbranch_scc1 Lts_32
    v_max3_u32 v12, v108, v109, v110
    v_max_u32 v12, v12, v111
    v_cmp_eq_u32 vcc, -1, v12
    s_cmp_eq_u32 s49, 0
    s_cbranch_scc1 Ltg_33
    s_cmp_lg_u64 vcc, 0
    s_cbranch_scc1 Lts_32
Ltg_33:
    s_setprio 0
    v_mfma_f32_32x32x16_bf16 v[24:39], a[60:63], v[108:111], v[24:39]
    v_mfma_f32_32x32x16_bf16 v[40:55], a[64:67], v[108:111], v[40:55]
    v_mfma_f32_32x32x16_bf16 v[56:71], a[68:71], v[108:111], v[56:71]
    v_mfma_f32_32x32x16_bf16 v[72:87], a[72:75], v[108:111], v[72:87]
    v_mfma_f32_32x32x16_bf16 v[88:103], a[76:79], v[108:111], v[88:103]
    s_setprio 2
    s_bitset0_b32 s66, 1
    s_waitcnt lgkmcnt(5)
    ds_read_b64_tr_b16 a[60:61], v15 offset:15360
    ds_read_b64_tr_b16 a[62:63], v15 offset:17920
    ds_read_b64_tr_b16 a[64:65], v15 offset:15424
    ds_read_b64_tr_b16 a[66:67], v15 offset:17984
    ds_read_b64_tr_b16 a[68:69], v15 offset:15488
    ds_read_b64_tr_b16 a[70:71], v15 offset:18048
    ds_read_b64_tr_b16 a[72:73], v15 offset:15552
    ds_read_b64_tr_b16 a[74:75], v15 offset:18112
    ds_read_b64_tr_b16 a[76:77], v15 offset:15616
    ds_read_b64_tr_b16 a[78:79], v15 offset:18176
Lts_32:
    s_waitcnt vmcnt(9)
    s_bitcmp0_b32 s65, 2
    s_cbranch_scc1 Lts_34
    v_max3_u32 v12, v112, v113, v114
    v_max_u32 v12, v12, v115
    v_cmp_eq_u32 vcc, -1, v12
    s_cmp_eq_u32 s49, 0
    s_cbranch_scc1 Ltg_35
    s_cmp_lg_u64 vcc, 0
    s_cbranch_scc1 Lts_34
Ltg_35:
    s_setprio 0
    v_mfma_f32_32x32x16_bf16 v[24:39], a[80:83], v[112:115], v[24:39]
    v_mfma_f32_32x32x16_bf16 v[40:55], a[84:87], v[112:115], v[40:55]
    v_mfma_f32_32x32x16_bf16 v[56:71], a[88:91], v[112:115], v[56:71]
    v_mfma_f32_32x32x16_bf16 v[72:87], a[92:95], v[112:115], v[72:87]
    v_mfma_f32_32x32x16_bf16 v[88:103], a[96:99], v[112:115], v[88:103]
    s_setprio 2
    s_bitset0_b32 s66, 2
    s_waitcnt lgkmcnt(5)
    ds_read_b64_tr_b16 a[80:81], v15 offset:0
    ds_read_b64_tr_b16 a[82:83], v15 offset:2560
    ds_read_b64_tr_b16 a[84:85], v15 offset:64
    ds_read_b64_tr_b16 a[86:87], v15 offset:2624
    ds_read_b64_tr_b16 a[88:89], v15 offset:128
    ds_read_b64_tr_b16 a[90:91], v15 offset:2688
    ds_read_b64_tr_b16 a[92:93], v15 offset:192
    ds_read_b64_tr_b16 a[94:95], v15 offset:2752
    ds_read_b64_tr_b16 a[96:97], v15 offset:256
    ds_read_b64_tr_b16 a[98:99], v15 offset:2816
Lts_34:
    s_waitcnt vmcnt(8)
    s_bitcmp0_b32 s65, 3
    s_cbranch_scc1 Lts_36
    v_max3_u32 v12, v116, v117, v118
    v_max_u32 v12, v12, v119
    v_cmp_eq_u32 vcc, -1, v12
    s_cmp_eq_u32 s49, 0
    s_cbranch_scc1 Ltg_37
    s_cmp_lg_u64 vcc, 0
    s_cbranch_scc1 Lts_36
Ltg_37:
    s_setprio 0
    v_mfma_f32_32x32x16_bf16 v[24:39], a[100:103], v[116:119], v[24:39]
    v_mfma_f32_32x32x16_bf16 v[40:55], a[104:107], v[116:119], v[40:55]
    v_mfma_f32_32x32x16_bf16 v[56:71], a[108:111], v[116:119], v[56:71]
    v_mfma_f32_32x32x16_bf16 v[72:87], a[112:115], v[116:119], v[72:87]
    v_mfma_f32_32x32x16_bf16 v[88:103], a[116:119], v[116:119], v[88:103]
    s_setprio 2
    s_bitset0_b32 s66, 3
    s_waitcnt lgkmcnt(5)
    ds_read_b64_tr_b16 a[100:101], v15 offset:5120
    ds_read_b64_tr_b16 a[102:103], v15 offset:7680
    ds_read_b64_tr_b16 a[104:105], v15 offset:5184
    ds_read_b64_tr_b16 a[106:107], v15 offset:7744
    ds_read_b64_tr_b16 a[108:109], v15 offset:5248
    ds_read_b64_tr_b16 a[110:111], v15 offset:7808
    ds_read_b64_tr_b16 a[112:113], v15 offset:5312
    ds_read_b64_tr_b16 a[114:115], v15 offset:7872
    ds_read_b64_tr_b16 a[116:117], v15 offset:5376
    ds_read_b64_tr_b16 a[118:119], v15 offset:7936
Lts_36:
    s_waitcnt vmcnt(7)
    s_bitcmp0_b32 s65, 4
    s_cbranch_scc1 Lts_38
    v_max3_u32 v12, v120, v121, v122
    v_max_u32 v12, v12, v123
    v_cmp_eq_u32 vcc, -1, v12
    s_cmp_eq_u32 s49, 0
    s_cbranch_scc1 Ltg_39
    s_cmp_lg_u64 vcc, 0
    s_cbranch_scc1 Lts_38
Ltg_39:
    s_setprio 0
    v_mfma_f32_32x32x16_bf16 v[24:39], a[0:3], v[120:123], v[24:39]
    v_mfma_f32_32x32x16_bf16 v[40:55], a[4:7], v[120:123], v[40:55]
    v_mfma_f32_32x32x16_bf16 v[56:71], a[8:11], v[120:123], v[56:71]
    v_mfma_f32_32x32x16_bf16 v[72:87], a[12:15], v[120:123], v[72:87]
    v_mfma_f32_32x32x16_bf16 v[88:103], a[16:19], v[120:123], v[88:103]
    s_setprio 2
    s_bitset0_b32 s66, 4
Lts_38:
    s_waitcnt vmcnt(6)
    s_bitcmp0_b32 s65, 5
    s_cbranch_scc1 Lts_40
    v_max3_u32 v12, v124, v125, v126
    v_max_u32 v12, v12, v127
    v_cmp_eq_u32 vcc, -1, v12
    s_cmp_eq_u32 s49, 0
    s_cbranch_scc1 Ltg_41
    s_cmp_lg_u64 vcc, 0
    s_cbranch_scc1 Lts_40
Ltg_41:
    s_setprio 0
    v_mfma_f32_32x32x16_bf16 v[24:39], a[20:23], v[124:127], v[24:39]
    v_mfma_f32_32x32x16_bf16 v[40:55], a[24:27], v[124:127], v[40:55]
    v_mfma_f32_32x32x16_bf16 v[56:71], a[28:31], v[124:127], v[56:71]
    v_mfma_f32_32x32x16_bf16 v[72:87], a[32:35], v[124:127], v[72:87]
    v_mfma_f32_32x32x16_bf16 v[88:103], a[36:39], v[124:127], v[88:103]
    s_setprio 2
    s_bitset0_b32 s66, 5
Lts_40:
    s_waitcnt vmcnt(5) lgkmcnt(0)
    s_bitcmp0_b32 s65, 6
    s_cbranch_scc1 Lts_42
    s_bitcmp1_b32 s66, 0
    s_cbranch_scc1 Lts_42
    v_max3_u32 v12, v0, v1, v2
    v_max_u32 v12, v12, v3
    v_cmp_eq_u32 vcc, -1, v12
    s_cmp_eq_u32 s49, 0
    s_cbranch_scc1 Ltg_43
    s_cmp_lg_u64 vcc, 0
    s_cbranch_scc1 Lts_42
Ltg_43:
    s_setprio 0
    v_mfma_f32_32x32x16_bf16 v[24:39], a[40:43], v[0:3], v[24:39]
    v_mfma_f32_32x32x16_bf16 v[40:55], a[44:47], v[0:3], v[40:55]
    v_mfma_f32_32x32x16_bf16 v[56:71], a[48:51], v[0:3], v[56:71]
    v_mfma_f32_32x32x16_bf16 v[72:87], a[52:55], v[0:3], v[72:87]
    v_mfma_f32_32x32x16_bf16 v[88:103], a[56:59], v[0:3], v[88:103]
    s_setprio 2
    s_bitset0_b32 s66, 6
Lts_42:
    s_waitcnt vmcnt(4)
    s_bitcmp0_b32 s65, 7
    s_cbranch_scc1 Lts_44
    s_bitcmp1_b32 s66, 1
    s_cbranch_scc1 Lts_44
    v_max3_u32 v12, v8, v9, v10
    v_max_u32 v12, v12, v11
    v_cmp_eq_u32 vcc, -1, v12
    s_cmp_eq_u32 s49, 0
    s_cbranch_scc1 Ltg_45
    s_cmp_lg_u64 vcc, 0
    s_cbranch_scc1 Lts_44
Ltg_45:
    s_setprio 0
    v_mfma_f32_32x32x16_bf16 v[24:39], a[60:63], v[8:11], v[24:39]
    v_mfma_f32_32x32x16_bf16 v[40:55], a[64:67], v[8:11], v[40:55]
    v_mfma_f32_32x32x16_bf16 v[56:71], a[68:71], v[8:11], v[56:71]
    v_mfma_f32_32x32x16_bf16 v[72:87], a[72:75], v[8:11], v[72:87]
    v_mfma_f32_32x32x16_bf16 v[88:103], a[76:79], v[8:11], v[88:103]
    s_setprio 2
    s_bitset0_b32 s66, 7
Lts_44:
    s_waitcnt vmcnt(2)
    s_bitcmp0_b32 s65, 8
    s_cbranch_scc1 Lts_46
    s_bitcmp1_b32 s66, 2
    s_cbranch_scc1 Lts_46
    v_max3_u32 v12, v16, v17, v18
    v_max_u32 v12, v12, v19
    v_cmp_eq_u32 vcc, -1, v12
    s_cmp_eq_u32 s49, 0
    s_cbranch_scc1 Ltg_47
    s_cmp_lg_u64 vcc, 0
    s_cbranch_scc1 Lts_46
Ltg_47:
    s_setprio 0
    v_mfma_f32_32x32x16_bf16 v[24:39], a[80:83], v[16:19], v[24:39]
    v_mfma_f32_32x32x16_bf16 v[40:55], a[84:87], v[16:19], v[40:55]
    v_mfma_f32_32x32x16_bf16 v[56:71], a[88:91], v[16:19], v[56:71]
    v_mfma_f32_32x32x16_bf16 v[72:87], a[92:95], v[16:19], v[72:87]
    v_mfma_f32_32x32x16_bf16 v[88:103], a[96:99], v[16:19], v[88:103]
    s_setprio 2
    s_bitset0_b32 s66, 8
Lts_46:
    s_waitcnt vmcnt(0)
    s_bitcmp0_b32 s65, 9
    s_cbranch_scc1 Lts_48
    s_bitcmp1_b32 s66, 3
    s_cbranch_scc1 Lts_48
    v_max3_u32 v12, v20, v21, v22
    v_max_u32 v12, v12, v23
    v_cmp_eq_u32 vcc, -1, v12
    s_cmp_eq_u32 s49, 0
    s_cbranch_scc1 Ltg_49
    s_cmp_lg_u64 vcc, 0
    s_cbranch_scc1 Lts_48
Ltg_49:
    s_setprio 0
    v_mfma_f32_32x32x16_bf16 v[24:39], a[100:103], v[20:23], v[24:39]
    v_mfma_f32_32x32x16_bf16 v[40:55], a[104:107], v[20:23], v[40:55]
    v_mfma_f32_32x32x16_bf16 v[56:71], a[108:111], v[20:23], v[56:71]
    v_mfma_f32_32x32x16_bf16 v[72:87], a[112:115], v[20:23], v[72:87]
    v_mfma_f32_32x32x16_bf16 v[88:103], a[116:119], v[20:23], v[88:103]
    s_setprio 2
    s_bitset0_b32 s66, 9
Lts_48:
    s_cmp_eq_u32 s66, 0
    s_cbranch_scc1 L_G_swept
    s_sleep 6
    s_branch L_G_next
    s_endpgm
L_G_tokretry:
    s_mov_b32 s40, s22
    s_mov_b32 s41, s23
    s_mov_b32 s42, 256
    s_mov_b32 s43, 0x20000
    v_mov_b32 v42, 0
    s_mov_b32 s49, 0x40000
L_G_tokl:
    buffer_load_dwordx2 v[40:41], v42, s[40:43], 0 offen sc1
    s_waitcnt vmcnt(0)
    v_readfirstlane_b32 s50, v40
    s_sub_u32 s49, s49, 1
    s_cbranch_scc1 L_G_tokok
    s_cmp_eq_u32 s50, 0
    s_cbranch_scc1 L_G_tokl
    s_branch L_G_tokok
L_A:
    s_cmp_lg_u32 s44, 0
    s_cbranch_scc1 L_A_notok
    v_mov_b32 v18, 0
    v_lshlrev_b32 v15, 2, v1
    v_add_u32 v15, 159744, v15
    s_mov_b64 exec, 0xffffffff
    ds_write_b32 v15, v18
    s_mov_b64 exec, -1
    s_waitcnt lgkmcnt(0)
L_A_notok:
    s_add_u32 s58, s58, 5
    s_cmp_ge_u32 s58, 10
    s_cselect_b32 s54, 10, 0
    s_sub_u32 s58, s58, s54
    s_cmp_ge_u32 s45, 2
    s_cselect_b32 s32, s14, s12
    s_cselect_b32 s33, s15, s13
    s_mov_b32 s34, 1966080
    s_mov_b32 s35, 0x20000
    s_mul_i32 s52, s27, 98304
    s_mul_i32 s54, s62, 192
    s_add_u32 s52, s52, s54
    s_mov_b32 s53, 2880
    v_add_u32 v6, 0, v1
    v_mul_u32_u24 v23, 5462, v6
    v_lshrrev_b32 v23, 16, v23
    v_lshlrev_b32 v6, 4, v6
    v_mad_u32_u24 v6, v23, s53, v6
    v_add_u32 v6, s52, v6
    v_add_u32 v7, 64, v1
    v_mul_u32_u24 v23, 5462, v7
    v_lshrrev_b32 v23, 16, v23
    v_lshlrev_b32 v7, 4, v7
    v_mad_u32_u24 v7, v23, s53, v7
    v_add_u32 v7, s52, v7
    v_add_u32 v8, 128, v1
    v_mul_u32_u24 v23, 5462, v8
    v_lshrrev_b32 v23, 16, v23
    v_lshlrev_b32 v8, 4, v8
    v_mad_u32_u24 v8, v23, s53, v8
    v_add_u32 v8, s52, v8
    s_mul_i32 s57, s45, 6144
    s_lshl_b32 s54, s26, 5
    s_add_u32 s57, s57, s54
    s_add_u32 s57, s57, 81920
    v_lshrrev_b32 v15, 1, v2
    v_xor_b32 v15, v15, v2
    v_and_b32 v15, 4, v15
    v_mul_u32_u24 v15, 3, v15
    s_cmp_ge_u32 s3, 10
    s_cselect_b32 s52, -1, 0
    v_and_b32 v15, s52, v15
    v_xor_b32 v17, v15, v2
    v_lshrrev_b32 v15, 1, v17
    v_and_b32 v15, 7, v15
    v_xor_b32 v15, v15, v3
    v_lshlrev_b32 v15, 4, v15
    v_lshlrev_b32 v16, 7, v17
    s_mul_i32 s52, s26, 40960
    v_add3_u32 v9, v15, v16, s52
    v_xor_b32 v10, 32, v9
    v_xor_b32 v11, 64, v9
    v_xor_b32 v12, 96, v9
    v_bfe_u32 v18, v1, 2, 2
    v_lshl_add_u32 v15, v3, 3, v18
    v_bfe_u32 v16, v1, 4, 1
    v_and_b32 v17, 3, v1
    v_and_b32 v19, 1, v17
    v_lshlrev_b32 v19, 4, v19
    v_lshrrev_b32 v20, 1, v17
    v_lshl_add_u32 v19, v20, 3, v19
    v_lshlrev_b32 v17, 3, v17
    s_cmp_ge_u32 s3, 10
    s_cselect_b64 vcc, -1, 0
    v_cndmask_b32 v17, v19, v17, vcc
    v_lshlrev_b32 v15, 8, v15
    v_lshl_add_u32 v15, v16, 5, v15
    v_add_u32 v15, v15, v17
    v_add_u32 v15, 81920, v15
    s_lshl_b32 s52, s27, 1
    v_xor_b32 v18, s52, v18
    v_lshl_add_u32 v13, v18, 6, v15
    v_xor_b32 v14, 64, v13
    s_lshl_b32 s52, s45, 2
    s_add_u32 s52, s52, 159792
    v_mov_b32 v21, s52
    v_mov_b32 v22, 1
    s_and_b32 s52, s2, 7
    s_lshl_b32 s52, s52, 2
    s_bfe_u32 s53, s2, 0x20003
    s_add_u32 s6, s52, s53
    s_lshr_b32 s7, s2, 5
    s_mul_i32 s52, s6, 20
    s_lshr_b32 s17, s52, 7
    s_add_u32 s52, s52, 19
    s_lshr_b32 s52, s52, 7
    s_sub_u32 s52, s52, s17
    v_bfe_u32 v96, v1, 3, 1
    v_mul_u32_u24 v96, s52, v96
    v_lshrrev_b32 v97, 4, v1
    v_mul_u32_u24 v98, 5, v97
    v_add3_u32 v96, v96, v98, s17
    v_lshlrev_b32 v96, 7, v96
    v_and_b32 v98, 7, v1
    v_lshl_add_u32 v117, v98, 4, v96
    s_mul_i32 s53, s6, 5
    s_add_u32 s53, s53, 1
    s_lshr_b32 s53, s53, 1
    s_lshl_b32 s53, s53, 9
    s_bitcmp1_b32 s6, 0
    s_cselect_b32 s54, -1528, 0
    s_add_u32 s54, s54, 1024
    s_add_u32 s54, s54, s53
    v_lshlrev_b32 v112, 4, v1
    v_add_u32 v112, s53, v112
    v_lshlrev_b32 v113, 4, v2
    v_add_u32 v113, s54, v113
    s_lshl_b32 s17, s17, 7
    s_add_u32 s17, s17, 81920
    v_mov_b32 v100, s17
    v_lshlrev_b32 v116, 30, v3
    v_add_u32 v116, v116, v113
    v_cmp_ne_u32 vcc, 0, v3
    s_mul_i32 s53, s6, 320
    s_add_u32 s53, s53, 40960
    v_cndmask_b32 v113, v113, v100, vcc
    v_mul_u32_u24 v114, 10240, v3
    v_lshl_add_u32 v114, v2, 4, v114
    v_add_u32 v114, s53, v114
    v_add_u32 v115, 20480, v114
    v_cmp_eq_u32 vcc, 20, v2
    v_mov_b32 v101, 0x40000000
    s_mul_i32 s18, s7, 327680
    v_cndmask_b32 v114, v114, v100, vcc
    v_cndmask_b32 v115, v115, v100, vcc
    v_cmp_lt_u32 vcc, 20, v2
    s_mov_b32 s9, 3145728
    s_mul_i32 s8, s45, 1320960
    v_cndmask_b32 v114, v114, v101, vcc
    v_cndmask_b32 v115, v115, v101, vcc
    s_add_u32 s8, s8, s9
    s_lshl_b32 s16, s7, 2
    s_add_u32 s16, s16, s45
    s_lshl_b32 s16, s16, 1
    s_mul_i32 s53, s16, 40960
    s_add_u32 s53, s53, 17825792
    s_mul_i32 s54, s6, 1280
    s_add_u32 s10, s53, s54
    v_lshlrev_b32 v99, 4, v1
    s_add_u32 s52, s45, 1
    s_and_b32 s52, s52, 3
    s_mul_i32 s52, s52, 18432
    s_add_u32 s52, s52, 0
    v_add_u32 v118, s52, v99
    s_add_u32 s52, s45, 2
    s_and_b32 s52, s52, 3
    s_mul_i32 s52, s52, 18432
    s_add_u32 s52, s52, 3072
    v_add_u32 v119, s52, v99
    s_add_u32 s52, s45, 3
    s_and_b32 s52, s52, 3
    s_mul_i32 s52, s52, 18432
    s_add_u32 s52, s52, 6144
    v_add_u32 v120, s52, v99
    v_accvgpr_write_b32 a0, 0
    v_accvgpr_write_b32 a1, 0
    v_accvgpr_write_b32 a2, 0
    v_accvgpr_write_b32 a3, 0
    v_accvgpr_write_b32 a4, 0
    v_accvgpr_write_b32 a5, 0
    v_accvgpr_write_b32 a6, 0
    v_accvgpr_write_b32 a7, 0
    v_accvgpr_write_b32 a8, 0
    v_accvgpr_write_b32 a9, 0
    v_accvgpr_write_b32 a10, 0
    v_accvgpr_write_b32 a11, 0
    v_accvgpr_write_b32 a12, 0
    v_accvgpr_write_b32 a13, 0
    v_accvgpr_write_b32 a14, 0
    v_accvgpr_write_b32 a15, 0
    v_accvgpr_write_b32 a16, 0
    v_accvgpr_write_b32 a17, 0
    v_accvgpr_write_b32 a18, 0
    v_accvgpr_write_b32 a19, 0
    v_accvgpr_write_b32 a20, 0
    v_accvgpr_write_b32 a21, 0
    v_accvgpr_write_b32 a22, 0
    v_accvgpr_write_b32 a23, 0
    v_accvgpr_write_b32 a24, 0
    v_accvgpr_write_b32 a25, 0
    v_accvgpr_write_b32 a26, 0
    v_accvgpr_write_b32 a27, 0
    v_accvgpr_write_b32 a28, 0
    v_accvgpr_write_b32 a29, 0
    v_accvgpr_write_b32 a30, 0
    v_accvgpr_write_b32 a31, 0
    v_accvgpr_write_b32 a32, 0
    v_accvgpr_write_b32 a33, 0
    v_accvgpr_write_b32 a34, 0
    v_accvgpr_write_b32 a35, 0
    v_accvgpr_write_b32 a36, 0
    v_accvgpr_write_b32 a37, 0
    v_accvgpr_write_b32 a38, 0
    v_accvgpr_write_b32 a39, 0
    v_accvgpr_write_b32 a40, 0
    v_accvgpr_write_b32 a41, 0
    v_accvgpr_write_b32 a42, 0
    v_accvgpr_write_b32 a43, 0
    v_accvgpr_write_b32 a44, 0
    v_accvgpr_write_b32 a45, 0
    v_accvgpr_write_b32 a46, 0
    v_accvgpr_write_b32 a47, 0
    v_accvgpr_write_b32 a48, 0
    v_accvgpr_write_b32 a49, 0
    v_accvgpr_write_b32 a50, 0
    v_accvgpr_write_b32 a51, 0
    v_accvgpr_write_b32 a52, 0
    v_accvgpr_write_b32 a53, 0
    v_accvgpr_write_b32 a54, 0
    v_accvgpr_write_b32 a55, 0
    v_accvgpr_write_b32 a56, 0
    v_accvgpr_write_b32 a57, 0
    v_accvgpr_write_b32 a58, 0
    v_accvgpr_write_b32 a59, 0
    v_accvgpr_write_b32 a60, 0
    v_accvgpr_write_b32 a61, 0
    v_accvgpr_write_b32 a62, 0
    v_accvgpr_write_b32 a63, 0
    v_accvgpr_write_b32 a64, 0
    v_accvgpr_write_b32 a65, 0
    v_accvgpr_write_b32 a66, 0
    v_accvgpr_write_b32 a67, 0
    v_accvgpr_write_b32 a68, 0
    v_accvgpr_write_b32 a69, 0
    v_accvgpr_write_b32 a70, 0
    v_accvgpr_write_b32 a71, 0
    v_accvgpr_write_b32 a72, 0
    v_accvgpr_write_b32 a73, 0
    v_accvgpr_write_b32 a74, 0
    v_accvgpr_write_b32 a75, 0
    v_accvgpr_write_b32 a76, 0
    v_accvgpr_write_b32 a77, 0
    v_accvgpr_write_b32 a78, 0
    v_accvgpr_write_b32 a79, 0
    v_accvgpr_write_b32 a80, 0
    v_accvgpr_write_b32 a81, 0
    v_accvgpr_write_b32 a82, 0
    v_accvgpr_write_b32 a83, 0
    v_accvgpr_write_b32 a84, 0
    v_accvgpr_write_b32 a85, 0
    v_accvgpr_write_b32 a86, 0
    v_accvgpr_write_b32 a87, 0
    s_barrier
    s_cmp_ge_u32 s3, 10
    s_cbranch_scc1 L_A_v
    ds_read_b128 a[88:91], v9 offset:0
    ds_read_b64_tr_b16 a[96:97], v13 offset:0
    ds_read_b64_tr_b16 a[98:99], v13 offset:1024
    ds_read_b128 a[92:95], v9 offset:4096
    ds_read_b64_tr_b16 a[100:101], v14 offset:0
    ds_read_b64_tr_b16 a[102:103], v14 offset:1024
    s_waitcnt lgkmcnt(2)
    v_mfma_f32_32x32x16_bf16 v[32:47], a[96:99], a[88:91], 0
    ds_read_b128 a[108:111], v10 offset:0
    ds_read_b64_tr_b16 a[116:117], v13 offset:4096
    v_mfma_f32_32x32x16_bf16 v[48:63], a[96:99], a[92:95], 0
    ds_read_b64_tr_b16 a[118:119], v13 offset:5120
    ds_read_b128 a[112:115], v10 offset:4096
    s_waitcnt lgkmcnt(4)
    v_mfma_f32_32x32x16_bf16 v[64:79], a[100:103], a[88:91], 0
    ds_read_b64_tr_b16 a[120:121], v14 offset:4096
    ds_read_b64_tr_b16 a[122:123], v14 offset:5120
    v_mfma_f32_32x32x16_bf16 v[80:95], a[100:103], a[92:95], 0
    s_waitcnt lgkmcnt(2)
    v_mfma_f32_32x32x16_bf16 v[32:47], a[116:119], a[108:111], v[32:47]
    ds_read_b128 a[88:91], v11 offset:0
    ds_read_b64_tr_b16 a[96:97], v13 offset:8192
    v_mfma_f32_32x32x16_bf16 v[48:63], a[116:119], a[112:115], v[48:63]
    ds_read_b64_tr_b16 a[98:99], v13 offset:9216
    ds_read_b128 a[92:95], v11 offset:4096
    s_waitcnt lgkmcnt(4)
    v_mfma_f32_32x32x16_bf16 v[64:79], a[120:123], a[108:111], v[64:79]
    ds_read_b64_tr_b16 a[100:101], v14 offset:8192
    ds_read_b64_tr_b16 a[102:103], v14 offset:9216
    v_mfma_f32_32x32x16_bf16 v[80:95], a[120:123], a[112:115], v[80:95]
    s_waitcnt lgkmcnt(2)
    v_mfma_f32_32x32x16_bf16 v[32:47], a[96:99], a[88:91], v[32:47]
    ds_read_b128 a[108:111], v12 offset:0
    ds_read_b64_tr_b16 a[116:117], v13 offset:12288
    v_mfma_f32_32x32x16_bf16 v[48:63], a[96:99], a[92:95], v[48:63]
    ds_read_b64_tr_b16 a[118:119], v13 offset:13312
    ds_read_b128 a[112:115], v12 offset:4096
    s_waitcnt lgkmcnt(4)
    v_mfma_f32_32x32x16_bf16 v[64:79], a[100:103], a[88:91], v[64:79]
    ds_read_b64_tr_b16 a[120:121], v14 offset:12288
    ds_read_b64_tr_b16 a[122:123], v14 offset:13312
    v_mfma_f32_32x32x16_bf16 v[80:95], a[100:103], a[92:95], v[80:95]
    s_waitcnt lgkmcnt(2)
    v_mfma_f32_32x32x16_bf16 v[32:47], a[116:119], a[108:111], v[32:47]
    s_waitcnt lgkmcnt(0)
    s_barrier
    ds_read_b128 a[88:91], v9 offset:8192
    ds_read_b64_tr_b16 a[96:97], v13 offset:24608
    v_mfma_f32_32x32x16_bf16 v[48:63], a[116:119], a[112:115], v[48:63]
    ds_read_b64_tr_b16 a[98:99], v13 offset:25632
    ds_read_b128 a[92:95], v9 offset:12288
    v_mfma_f32_32x32x16_bf16 v[64:79], a[120:123], a[108:111], v[64:79]
    ds_read_b64_tr_b16 a[100:101], v14 offset:24608
    ds_read_b64_tr_b16 a[102:103], v14 offset:25632
    v_mfma_f32_32x32x16_bf16 v[80:95], a[120:123], a[112:115], v[80:95]
    s_waitcnt lgkmcnt(2)
    v_mfma_f32_32x32x16_bf16 v[32:47], a[96:99], a[88:91], v[32:47]
    ds_read_b128 a[108:111], v10 offset:8192
    ds_read_b64_tr_b16 a[116:117], v13 offset:28704
    v_mfma_f32_32x32x16_bf16 v[48:63], a[96:99], a[92:95], v[48:63]
    ds_read_b64_tr_b16 a[118:119], v13 offset:29728
    ds_read_b128 a[112:115], v10 offset:12288
    s_waitcnt lgkmcnt(4)
    v_mfma_f32_32x32x16_bf16 v[64:79], a[100:103], a[88:91], v[64:79]
    ds_read_b64_tr_b16 a[120:121], v14 offset:28704
    ds_read_b64_tr_b16 a[122:123], v14 offset:29728
    v_mfma_f32_32x32x16_bf16 v[80:95], a[100:103], a[92:95], v[80:95]
    s_waitcnt lgkmcnt(2)
    v_mfma_f32_32x32x16_bf16 v[32:47], a[116:119], a[108:111], v[32:47]
    ds_read_b128 a[88:91], v11 offset:8192
    ds_read_b64_tr_b16 a[96:97], v13 offset:32800
    v_mfma_f32_32x32x16_bf16 v[48:63], a[116:119], a[112:115], v[48:63]
    ds_read_b64_tr_b16 a[98:99], v13 offset:33824
    ds_read_b128 a[92:95], v11 offset:12288
    s_waitcnt lgkmcnt(4)
    v_mfma_f32_32x32x16_bf16 v[64:79], a[120:123], a[108:111], v[64:79]
    ds_read_b64_tr_b16 a[100:101], v14 offset:32800
    ds_read_b64_tr_b16 a[102:103], v14 offset:33824
    v_mfma_f32_32x32x16_bf16 v[80:95], a[120:123], a[112:115], v[80:95]
    s_waitcnt lgkmcnt(2)
    v_mfma_f32_32x32x16_bf16 v[32:47], a[96:99], a[88:91], v[32:47]
    ds_read_b128 a[108:111], v12 offset:8192
    ds_read_b64_tr_b16 a[116:117], v13 offset:36896
    v_mfma_f32_32x32x16_bf16 v[48:63], a[96:99], a[92:95], v[48:63]
    ds_read_b64_tr_b16 a[118:119], v13 offset:37920
    ds_read_b128 a[112:115], v12 offset:12288
    s_waitcnt lgkmcnt(4)
    v_mfma_f32_32x32x16_bf16 v[64:79], a[100:103], a[88:91], v[64:79]
    ds_read_b64_tr_b16 a[120:121], v14 offset:36896
    ds_read_b64_tr_b16 a[122:123], v14 offset:37920
    v_mfma_f32_32x32x16_bf16 v[80:95], a[100:103], a[92:95], v[80:95]
    s_waitcnt lgkmcnt(2)
    v_mfma_f32_32x32x16_bf16 v[32:47], a[116:119], a[108:111], v[32:47]
    s_waitcnt lgkmcnt(0)
    s_barrier
    ds_read_b128 a[88:91], v9 offset:16384
    ds_read_b64_tr_b16 a[96:97], v13 offset:49216
    v_mfma_f32_32x32x16_bf16 v[48:63], a[116:119], a[112:115], v[48:63]
    ds_read_b64_tr_b16 a[98:99], v13 offset:50240
    ds_read_b128 a[92:95], v9 offset:20480
    v_mfma_f32_32x32x16_bf16 v[64:79], a[120:123], a[108:111], v[64:79]
    ds_read_b64_tr_b16 a[100:101], v14 offset:49216
    ds_read_b64_tr_b16 a[102:103], v14 offset:50240
    v_mfma_f32_32x32x16_bf16 v[80:95], a[120:123], a[112:115], v[80:95]
    s_waitcnt lgkmcnt(2)
    v_mfma_f32_32x32x16_bf16 v[32:47], a[96:99], a[88:91], v[32:47]
    ds_read_b128 a[108:111], v10 offset:16384
    ds_read_b64_tr_b16 a[116:117], v13 offset:53312
    v_mfma_f32_32x32x16_bf16 v[48:63], a[96:99], a[92:95], v[48:63]
    ds_read_b64_tr_b16 a[118:119], v13 offset:54336
    ds_read_b128 a[112:115], v10 offset:20480
    s_waitcnt lgkmcnt(4)
    v_mfma_f32_32x32x16_bf16 v[64:79], a[100:103], a[88:91], v[64:79]
    ds_read_b64_tr_b16 a[120:121], v14 offset:53312
    ds_read_b64_tr_b16 a[122:123], v14 offset:54336
    v_mfma_f32_32x32x16_bf16 v[80:95], a[100:103], a[92:95], v[80:95]
    s_waitcnt lgkmcnt(2)
    v_mfma_f32_32x32x16_bf16 v[32:47], a[116:119], a[108:111], v[32:47]
    ds_read_b128 a[88:91], v11 offset:16384
    ds_read_b64_tr_b16 a[96:97], v13 offset:57408
    v_mfma_f32_32x32x16_bf16 v[48:63], a[116:119], a[112:115], v[48:63]
    ds_read_b64_tr_b16 a[98:99], v13 offset:58432
    ds_read_b128 a[92:95], v11 offset:20480
    s_waitcnt lgkmcnt(4)
    v_mfma_f32_32x32x16_bf16 v[64:79], a[120:123], a[108:111], v[64:79]
    ds_read_b64_tr_b16 a[100:101], v14 offset:57408
    ds_read_b64_tr_b16 a[102:103], v14 offset:58432
    v_mfma_f32_32x32x16_bf16 v[80:95], a[120:123], a[112:115], v[80:95]
    s_waitcnt lgkmcnt(2)
    v_mfma_f32_32x32x16_bf16 v[32:47], a[96:99], a[88:91], v[32:47]
    ds_read_b128 a[108:111], v12 offset:16384
    ds_read_b64_tr_b16 a[116:117], v13 offset:61504
    v_mfma_f32_32x32x16_bf16 v[48:63], a[96:99], a[92:95], v[48:63]
    ds_read_b64_tr_b16 a[118:119], v13 offset:62528
    ds_read_b128 a[112:115], v12 offset:20480
    s_waitcnt lgkmcnt(4)
    v_mfma_f32_32x32x16_bf16 v[64:79], a[100:103], a[88:91], v[64:79]
    ds_read_b64_tr_b16 a[120:121], v14 offset:61504
    ds_read_b64_tr_b16 a[122:123], v14 offset:62528
    v_mfma_f32_32x32x16_bf16 v[80:95], a[100:103], a[92:95], v[80:95]
    s_waitcnt lgkmcnt(2)
    v_mfma_f32_32x32x16_bf16 v[32:47], a[116:119], a[108:111], v[32:47]
    s_waitcnt lgkmcnt(0)
    s_barrier
    ds_read_b128 a[88:91], v9 offset:24576
    ds_read_b64_tr_b16 a[96:97], v13 offset:0
    v_mfma_f32_32x32x16_bf16 v[48:63], a[116:119], a[112:115], v[48:63]
    ds_read_b64_tr_b16 a[98:99], v13 offset:1024
    ds_read_b128 a[92:95], v9 offset:28672
    v_mfma_f32_32x32x16_bf16 v[64:79], a[120:123], a[108:111], v[64:79]
    ds_read_b64_tr_b16 a[100:101], v14 offset:0
    ds_read_b64_tr_b16 a[102:103], v14 offset:1024
    v_mfma_f32_32x32x16_bf16 v[80:95], a[120:123], a[112:115], v[80:95]
    s_waitcnt lgkmcnt(2)
    v_mfma_f32_32x32x16_bf16 v[32:47], a[96:99], a[88:91], v[32:47]
    ds_read_b128 a[108:111], v10 offset:24576
    ds_read_b64_tr_b16 a[116:117], v13 offset:4096
    v_mfma_f32_32x32x16_bf16 v[48:63], a[96:99], a[92:95], v[48:63]
    ds_read_b64_tr_b16 a[118:119], v13 offset:5120
    ds_read_b128 a[112:115], v10 offset:28672
    s_waitcnt lgkmcnt(4)
    v_mfma_f32_32x32x16_bf16 v[64:79], a[100:103], a[88:91], v[64:79]
    ds_read_b64_tr_b16 a[120:121], v14 offset:4096
    ds_read_b64_tr_b16 a[122:123], v14 offset:5120
    v_mfma_f32_32x32x16_bf16 v[80:95], a[100:103], a[92:95], v[80:95]
    s_waitcnt lgkmcnt(2)
    v_mfma_f32_32x32x16_bf16 v[32:47], a[116:119], a[108:111], v[32:47]
    ds_read_b128 a[88:91], v11 offset:24576
    ds_read_b64_tr_b16 a[96:97], v13 offset:8192
    v_mfma_f32_32x32x16_bf16 v[48:63], a[116:119], a[112:115], v[48:63]
    ds_read_b64_tr_b16 a[98:99], v13 offset:9216
    ds_read_b128 a[92:95], v11 offset:28672
    s_waitcnt lgkmcnt(4)
    v_mfma_f32_32x32x16_bf16 v[64:79], a[120:123], a[108:111], v[64:79]
    ds_read_b64_tr_b16 a[100:101], v14 offset:8192
    ds_read_b64_tr_b16 a[102:103], v14 offset:9216
    v_mfma_f32_32x32x16_bf16 v[80:95], a[120:123], a[112:115], v[80:95]
    s_waitcnt lgkmcnt(2)
    v_mfma_f32_32x32x16_bf16 v[32:47], a[96:99], a[88:91], v[32:47]
    ds_read_b128 a[108:111], v12 offset:24576
    ds_read_b64_tr_b16 a[116:117], v13 offset:12288
    v_mfma_f32_32x32x16_bf16 v[48:63], a[96:99], a[92:95], v[48:63]
    ds_read_b64_tr_b16 a[118:119], v13 offset:13312
    ds_read_b128 a[112:115], v12 offset:28672
    s_waitcnt lgkmcnt(4)
    v_mfma_f32_32x32x16_bf16 v[64:79], a[100:103], a[88:91], v[64:79]
    ds_read_b64_tr_b16 a[120:121], v14 offset:12288
    ds_read_b64_tr_b16 a[122:123], v14 offset:13312
    v_mfma_f32_32x32x16_bf16 v[80:95], a[100:103], a[92:95], v[80:95]
    s_waitcnt lgkmcnt(2)
    v_mfma_f32_32x32x16_bf16 v[32:47], a[116:119], a[108:111], v[32:47]
    s_waitcnt lgkmcnt(0)
    s_barrier
    ds_read_b128 a[88:91], v9 offset:32768
    ds_read_b64_tr_b16 a[96:97], v13 offset:24608
    v_mfma_f32_32x32x16_bf16 v[48:63], a[116:119], a[112:115], v[48:63]
    ds_read_b64_tr_b16 a[98:99], v13 offset:25632
    ds_read_b128 a[92:95], v9 offset:36864
    v_mfma_f32_32x32x16_bf16 v[64:79], a[120:123], a[108:111], v[64:79]
    ds_read_b64_tr_b16 a[100:101], v14 offset:24608
    ds_read_b64_tr_b16 a[102:103], v14 offset:25632
    v_mfma_f32_32x32x16_bf16 v[80:95], a[120:123], a[112:115], v[80:95]
    s_waitcnt lgkmcnt(2)
    v_mfma_f32_32x32x16_bf16 v[32:47], a[96:99], a[88:91], v[32:47]
    ds_read_b128 a[108:111], v10 offset:32768
    ds_read_b64_tr_b16 a[116:117], v13 offset:28704
    v_mfma_f32_32x32x16_bf16 v[48:63], a[96:99], a[92:95], v[48:63]
    ds_read_b64_tr_b16 a[118:119], v13 offset:29728
    ds_read_b128 a[112:115], v10 offset:36864
    s_waitcnt lgkmcnt(4)
    v_mfma_f32_32x32x16_bf16 v[64:79], a[100:103], a[88:91], v[64:79]
    ds_read_b64_tr_b16 a[120:121], v14 offset:28704
    ds_read_b64_tr_b16 a[122:123], v14 offset:29728
    v_mfma_f32_32x32x16_bf16 v[80:95], a[100:103], a[92:95], v[80:95]
    s_waitcnt lgkmcnt(2)
    v_mfma_f32_32x32x16_bf16 v[32:47], a[116:119], a[108:111], v[32:47]
    ds_read_b128 a[88:91], v11 offset:32768
    ds_read_b64_tr_b16 a[96:97], v13 offset:32800
    v_mfma_f32_32x32x16_bf16 v[48:63], a[116:119], a[112:115], v[48:63]
    ds_read_b64_tr_b16 a[98:99], v13 offset:33824
    ds_read_b128 a[92:95], v11 offset:36864
    s_waitcnt lgkmcnt(4)
    v_mfma_f32_32x32x16_bf16 v[64:79], a[120:123], a[108:111], v[64:79]
    ds_read_b64_tr_b16 a[100:101], v14 offset:32800
    ds_read_b64_tr_b16 a[102:103], v14 offset:33824
    v_mfma_f32_32x32x16_bf16 v[80:95], a[120:123], a[112:115], v[80:95]
    s_waitcnt lgkmcnt(2)
    v_mfma_f32_32x32x16_bf16 v[32:47], a[96:99], a[88:91], v[32:47]
    ds_read_b128 a[108:111], v12 offset:32768
    ds_read_b64_tr_b16 a[116:117], v13 offset:36896
    v_mfma_f32_32x32x16_bf16 v[48:63], a[96:99], a[92:95], v[48:63]
    ds_read_b64_tr_b16 a[118:119], v13 offset:37920
    ds_read_b128 a[112:115], v12 offset:36864
    s_waitcnt lgkmcnt(4)
    v_mfma_f32_32x32x16_bf16 v[64:79], a[100:103], a[88:91], v[64:79]
    ds_read_b64_tr_b16 a[120:121], v14 offset:36896
    ds_read_b64_tr_b16 a[122:123], v14 offset:37920
    v_mfma_f32_32x32x16_bf16 v[80:95], a[100:103], a[92:95], v[80:95]
    s_waitcnt lgkmcnt(2)
    v_mfma_f32_32x32x16_bf16 v[32:47], a[116:119], a[108:111], v[32:47]
    s_waitcnt lgkmcnt(0)
    s_barrier
    ds_read_b128 a[88:91], v9 offset:0
    ds_read_b64_tr_b16 a[96:97], v13 offset:49216
    v_mfma_f32_32x32x16_bf16 v[48:63], a[116:119], a[112:115], v[48:63]
    ds_read_b64_tr_b16 a[98:99], v13 offset:50240
    ds_read_b128 a[92:95], v9 offset:4096
    v_mfma_f32_32x32x16_bf16 v[64:79], a[120:123], a[108:111], v[64:79]
    ds_read_b64_tr_b16 a[100:101], v14 offset:49216
    ds_read_b64_tr_b16 a[102:103], v14 offset:50240
    v_mfma_f32_32x32x16_bf16 v[80:95], a[120:123], a[112:115], v[80:95]
    s_waitcnt lgkmcnt(2)
    v_mfma_f32_32x32x16_bf16 v[32:47], a[96:99], a[88:91], v[32:47]
    ds_read_b128 a[108:111], v10 offset:0
    ds_read_b64_tr_b16 a[116:117], v13 offset:53312
    v_mfma_f32_32x32x16_bf16 v[48:63], a[96:99], a[92:95], v[48:63]
    ds_read_b64_tr_b16 a[118:119], v13 offset:54336
    ds_read_b128 a[112:115], v10 offset:4096
    s_waitcnt lgkmcnt(4)
    v_mfma_f32_32x32x16_bf16 v[64:79], a[100:103], a[88:91], v[64:79]
    ds_read_b64_tr_b16 a[120:121], v14 offset:53312
    ds_read_b64_tr_b16 a[122:123], v14 offset:54336
    v_mfma_f32_32x32x16_bf16 v[80:95], a[100:103], a[92:95], v[80:95]
    s_waitcnt lgkmcnt(2)
    v_mfma_f32_32x32x16_bf16 v[32:47], a[116:119], a[108:111], v[32:47]
    ds_read_b128 a[88:91], v11 offset:0
    ds_read_b64_tr_b16 a[96:97], v13 offset:57408
    v_mfma_f32_32x32x16_bf16 v[48:63], a[116:119], a[112:115], v[48:63]
    ds_read_b64_tr_b16 a[98:99], v13 offset:58432
    ds_read_b128 a[92:95], v11 offset:4096
    s_waitcnt lgkmcnt(4)
    v_mfma_f32_32x32x16_bf16 v[64:79], a[120:123], a[108:111], v[64:79]
    ds_read_b64_tr_b16 a[100:101], v14 offset:57408
    ds_read_b64_tr_b16 a[102:103], v14 offset:58432
    v_mfma_f32_32x32x16_bf16 v[80:95], a[120:123], a[112:115], v[80:95]
    s_waitcnt lgkmcnt(2)
    v_mfma_f32_32x32x16_bf16 v[32:47], a[96:99], a[88:91], v[32:47]
    ds_read_b128 a[108:111], v12 offset:0
    ds_read_b64_tr_b16 a[116:117], v13 offset:61504
    v_mfma_f32_32x32x16_bf16 v[48:63], a[96:99], a[92:95], v[48:63]
    ds_read_b64_tr_b16 a[118:119], v13 offset:62528
    ds_read_b128 a[112:115], v12 offset:4096
    s_waitcnt lgkmcnt(4)
    v_mfma_f32_32x32x16_bf16 v[64:79], a[100:103], a[88:91], v[64:79]
    ds_read_b64_tr_b16 a[120:121], v14 offset:61504
    ds_read_b64_tr_b16 a[122:123], v14 offset:62528
    v_mfma_f32_32x32x16_bf16 v[80:95], a[100:103], a[92:95], v[80:95]
    s_waitcnt lgkmcnt(2)
    v_mfma_f32_32x32x16_bf16 v[32:47], a[116:119], a[108:111], v[32:47]
    s_waitcnt lgkmcnt(0)
    s_barrier
    ds_read_b128 a[88:91], v9 offset:8192
    ds_read_b64_tr_b16 a[96:97], v13 offset:0
    v_mfma_f32_32x32x16_bf16 v[48:63], a[116:119], a[112:115], v[48:63]
    ds_read_b64_tr_b16 a[98:99], v13 offset:1024
    ds_read_b128 a[92:95], v9 offset:12288
    v_mfma_f32_32x32x16_bf16 v[64:79], a[120:123], a[108:111], v[64:79]
    ds_read_b64_tr_b16 a[100:101], v14 offset:0
    ds_read_b64_tr_b16 a[102:103], v14 offset:1024
    v_mfma_f32_32x32x16_bf16 v[80:95], a[120:123], a[112:115], v[80:95]
    s_waitcnt lgkmcnt(2)
    v_mfma_f32_32x32x16_bf16 v[32:47], a[96:99], a[88:91], v[32:47]
    ds_read_b128 a[108:111], v10 offset:8192
    ds_read_b64_tr_b16 a[116:117], v13 offset:4096
    v_mfma_f32_32x32x16_bf16 v[48:63], a[96:99], a[92:95], v[48:63]
    ds_read_b64_tr_b16 a[118:119], v13 offset:5120
    ds_read_b128 a[112:115], v10 offset:12288
    s_waitcnt lgkmcnt(4)
    v_mfma_f32_32x32x16_bf16 v[64:79], a[100:103], a[88:91], v[64:79]
    ds_read_b64_tr_b16 a[120:121], v14 offset:4096
    ds_read_b64_tr_b16 a[122:123], v14 offset:5120
    v_mfma_f32_32x32x16_bf16 v[80:95], a[100:103], a[92:95], v[80:95]
    s_waitcnt lgkmcnt(2)
    v_mfma_f32_32x32x16_bf16 v[32:47], a[116:119], a[108:111], v[32:47]
    ds_read_b128 a[88:91], v11 offset:8192
    ds_read_b64_tr_b16 a[96:97], v13 offset:8192
    v_mfma_f32_32x32x16_bf16 v[48:63], a[116:119], a[112:115], v[48:63]
    ds_read_b64_tr_b16 a[98:99], v13 offset:9216
    ds_read_b128 a[92:95], v11 offset:12288
    s_waitcnt lgkmcnt(4)
    v_mfma_f32_32x32x16_bf16 v[64:79], a[120:123], a[108:111], v[64:79]
    ds_read_b64_tr_b16 a[100:101], v14 offset:8192
    ds_read_b64_tr_b16 a[102:103], v14 offset:9216
    v_mfma_f32_32x32x16_bf16 v[80:95], a[120:123], a[112:115], v[80:95]
    s_waitcnt lgkmcnt(2)
    v_mfma_f32_32x32x16_bf16 v[32:47], a[96:99], a[88:91], v[32:47]
    ds_read_b128 a[108:111], v12 offset:8192
    ds_read_b64_tr_b16 a[116:117], v13 offset:12288
    v_mfma_f32_32x32x16_bf16 v[48:63], a[96:99], a[92:95], v[48:63]
    ds_read_b64_tr_b16 a[118:119], v13 offset:13312
    ds_read_b128 a[112:115], v12 offset:12288
    s_waitcnt lgkmcnt(4)
    v_mfma_f32_32x32x16_bf16 v[64:79], a[100:103], a[88:91], v[64:79]
    ds_read_b64_tr_b16 a[120:121], v14 offset:12288
    ds_read_b64_tr_b16 a[122:123], v14 offset:13312
    v_mfma_f32_32x32x16_bf16 v[80:95], a[100:103], a[92:95], v[80:95]
    s_waitcnt lgkmcnt(2)
    v_mfma_f32_32x32x16_bf16 v[32:47], a[116:119], a[108:111], v[32:47]
    s_waitcnt lgkmcnt(0)
    s_barrier
    ds_read_b128 a[88:91], v9 offset:16384
    ds_read_b64_tr_b16 a[96:97], v13 offset:24608
    v_mfma_f32_32x32x16_bf16 v[48:63], a[116:119], a[112:115], v[48:63]
    ds_read_b64_tr_b16 a[98:99], v13 offset:25632
    ds_read_b128 a[92:95], v9 offset:20480
    v_mfma_f32_32x32x16_bf16 v[64:79], a[120:123], a[108:111], v[64:79]
    ds_read_b64_tr_b16 a[100:101], v14 offset:24608
    ds_read_b64_tr_b16 a[102:103], v14 offset:25632
    v_mfma_f32_32x32x16_bf16 v[80:95], a[120:123], a[112:115], v[80:95]
    s_waitcnt lgkmcnt(2)
    v_mfma_f32_32x32x16_bf16 v[32:47], a[96:99], a[88:91], v[32:47]
    ds_read_b128 a[108:111], v10 offset:16384
    ds_read_b64_tr_b16 a[116:117], v13 offset:28704
    v_mfma_f32_32x32x16_bf16 v[48:63], a[96:99], a[92:95], v[48:63]
    ds_read_b64_tr_b16 a[118:119], v13 offset:29728
    ds_read_b128 a[112:115], v10 offset:20480
    s_waitcnt lgkmcnt(4)
    v_mfma_f32_32x32x16_bf16 v[64:79], a[100:103], a[88:91], v[64:79]
    ds_read_b64_tr_b16 a[120:121], v14 offset:28704
    ds_read_b64_tr_b16 a[122:123], v14 offset:29728
    v_mfma_f32_32x32x16_bf16 v[80:95], a[100:103], a[92:95], v[80:95]
    s_waitcnt lgkmcnt(2)
    v_mfma_f32_32x32x16_bf16 v[32:47], a[116:119], a[108:111], v[32:47]
    ds_read_b128 a[88:91], v11 offset:16384
    ds_read_b64_tr_b16 a[96:97], v13 offset:32800
    v_mfma_f32_32x32x16_bf16 v[48:63], a[116:119], a[112:115], v[48:63]
    ds_read_b64_tr_b16 a[98:99], v13 offset:33824
    ds_read_b128 a[92:95], v11 offset:20480
    s_waitcnt lgkmcnt(4)
    v_mfma_f32_32x32x16_bf16 v[64:79], a[120:123], a[108:111], v[64:79]
    ds_read_b64_tr_b16 a[100:101], v14 offset:32800
    ds_read_b64_tr_b16 a[102:103], v14 offset:33824
    v_mfma_f32_32x32x16_bf16 v[80:95], a[120:123], a[112:115], v[80:95]
    s_waitcnt lgkmcnt(2)
    v_mfma_f32_32x32x16_bf16 v[32:47], a[96:99], a[88:91], v[32:47]
    ds_read_b128 a[108:111], v12 offset:16384
    ds_read_b64_tr_b16 a[116:117], v13 offset:36896
    v_mfma_f32_32x32x16_bf16 v[48:63], a[96:99], a[92:95], v[48:63]
    ds_read_b64_tr_b16 a[118:119], v13 offset:37920
    ds_read_b128 a[112:115], v12 offset:20480
    s_waitcnt lgkmcnt(4)
    v_mfma_f32_32x32x16_bf16 v[64:79], a[100:103], a[88:91], v[64:79]
    ds_read_b64_tr_b16 a[120:121], v14 offset:36896
    ds_read_b64_tr_b16 a[122:123], v14 offset:37920
    v_mfma_f32_32x32x16_bf16 v[80:95], a[100:103], a[92:95], v[80:95]
    s_waitcnt lgkmcnt(2)
    v_mfma_f32_32x32x16_bf16 v[32:47], a[116:119], a[108:111], v[32:47]
    s_waitcnt lgkmcnt(0)
    s_barrier
    ds_read_b128 a[88:91], v9 offset:24576
    ds_read_b64_tr_b16 a[96:97], v13 offset:49216
    v_mfma_f32_32x32x16_bf16 v[48:63], a[116:119], a[112:115], v[48:63]
    ds_read_b64_tr_b16 a[98:99], v13 offset:50240
    ds_read_b128 a[92:95], v9 offset:28672
    v_mfma_f32_32x32x16_bf16 v[64:79], a[120:123], a[108:111], v[64:79]
    ds_read_b64_tr_b16 a[100:101], v14 offset:49216
    ds_read_b64_tr_b16 a[102:103], v14 offset:50240
    v_mfma_f32_32x32x16_bf16 v[80:95], a[120:123], a[112:115], v[80:95]
    s_waitcnt lgkmcnt(2)
    v_mfma_f32_32x32x16_bf16 v[32:47], a[96:99], a[88:91], v[32:47]
    ds_read_b128 a[108:111], v10 offset:24576
    ds_read_b64_tr_b16 a[116:117], v13 offset:53312
    v_mfma_f32_32x32x16_bf16 v[48:63], a[96:99], a[92:95], v[48:63]
    ds_read_b64_tr_b16 a[118:119], v13 offset:54336
    ds_read_b128 a[112:115], v10 offset:28672
    s_waitcnt lgkmcnt(4)
    v_mfma_f32_32x32x16_bf16 v[64:79], a[100:103], a[88:91], v[64:79]
    ds_read_b64_tr_b16 a[120:121], v14 offset:53312
    ds_read_b64_tr_b16 a[122:123], v14 offset:54336
    v_mfma_f32_32x32x16_bf16 v[80:95], a[100:103], a[92:95], v[80:95]
    s_waitcnt lgkmcnt(2)
    v_mfma_f32_32x32x16_bf16 v[32:47], a[116:119], a[108:111], v[32:47]
    ds_read_b128 a[88:91], v11 offset:24576
    ds_read_b64_tr_b16 a[96:97], v13 offset:57408
    v_mfma_f32_32x32x16_bf16 v[48:63], a[116:119], a[112:115], v[48:63]
    ds_read_b64_tr_b16 a[98:99], v13 offset:58432
    ds_read_b128 a[92:95], v11 offset:28672
    s_waitcnt lgkmcnt(4)
    v_mfma_f32_32x32x16_bf16 v[64:79], a[120:123], a[108:111], v[64:79]
    ds_read_b64_tr_b16 a[100:101], v14 offset:57408
    ds_read_b64_tr_b16 a[102:103], v14 offset:58432
    v_mfma_f32_32x32x16_bf16 v[80:95], a[120:123], a[112:115], v[80:95]
    s_waitcnt lgkmcnt(2)
    v_mfma_f32_32x32x16_bf16 v[32:47], a[96:99], a[88:91], v[32:47]
    ds_read_b128 a[108:111], v12 offset:24576
    ds_read_b64_tr_b16 a[116:117], v13 offset:61504
    v_mfma_f32_32x32x16_bf16 v[48:63], a[96:99], a[92:95], v[48:63]
    ds_read_b64_tr_b16 a[118:119], v13 offset:62528
    ds_read_b128 a[112:115], v12 offset:28672
    s_waitcnt lgkmcnt(4)
    v_mfma_f32_32x32x16_bf16 v[64:79], a[100:103], a[88:91], v[64:79]
    ds_read_b64_tr_b16 a[120:121], v14 offset:61504
    ds_read_b64_tr_b16 a[122:123], v14 offset:62528
    v_mfma_f32_32x32x16_bf16 v[80:95], a[100:103], a[92:95], v[80:95]
    s_waitcnt lgkmcnt(2)
    v_mfma_f32_32x32x16_bf16 v[32:47], a[116:119], a[108:111], v[32:47]
    s_waitcnt lgkmcnt(0)
    s_barrier
    ds_read_b128 a[88:91], v9 offset:32768
    ds_read_b64_tr_b16 a[96:97], v13 offset:0
    v_mfma_f32_32x32x16_bf16 v[48:63], a[116:119], a[112:115], v[48:63]
    ds_read_b64_tr_b16 a[98:99], v13 offset:1024
    ds_read_b128 a[92:95], v9 offset:36864
    v_mfma_f32_32x32x16_bf16 v[64:79], a[120:123], a[108:111], v[64:79]
    ds_read_b64_tr_b16 a[100:101], v14 offset:0
    ds_read_b64_tr_b16 a[102:103], v14 offset:1024
    v_mfma_f32_32x32x16_bf16 v[80:95], a[120:123], a[112:115], v[80:95]
    s_waitcnt lgkmcnt(2)
    v_mfma_f32_32x32x16_bf16 v[32:47], a[96:99], a[88:91], v[32:47]
    ds_read_b128 a[108:111], v10 offset:32768
    ds_read_b64_tr_b16 a[116:117], v13 offset:4096
    v_mfma_f32_32x32x16_bf16 v[48:63], a[96:99], a[92:95], v[48:63]
    ds_read_b64_tr_b16 a[118:119], v13 offset:5120
    ds_read_b128 a[112:115], v10 offset:36864
    s_waitcnt lgkmcnt(4)
    v_mfma_f32_32x32x16_bf16 v[64:79], a[100:103], a[88:91], v[64:79]
    ds_read_b64_tr_b16 a[120:121], v14 offset:4096
    ds_read_b64_tr_b16 a[122:123], v14 offset:5120
    v_mfma_f32_32x32x16_bf16 v[80:95], a[100:103], a[92:95], v[80:95]
    s_waitcnt lgkmcnt(2)
    v_mfma_f32_32x32x16_bf16 v[32:47], a[116:119], a[108:111], v[32:47]
    ds_read_b128 a[88:91], v11 offset:32768
    ds_read_b64_tr_b16 a[96:97], v13 offset:8192
    v_mfma_f32_32x32x16_bf16 v[48:63], a[116:119], a[112:115], v[48:63]
    ds_read_b64_tr_b16 a[98:99], v13 offset:9216
    ds_read_b128 a[92:95], v11 offset:36864
    s_waitcnt lgkmcnt(4)
    v_mfma_f32_32x32x16_bf16 v[64:79], a[120:123], a[108:111], v[64:79]
    ds_read_b64_tr_b16 a[100:101], v14 offset:8192
    ds_read_b64_tr_b16 a[102:103], v14 offset:9216
    v_mfma_f32_32x32x16_bf16 v[80:95], a[120:123], a[112:115], v[80:95]
    s_waitcnt lgkmcnt(2)
    v_mfma_f32_32x32x16_bf16 v[32:47], a[96:99], a[88:91], v[32:47]
    ds_read_b128 a[108:111], v12 offset:32768
    ds_read_b64_tr_b16 a[116:117], v13 offset:12288
    v_mfma_f32_32x32x16_bf16 v[48:63], a[96:99], a[92:95], v[48:63]
    ds_read_b64_tr_b16 a[118:119], v13 offset:13312
    ds_read_b128 a[112:115], v12 offset:36864
    s_waitcnt lgkmcnt(4)
    v_mfma_f32_32x32x16_bf16 v[64:79], a[100:103], a[88:91], v[64:79]
    ds_read_b64_tr_b16 a[120:121], v14 offset:12288
    ds_read_b64_tr_b16 a[122:123], v14 offset:13312
    v_mfma_f32_32x32x16_bf16 v[80:95], a[100:103], a[92:95], v[80:95]
    s_waitcnt lgkmcnt(2)
    v_mfma_f32_32x32x16_bf16 v[32:47], a[116:119], a[108:111], v[32:47]
    s_waitcnt lgkmcnt(0)
    ds_write_b32 v21, v22
    v_mfma_f32_32x32x16_bf16 v[48:63], a[116:119], a[112:115], v[48:63]
    v_mfma_f32_32x32x16_bf16 v[64:79], a[120:123], a[108:111], v[64:79]
    v_mfma_f32_32x32x16_bf16 v[80:95], a[120:123], a[112:115], v[80:95]
    s_setprio 3
    s_lshl_b32 s52, s46, 1
    s_add_u32 s52, s52, s26
    s_lshl_b32 s52, s52, 1
    s_mul_i32 s53, s3, 52
    s_lshr_b32 s53, s53, 8
    s_mul_i32 s53, s53, 5
    s_sub_u32 s53, s3, s53
    s_lshl_b32 s54, s53, 1
    s_add_u32 s54, s54, s27
    s_lshl_b32 s54, s54, 1
    s_cmp_lt_u32 s3, 5
    s_cselect_b32 s67, 40960, 0
    s_cselect_b32 s53, 0x3ea52b5c, 1.0
    s_cselect_b32 s66, 0, 3145728
    s_cbranch_scc1 L_epi_q
    s_mov_b32 s67, 82560
L_epi_q:
    s_mul_i32 s52, s52, s67
    s_add_u32 s66, s66, s52
    s_lshl_b32 s54, s54, 11
    s_add_u32 s66, s66, s54
    s_add_u32 s67, s67, s66
    v_lshlrev_b32 v101, 4, v1
    v_mov_b32 v102, s53
    v_mov_b32 v103, s53
    v_pk_mul_f32 v[32:33], v[32:33], v[102:103]
    v_pk_mul_f32 v[34:35], v[34:35], v[102:103]
    v_pk_mul_f32 v[36:37], v[36:37], v[102:103]
    v_pk_mul_f32 v[38:39], v[38:39], v[102:103]
    v_cvt_pk_bf16_f32 v24, v32, v33
    v_cvt_pk_bf16_f32 v25, v34, v35
    v_cvt_pk_bf16_f32 v26, v36, v37
    v_cvt_pk_bf16_f32 v27, v38, v39
    buffer_store_dwordx4 v[24:27], v101, s[36:39], s66 offen offset:0 sc1
    v_pk_mul_f32 v[40:41], v[40:41], v[102:103]
    v_pk_mul_f32 v[42:43], v[42:43], v[102:103]
    v_pk_mul_f32 v[44:45], v[44:45], v[102:103]
    v_pk_mul_f32 v[46:47], v[46:47], v[102:103]
    v_cvt_pk_bf16_f32 v28, v40, v41
    v_cvt_pk_bf16_f32 v29, v42, v43
    v_cvt_pk_bf16_f32 v30, v44, v45
    v_cvt_pk_bf16_f32 v31, v46, v47
    buffer_store_dwordx4 v[28:31], v101, s[36:39], s66 offen offset:1024 sc1
    v_pk_mul_f32 v[64:65], v[64:65], v[102:103]
    v_pk_mul_f32 v[66:67], v[66:67], v[102:103]
    v_pk_mul_f32 v[68:69], v[68:69], v[102:103]
    v_pk_mul_f32 v[70:71], v[70:71], v[102:103]
    v_cvt_pk_bf16_f32 v24, v64, v65
    v_cvt_pk_bf16_f32 v25, v66, v67
    v_cvt_pk_bf16_f32 v26, v68, v69
    v_cvt_pk_bf16_f32 v27, v70, v71
    buffer_store_dwordx4 v[24:27], v101, s[36:39], s66 offen offset:2048 sc1
    v_pk_mul_f32 v[72:73], v[72:73], v[102:103]
    v_pk_mul_f32 v[74:75], v[74:75], v[102:103]
    v_pk_mul_f32 v[76:77], v[76:77], v[102:103]
    v_pk_mul_f32 v[78:79], v[78:79], v[102:103]
    v_cvt_pk_bf16_f32 v28, v72, v73
    v_cvt_pk_bf16_f32 v29, v74, v75
    v_cvt_pk_bf16_f32 v30, v76, v77
    v_cvt_pk_bf16_f32 v31, v78, v79
    buffer_store_dwordx4 v[28:31], v101, s[36:39], s66 offen offset:3072 sc1
    v_pk_mul_f32 v[48:49], v[48:49], v[102:103]
    v_pk_mul_f32 v[50:51], v[50:51], v[102:103]
    v_pk_mul_f32 v[52:53], v[52:53], v[102:103]
    v_pk_mul_f32 v[54:55], v[54:55], v[102:103]
    v_cvt_pk_bf16_f32 v24, v48, v49
    v_cvt_pk_bf16_f32 v25, v50, v51
    v_cvt_pk_bf16_f32 v26, v52, v53
    v_cvt_pk_bf16_f32 v27, v54, v55
    buffer_store_dwordx4 v[24:27], v101, s[36:39], s67 offen offset:0 sc1
    v_pk_mul_f32 v[56:57], v[56:57], v[102:103]
    v_pk_mul_f32 v[58:59], v[58:59], v[102:103]
    v_pk_mul_f32 v[60:61], v[60:61], v[102:103]
    v_pk_mul_f32 v[62:63], v[62:63], v[102:103]
    v_cvt_pk_bf16_f32 v28, v56, v57
    v_cvt_pk_bf16_f32 v29, v58, v59
    v_cvt_pk_bf16_f32 v30, v60, v61
    v_cvt_pk_bf16_f32 v31, v62, v63
    buffer_store_dwordx4 v[28:31], v101, s[36:39], s67 offen offset:1024 sc1
    v_pk_mul_f32 v[80:81], v[80:81], v[102:103]
    v_pk_mul_f32 v[82:83], v[82:83], v[102:103]
    v_pk_mul_f32 v[84:85], v[84:85], v[102:103]
    v_pk_mul_f32 v[86:87], v[86:87], v[102:103]
    v_cvt_pk_bf16_f32 v24, v80, v81
    v_cvt_pk_bf16_f32 v25, v82, v83
    v_cvt_pk_bf16_f32 v26, v84, v85
    v_cvt_pk_bf16_f32 v27, v86, v87
    buffer_store_dwordx4 v[24:27], v101, s[36:39], s67 offen offset:2048 sc1
    v_pk_mul_f32 v[88:89], v[88:89], v[102:103]
    v_pk_mul_f32 v[90:91], v[90:91], v[102:103]
    v_pk_mul_f32 v[92:93], v[92:93], v[102:103]
    v_pk_mul_f32 v[94:95], v[94:95], v[102:103]
    v_cvt_pk_bf16_f32 v28, v88, v89
    v_cvt_pk_bf16_f32 v29, v90, v91
    v_cvt_pk_bf16_f32 v30, v92, v93
    v_cvt_pk_bf16_f32 v31, v94, v95
    buffer_store_dwordx4 v[28:31], v101, s[36:39], s67 offen offset:3072 sc1
    s_branch L_A_r2
L_A_v:
    ds_read_b128 a[88:91], v9 offset:0
    ds_read_b64_tr_b16 a[96:97], v13 offset:0
    ds_read_b64_tr_b16 a[98:99], v13 offset:1024
    ds_read_b128 a[92:95], v9 offset:4096
    ds_read_b64_tr_b16 a[100:101], v14 offset:0
    ds_read_b64_tr_b16 a[102:103], v14 offset:1024
    s_waitcnt lgkmcnt(2)
    v_mfma_f32_32x32x16_bf16 v[32:47], a[88:91], a[96:99], 0
    ds_read_b128 a[108:111], v10 offset:0
    ds_read_b64_tr_b16 a[116:117], v13 offset:4096
    v_mfma_f32_32x32x16_bf16 v[48:63], a[92:95], a[96:99], 0
    ds_read_b64_tr_b16 a[118:119], v13 offset:5120
    ds_read_b128 a[112:115], v10 offset:4096
    s_waitcnt lgkmcnt(4)
    v_mfma_f32_32x32x16_bf16 v[64:79], a[88:91], a[100:103], 0
    ds_read_b64_tr_b16 a[120:121], v14 offset:4096
    ds_read_b64_tr_b16 a[122:123], v14 offset:5120
    v_mfma_f32_32x32x16_bf16 v[80:95], a[92:95], a[100:103], 0
    s_waitcnt lgkmcnt(2)
    v_mfma_f32_32x32x16_bf16 v[32:47], a[108:111], a[116:119], v[32:47]
    ds_read_b128 a[88:91], v11 offset:0
    ds_read_b64_tr_b16 a[96:97], v13 offset:8192
    v_mfma_f32_32x32x16_bf16 v[48:63], a[112:115], a[116:119], v[48:63]
    ds_read_b64_tr_b16 a[98:99], v13 offset:9216
    ds_read_b128 a[92:95], v11 offset:4096
    s_waitcnt lgkmcnt(4)
    v_mfma_f32_32x32x16_bf16 v[64:79], a[108:111], a[120:123], v[64:79]
    ds_read_b64_tr_b16 a[100:101], v14 offset:8192
    ds_read_b64_tr_b16 a[102:103], v14 offset:9216
    v_mfma_f32_32x32x16_bf16 v[80:95], a[112:115], a[120:123], v[80:95]
    s_waitcnt lgkmcnt(2)
    v_mfma_f32_32x32x16_bf16 v[32:47], a[88:91], a[96:99], v[32:47]
    ds_read_b128 a[108:111], v12 offset:0
    ds_read_b64_tr_b16 a[116:117], v13 offset:12288
    v_mfma_f32_32x32x16_bf16 v[48:63], a[92:95], a[96:99], v[48:63]
    ds_read_b64_tr_b16 a[118:119], v13 offset:13312
    ds_read_b128 a[112:115], v12 offset:4096
    s_waitcnt lgkmcnt(4)
    v_mfma_f32_32x32x16_bf16 v[64:79], a[88:91], a[100:103], v[64:79]
    ds_read_b64_tr_b16 a[120:121], v14 offset:12288
    ds_read_b64_tr_b16 a[122:123], v14 offset:13312
    v_mfma_f32_32x32x16_bf16 v[80:95], a[92:95], a[100:103], v[80:95]
    s_waitcnt lgkmcnt(2)
    v_mfma_f32_32x32x16_bf16 v[32:47], a[108:111], a[116:119], v[32:47]
    s_waitcnt lgkmcnt(0)
    s_barrier
    ds_read_b128 a[88:91], v9 offset:8192
    ds_read_b64_tr_b16 a[96:97], v13 offset:24608
    v_mfma_f32_32x32x16_bf16 v[48:63], a[112:115], a[116:119], v[48:63]
    ds_read_b64_tr_b16 a[98:99], v13 offset:25632
    ds_read_b128 a[92:95], v9 offset:12288
    v_mfma_f32_32x32x16_bf16 v[64:79], a[108:111], a[120:123], v[64:79]
    ds_read_b64_tr_b16 a[100:101], v14 offset:24608
    ds_read_b64_tr_b16 a[102:103], v14 offset:25632
    v_mfma_f32_32x32x16_bf16 v[80:95], a[112:115], a[120:123], v[80:95]
    s_waitcnt lgkmcnt(2)
    v_mfma_f32_32x32x16_bf16 v[32:47], a[88:91], a[96:99], v[32:47]
    ds_read_b128 a[108:111], v10 offset:8192
    ds_read_b64_tr_b16 a[116:117], v13 offset:28704
    v_mfma_f32_32x32x16_bf16 v[48:63], a[92:95], a[96:99], v[48:63]
    ds_read_b64_tr_b16 a[118:119], v13 offset:29728
    ds_read_b128 a[112:115], v10 offset:12288
    s_waitcnt lgkmcnt(4)
    v_mfma_f32_32x32x16_bf16 v[64:79], a[88:91], a[100:103], v[64:79]
    ds_read_b64_tr_b16 a[120:121], v14 offset:28704
    ds_read_b64_tr_b16 a[122:123], v14 offset:29728
    v_mfma_f32_32x32x16_bf16 v[80:95], a[92:95], a[100:103], v[80:95]
    s_waitcnt lgkmcnt(2)
    v_mfma_f32_32x32x16_bf16 v[32:47], a[108:111], a[116:119], v[32:47]
    ds_read_b128 a[88:91], v11 offset:8192
    ds_read_b64_tr_b16 a[96:97], v13 offset:32800
    v_mfma_f32_32x32x16_bf16 v[48:63], a[112:115], a[116:119], v[48:63]
    ds_read_b64_tr_b16 a[98:99], v13 offset:33824
    ds_read_b128 a[92:95], v11 offset:12288
    s_waitcnt lgkmcnt(4)
    v_mfma_f32_32x32x16_bf16 v[64:79], a[108:111], a[120:123], v[64:79]
    ds_read_b64_tr_b16 a[100:101], v14 offset:32800
    ds_read_b64_tr_b16 a[102:103], v14 offset:33824
    v_mfma_f32_32x32x16_bf16 v[80:95], a[112:115], a[120:123], v[80:95]
    s_waitcnt lgkmcnt(2)
    v_mfma_f32_32x32x16_bf16 v[32:47], a[88:91], a[96:99], v[32:47]
    ds_read_b128 a[108:111], v12 offset:8192
    ds_read_b64_tr_b16 a[116:117], v13 offset:36896
    v_mfma_f32_32x32x16_bf16 v[48:63], a[92:95], a[96:99], v[48:63]
    ds_read_b64_tr_b16 a[118:119], v13 offset:37920
    ds_read_b128 a[112:115], v12 offset:12288
    s_waitcnt lgkmcnt(4)
    v_mfma_f32_32x32x16_bf16 v[64:79], a[88:91], a[100:103], v[64:79]
    ds_read_b64_tr_b16 a[120:121], v14 offset:36896
    ds_read_b64_tr_b16 a[122:123], v14 offset:37920
    v_mfma_f32_32x32x16_bf16 v[80:95], a[92:95], a[100:103], v[80:95]
    s_waitcnt lgkmcnt(2)
    v_mfma_f32_32x32x16_bf16 v[32:47], a[108:111], a[116:119], v[32:47]
    s_waitcnt lgkmcnt(0)
    s_barrier
    ds_read_b128 a[88:91], v9 offset:16384
    ds_read_b64_tr_b16 a[96:97], v13 offset:49216
    v_mfma_f32_32x32x16_bf16 v[48:63], a[112:115], a[116:119], v[48:63]
    ds_read_b64_tr_b16 a[98:99], v13 offset:50240
    ds_read_b128 a[92:95], v9 offset:20480
    v_mfma_f32_32x32x16_bf16 v[64:79], a[108:111], a[120:123], v[64:79]
    ds_read_b64_tr_b16 a[100:101], v14 offset:49216
    ds_read_b64_tr_b16 a[102:103], v14 offset:50240
    v_mfma_f32_32x32x16_bf16 v[80:95], a[112:115], a[120:123], v[80:95]
    s_waitcnt lgkmcnt(2)
    v_mfma_f32_32x32x16_bf16 v[32:47], a[88:91], a[96:99], v[32:47]
    ds_read_b128 a[108:111], v10 offset:16384
    ds_read_b64_tr_b16 a[116:117], v13 offset:53312
    v_mfma_f32_32x32x16_bf16 v[48:63], a[92:95], a[96:99], v[48:63]
    ds_read_b64_tr_b16 a[118:119], v13 offset:54336
    ds_read_b128 a[112:115], v10 offset:20480
    s_waitcnt lgkmcnt(4)
    v_mfma_f32_32x32x16_bf16 v[64:79], a[88:91], a[100:103], v[64:79]
    ds_read_b64_tr_b16 a[120:121], v14 offset:53312
    ds_read_b64_tr_b16 a[122:123], v14 offset:54336
    v_mfma_f32_32x32x16_bf16 v[80:95], a[92:95], a[100:103], v[80:95]
    s_waitcnt lgkmcnt(2)
    v_mfma_f32_32x32x16_bf16 v[32:47], a[108:111], a[116:119], v[32:47]
    ds_read_b128 a[88:91], v11 offset:16384
    ds_read_b64_tr_b16 a[96:97], v13 offset:57408
    v_mfma_f32_32x32x16_bf16 v[48:63], a[112:115], a[116:119], v[48:63]
    ds_read_b64_tr_b16 a[98:99], v13 offset:58432
    ds_read_b128 a[92:95], v11 offset:20480
    s_waitcnt lgkmcnt(4)
    v_mfma_f32_32x32x16_bf16 v[64:79], a[108:111], a[120:123], v[64:79]
    ds_read_b64_tr_b16 a[100:101], v14 offset:57408
    ds_read_b64_tr_b16 a[102:103], v14 offset:58432
    v_mfma_f32_32x32x16_bf16 v[80:95], a[112:115], a[120:123], v[80:95]
    s_waitcnt lgkmcnt(2)
    v_mfma_f32_32x32x16_bf16 v[32:47], a[88:91], a[96:99], v[32:47]
    ds_read_b128 a[108:111], v12 offset:16384
    ds_read_b64_tr_b16 a[116:117], v13 offset:61504
    v_mfma_f32_32x32x16_bf16 v[48:63], a[92:95], a[96:99], v[48:63]
    ds_read_b64_tr_b16 a[118:119], v13 offset:62528
    ds_read_b128 a[112:115], v12 offset:20480
    s_waitcnt lgkmcnt(4)
    v_mfma_f32_32x32x16_bf16 v[64:79], a[88:91], a[100:103], v[64:79]
    ds_read_b64_tr_b16 a[120:121], v14 offset:61504
    ds_read_b64_tr_b16 a[122:123], v14 offset:62528
    v_mfma_f32_32x32x16_bf16 v[80:95], a[92:95], a[100:103], v[80:95]
    s_waitcnt lgkmcnt(2)
    v_mfma_f32_32x32x16_bf16 v[32:47], a[108:111], a[116:119], v[32:47]
    s_waitcnt lgkmcnt(0)
    s_barrier
    ds_read_b128 a[88:91], v9 offset:24576
    ds_read_b64_tr_b16 a[96:97], v13 offset:0
    v_mfma_f32_32x32x16_bf16 v[48:63], a[112:115], a[116:119], v[48:63]
    ds_read_b64_tr_b16 a[98:99], v13 offset:1024
    ds_read_b128 a[92:95], v9 offset:28672
    v_mfma_f32_32x32x16_bf16 v[64:79], a[108:111], a[120:123], v[64:79]
    ds_read_b64_tr_b16 a[100:101], v14 offset:0
    ds_read_b64_tr_b16 a[102:103], v14 offset:1024
    v_mfma_f32_32x32x16_bf16 v[80:95], a[112:115], a[120:123], v[80:95]
    s_waitcnt lgkmcnt(2)
    v_mfma_f32_32x32x16_bf16 v[32:47], a[88:91], a[96:99], v[32:47]
    ds_read_b128 a[108:111], v10 offset:24576
    ds_read_b64_tr_b16 a[116:117], v13 offset:4096
    v_mfma_f32_32x32x16_bf16 v[48:63], a[92:95], a[96:99], v[48:63]
    ds_read_b64_tr_b16 a[118:119], v13 offset:5120
    ds_read_b128 a[112:115], v10 offset:28672
    s_waitcnt lgkmcnt(4)
    v_mfma_f32_32x32x16_bf16 v[64:79], a[88:91], a[100:103], v[64:79]
    ds_read_b64_tr_b16 a[120:121], v14 offset:4096
    ds_read_b64_tr_b16 a[122:123], v14 offset:5120
    v_mfma_f32_32x32x16_bf16 v[80:95], a[92:95], a[100:103], v[80:95]
    s_waitcnt lgkmcnt(2)
    v_mfma_f32_32x32x16_bf16 v[32:47], a[108:111], a[116:119], v[32:47]
    ds_read_b128 a[88:91], v11 offset:24576
    ds_read_b64_tr_b16 a[96:97], v13 offset:8192
    v_mfma_f32_32x32x16_bf16 v[48:63], a[112:115], a[116:119], v[48:63]
    ds_read_b64_tr_b16 a[98:99], v13 offset:9216
    ds_read_b128 a[92:95], v11 offset:28672
    s_waitcnt lgkmcnt(4)
    v_mfma_f32_32x32x16_bf16 v[64:79], a[108:111], a[120:123], v[64:79]
    ds_read_b64_tr_b16 a[100:101], v14 offset:8192
    ds_read_b64_tr_b16 a[102:103], v14 offset:9216
    v_mfma_f32_32x32x16_bf16 v[80:95], a[112:115], a[120:123], v[80:95]
    s_waitcnt lgkmcnt(2)
    v_mfma_f32_32x32x16_bf16 v[32:47], a[88:91], a[96:99], v[32:47]
    ds_read_b128 a[108:111], v12 offset:24576
    ds_read_b64_tr_b16 a[116:117], v13 offset:12288
    v_mfma_f32_32x32x16_bf16 v[48:63], a[92:95], a[96:99], v[48:63]
    ds_read_b64_tr_b16 a[118:119], v13 offset:13312
    ds_read_b128 a[112:115], v12 offset:28672
    s_waitcnt lgkmcnt(4)
    v_mfma_f32_32x32x16_bf16 v[64:79], a[88:91], a[100:103], v[64:79]
    ds_read_b64_tr_b16 a[120:121], v14 offset:12288
    ds_read_b64_tr_b16 a[122:123], v14 offset:13312
    v_mfma_f32_32x32x16_bf16 v[80:95], a[92:95], a[100:103], v[80:95]
    s_waitcnt lgkmcnt(2)
    v_mfma_f32_32x32x16_bf16 v[32:47], a[108:111], a[116:119], v[32:47]
    s_waitcnt lgkmcnt(0)
    s_barrier
    ds_read_b128 a[88:91], v9 offset:32768
    ds_read_b64_tr_b16 a[96:97], v13 offset:24608
    v_mfma_f32_32x32x16_bf16 v[48:63], a[112:115], a[116:119], v[48:63]
    ds_read_b64_tr_b16 a[98:99], v13 offset:25632
    ds_read_b128 a[92:95], v9 offset:36864
    v_mfma_f32_32x32x16_bf16 v[64:79], a[108:111], a[120:123], v[64:79]
    ds_read_b64_tr_b16 a[100:101], v14 offset:24608
    ds_read_b64_tr_b16 a[102:103], v14 offset:25632
    v_mfma_f32_32x32x16_bf16 v[80:95], a[112:115], a[120:123], v[80:95]
    s_waitcnt lgkmcnt(2)
    v_mfma_f32_32x32x16_bf16 v[32:47], a[88:91], a[96:99], v[32:47]
    ds_read_b128 a[108:111], v10 offset:32768
    ds_read_b64_tr_b16 a[116:117], v13 offset:28704
    v_mfma_f32_32x32x16_bf16 v[48:63], a[92:95], a[96:99], v[48:63]
    ds_read_b64_tr_b16 a[118:119], v13 offset:29728
    ds_read_b128 a[112:115], v10 offset:36864
    s_waitcnt lgkmcnt(4)
    v_mfma_f32_32x32x16_bf16 v[64:79], a[88:91], a[100:103], v[64:79]
    ds_read_b64_tr_b16 a[120:121], v14 offset:28704
    ds_read_b64_tr_b16 a[122:123], v14 offset:29728
    v_mfma_f32_32x32x16_bf16 v[80:95], a[92:95], a[100:103], v[80:95]
    s_waitcnt lgkmcnt(2)
    v_mfma_f32_32x32x16_bf16 v[32:47], a[108:111], a[116:119], v[32:47]
    ds_read_b128 a[88:91], v11 offset:32768
    ds_read_b64_tr_b16 a[96:97], v13 offset:32800
    v_mfma_f32_32x32x16_bf16 v[48:63], a[112:115], a[116:119], v[48:63]
    ds_read_b64_tr_b16 a[98:99], v13 offset:33824
    ds_read_b128 a[92:95], v11 offset:36864
    s_waitcnt lgkmcnt(4)
    v_mfma_f32_32x32x16_bf16 v[64:79], a[108:111], a[120:123], v[64:79]
    ds_read_b64_tr_b16 a[100:101], v14 offset:32800
    ds_read_b64_tr_b16 a[102:103], v14 offset:33824
    v_mfma_f32_32x32x16_bf16 v[80:95], a[112:115], a[120:123], v[80:95]
    s_waitcnt lgkmcnt(2)
    v_mfma_f32_32x32x16_bf16 v[32:47], a[88:91], a[96:99], v[32:47]
    ds_read_b128 a[108:111], v12 offset:32768
    ds_read_b64_tr_b16 a[116:117], v13 offset:36896
    v_mfma_f32_32x32x16_bf16 v[48:63], a[92:95], a[96:99], v[48:63]
    ds_read_b64_tr_b16 a[118:119], v13 offset:37920
    ds_read_b128 a[112:115], v12 offset:36864
    s_waitcnt lgkmcnt(4)
    v_mfma_f32_32x32x16_bf16 v[64:79], a[88:91], a[100:103], v[64:79]
    ds_read_b64_tr_b16 a[120:121], v14 offset:36896
    ds_read_b64_tr_b16 a[122:123], v14 offset:37920
    v_mfma_f32_32x32x16_bf16 v[80:95], a[92:95], a[100:103], v[80:95]
    s_waitcnt lgkmcnt(2)
    v_mfma_f32_32x32x16_bf16 v[32:47], a[108:111], a[116:119], v[32:47]
    s_waitcnt lgkmcnt(0)
    s_barrier
    ds_read_b128 a[88:91], v9 offset:0
    ds_read_b64_tr_b16 a[96:97], v13 offset:49216
    v_mfma_f32_32x32x16_bf16 v[48:63], a[112:115], a[116:119], v[48:63]
    ds_read_b64_tr_b16 a[98:99], v13 offset:50240
    ds_read_b128 a[92:95], v9 offset:4096
    v_mfma_f32_32x32x16_bf16 v[64:79], a[108:111], a[120:123], v[64:79]
    ds_read_b64_tr_b16 a[100:101], v14 offset:49216
    ds_read_b64_tr_b16 a[102:103], v14 offset:50240
    v_mfma_f32_32x32x16_bf16 v[80:95], a[112:115], a[120:123], v[80:95]
    s_waitcnt lgkmcnt(2)
    v_mfma_f32_32x32x16_bf16 v[32:47], a[88:91], a[96:99], v[32:47]
    ds_read_b128 a[108:111], v10 offset:0
    ds_read_b64_tr_b16 a[116:117], v13 offset:53312
    v_mfma_f32_32x32x16_bf16 v[48:63], a[92:95], a[96:99], v[48:63]
    ds_read_b64_tr_b16 a[118:119], v13 offset:54336
    ds_read_b128 a[112:115], v10 offset:4096
    s_waitcnt lgkmcnt(4)
    v_mfma_f32_32x32x16_bf16 v[64:79], a[88:91], a[100:103], v[64:79]
    ds_read_b64_tr_b16 a[120:121], v14 offset:53312
    ds_read_b64_tr_b16 a[122:123], v14 offset:54336
    v_mfma_f32_32x32x16_bf16 v[80:95], a[92:95], a[100:103], v[80:95]
    s_waitcnt lgkmcnt(2)
    v_mfma_f32_32x32x16_bf16 v[32:47], a[108:111], a[116:119], v[32:47]
    ds_read_b128 a[88:91], v11 offset:0
    ds_read_b64_tr_b16 a[96:97], v13 offset:57408
    v_mfma_f32_32x32x16_bf16 v[48:63], a[112:115], a[116:119], v[48:63]
    ds_read_b64_tr_b16 a[98:99], v13 offset:58432
    ds_read_b128 a[92:95], v11 offset:4096
    s_waitcnt lgkmcnt(4)
    v_mfma_f32_32x32x16_bf16 v[64:79], a[108:111], a[120:123], v[64:79]
    ds_read_b64_tr_b16 a[100:101], v14 offset:57408
    ds_read_b64_tr_b16 a[102:103], v14 offset:58432
    v_mfma_f32_32x32x16_bf16 v[80:95], a[112:115], a[120:123], v[80:95]
    s_waitcnt lgkmcnt(2)
    v_mfma_f32_32x32x16_bf16 v[32:47], a[88:91], a[96:99], v[32:47]
    ds_read_b128 a[108:111], v12 offset:0
    ds_read_b64_tr_b16 a[116:117], v13 offset:61504
    v_mfma_f32_32x32x16_bf16 v[48:63], a[92:95], a[96:99], v[48:63]
    ds_read_b64_tr_b16 a[118:119], v13 offset:62528
    ds_read_b128 a[112:115], v12 offset:4096
    s_waitcnt lgkmcnt(4)
    v_mfma_f32_32x32x16_bf16 v[64:79], a[88:91], a[100:103], v[64:79]
    ds_read_b64_tr_b16 a[120:121], v14 offset:61504
    ds_read_b64_tr_b16 a[122:123], v14 offset:62528
    v_mfma_f32_32x32x16_bf16 v[80:95], a[92:95], a[100:103], v[80:95]
    s_waitcnt lgkmcnt(2)
    v_mfma_f32_32x32x16_bf16 v[32:47], a[108:111], a[116:119], v[32:47]
    s_waitcnt lgkmcnt(0)
    s_barrier
    ds_read_b128 a[88:91], v9 offset:8192
    ds_read_b64_tr_b16 a[96:97], v13 offset:0
    v_mfma_f32_32x32x16_bf16 v[48:63], a[112:115], a[116:119], v[48:63]
    ds_read_b64_tr_b16 a[98:99], v13 offset:1024
    ds_read_b128 a[92:95], v9 offset:12288
    v_mfma_f32_32x32x16_bf16 v[64:79], a[108:111], a[120:123], v[64:79]
    ds_read_b64_tr_b16 a[100:101], v14 offset:0
    ds_read_b64_tr_b16 a[102:103], v14 offset:1024
    v_mfma_f32_32x32x16_bf16 v[80:95], a[112:115], a[120:123], v[80:95]
    s_waitcnt lgkmcnt(2)
    v_mfma_f32_32x32x16_bf16 v[32:47], a[88:91], a[96:99], v[32:47]
    ds_read_b128 a[108:111], v10 offset:8192
    ds_read_b64_tr_b16 a[116:117], v13 offset:4096
    v_mfma_f32_32x32x16_bf16 v[48:63], a[92:95], a[96:99], v[48:63]
    ds_read_b64_tr_b16 a[118:119], v13 offset:5120
    ds_read_b128 a[112:115], v10 offset:12288
    s_waitcnt lgkmcnt(4)
    v_mfma_f32_32x32x16_bf16 v[64:79], a[88:91], a[100:103], v[64:79]
    ds_read_b64_tr_b16 a[120:121], v14 offset:4096
    ds_read_b64_tr_b16 a[122:123], v14 offset:5120
    v_mfma_f32_32x32x16_bf16 v[80:95], a[92:95], a[100:103], v[80:95]
    s_waitcnt lgkmcnt(2)
    v_mfma_f32_32x32x16_bf16 v[32:47], a[108:111], a[116:119], v[32:47]
    ds_read_b128 a[88:91], v11 offset:8192
    ds_read_b64_tr_b16 a[96:97], v13 offset:8192
    v_mfma_f32_32x32x16_bf16 v[48:63], a[112:115], a[116:119], v[48:63]
    ds_read_b64_tr_b16 a[98:99], v13 offset:9216
    ds_read_b128 a[92:95], v11 offset:12288
    s_waitcnt lgkmcnt(4)
    v_mfma_f32_32x32x16_bf16 v[64:79], a[108:111], a[120:123], v[64:79]
    ds_read_b64_tr_b16 a[100:101], v14 offset:8192
    ds_read_b64_tr_b16 a[102:103], v14 offset:9216
    v_mfma_f32_32x32x16_bf16 v[80:95], a[112:115], a[120:123], v[80:95]
    s_waitcnt lgkmcnt(2)
    v_mfma_f32_32x32x16_bf16 v[32:47], a[88:91], a[96:99], v[32:47]
    ds_read_b128 a[108:111], v12 offset:8192
    ds_read_b64_tr_b16 a[116:117], v13 offset:12288
    v_mfma_f32_32x32x16_bf16 v[48:63], a[92:95], a[96:99], v[48:63]
    ds_read_b64_tr_b16 a[118:119], v13 offset:13312
    ds_read_b128 a[112:115], v12 offset:12288
    s_waitcnt lgkmcnt(4)
    v_mfma_f32_32x32x16_bf16 v[64:79], a[88:91], a[100:103], v[64:79]
    ds_read_b64_tr_b16 a[120:121], v14 offset:12288
    ds_read_b64_tr_b16 a[122:123], v14 offset:13312
    v_mfma_f32_32x32x16_bf16 v[80:95], a[92:95], a[100:103], v[80:95]
    s_waitcnt lgkmcnt(2)
    v_mfma_f32_32x32x16_bf16 v[32:47], a[108:111], a[116:119], v[32:47]
    s_waitcnt lgkmcnt(0)
    s_barrier
    ds_read_b128 a[88:91], v9 offset:16384
    ds_read_b64_tr_b16 a[96:97], v13 offset:24608
    v_mfma_f32_32x32x16_bf16 v[48:63], a[112:115], a[116:119], v[48:63]
    ds_read_b64_tr_b16 a[98:99], v13 offset:25632
    ds_read_b128 a[92:95], v9 offset:20480
    v_mfma_f32_32x32x16_bf16 v[64:79], a[108:111], a[120:123], v[64:79]
    ds_read_b64_tr_b16 a[100:101], v14 offset:24608
    ds_read_b64_tr_b16 a[102:103], v14 offset:25632
    v_mfma_f32_32x32x16_bf16 v[80:95], a[112:115], a[120:123], v[80:95]
    s_waitcnt lgkmcnt(2)
    v_mfma_f32_32x32x16_bf16 v[32:47], a[88:91], a[96:99], v[32:47]
    ds_read_b128 a[108:111], v10 offset:16384
    ds_read_b64_tr_b16 a[116:117], v13 offset:28704
    v_mfma_f32_32x32x16_bf16 v[48:63], a[92:95], a[96:99], v[48:63]
    ds_read_b64_tr_b16 a[118:119], v13 offset:29728
    ds_read_b128 a[112:115], v10 offset:20480
    s_waitcnt lgkmcnt(4)
    v_mfma_f32_32x32x16_bf16 v[64:79], a[88:91], a[100:103], v[64:79]
    ds_read_b64_tr_b16 a[120:121], v14 offset:28704
    ds_read_b64_tr_b16 a[122:123], v14 offset:29728
    v_mfma_f32_32x32x16_bf16 v[80:95], a[92:95], a[100:103], v[80:95]
    s_waitcnt lgkmcnt(2)
    v_mfma_f32_32x32x16_bf16 v[32:47], a[108:111], a[116:119], v[32:47]
    ds_read_b128 a[88:91], v11 offset:16384
    ds_read_b64_tr_b16 a[96:97], v13 offset:32800
    v_mfma_f32_32x32x16_bf16 v[48:63], a[112:115], a[116:119], v[48:63]
    ds_read_b64_tr_b16 a[98:99], v13 offset:33824
    ds_read_b128 a[92:95], v11 offset:20480
    s_waitcnt lgkmcnt(4)
    v_mfma_f32_32x32x16_bf16 v[64:79], a[108:111], a[120:123], v[64:79]
    ds_read_b64_tr_b16 a[100:101], v14 offset:32800
    ds_read_b64_tr_b16 a[102:103], v14 offset:33824
    v_mfma_f32_32x32x16_bf16 v[80:95], a[112:115], a[120:123], v[80:95]
    s_waitcnt lgkmcnt(2)
    v_mfma_f32_32x32x16_bf16 v[32:47], a[88:91], a[96:99], v[32:47]
    ds_read_b128 a[108:111], v12 offset:16384
    ds_read_b64_tr_b16 a[116:117], v13 offset:36896
    v_mfma_f32_32x32x16_bf16 v[48:63], a[92:95], a[96:99], v[48:63]
    ds_read_b64_tr_b16 a[118:119], v13 offset:37920
    ds_read_b128 a[112:115], v12 offset:20480
    s_waitcnt lgkmcnt(4)
    v_mfma_f32_32x32x16_bf16 v[64:79], a[88:91], a[100:103], v[64:79]
    ds_read_b64_tr_b16 a[120:121], v14 offset:36896
    ds_read_b64_tr_b16 a[122:123], v14 offset:37920
    v_mfma_f32_32x32x16_bf16 v[80:95], a[92:95], a[100:103], v[80:95]
    s_waitcnt lgkmcnt(2)
    v_mfma_f32_32x32x16_bf16 v[32:47], a[108:111], a[116:119], v[32:47]
    s_waitcnt lgkmcnt(0)
    s_barrier
    ds_read_b128 a[88:91], v9 offset:24576
    ds_read_b64_tr_b16 a[96:97], v13 offset:49216
    v_mfma_f32_32x32x16_bf16 v[48:63], a[112:115], a[116:119], v[48:63]
    ds_read_b64_tr_b16 a[98:99], v13 offset:50240
    ds_read_b128 a[92:95], v9 offset:28672
    v_mfma_f32_32x32x16_bf16 v[64:79], a[108:111], a[120:123], v[64:79]
    ds_read_b64_tr_b16 a[100:101], v14 offset:49216
    ds_read_b64_tr_b16 a[102:103], v14 offset:50240
    v_mfma_f32_32x32x16_bf16 v[80:95], a[112:115], a[120:123], v[80:95]
    s_waitcnt lgkmcnt(2)
    v_mfma_f32_32x32x16_bf16 v[32:47], a[88:91], a[96:99], v[32:47]
    ds_read_b128 a[108:111], v10 offset:24576
    ds_read_b64_tr_b16 a[116:117], v13 offset:53312
    v_mfma_f32_32x32x16_bf16 v[48:63], a[92:95], a[96:99], v[48:63]
    ds_read_b64_tr_b16 a[118:119], v13 offset:54336
    ds_read_b128 a[112:115], v10 offset:28672
    s_waitcnt lgkmcnt(4)
    v_mfma_f32_32x32x16_bf16 v[64:79], a[88:91], a[100:103], v[64:79]
    ds_read_b64_tr_b16 a[120:121], v14 offset:53312
    ds_read_b64_tr_b16 a[122:123], v14 offset:54336
    v_mfma_f32_32x32x16_bf16 v[80:95], a[92:95], a[100:103], v[80:95]
    s_waitcnt lgkmcnt(2)
    v_mfma_f32_32x32x16_bf16 v[32:47], a[108:111], a[116:119], v[32:47]
    ds_read_b128 a[88:91], v11 offset:24576
    ds_read_b64_tr_b16 a[96:97], v13 offset:57408
    v_mfma_f32_32x32x16_bf16 v[48:63], a[112:115], a[116:119], v[48:63]
    ds_read_b64_tr_b16 a[98:99], v13 offset:58432
    ds_read_b128 a[92:95], v11 offset:28672
    s_waitcnt lgkmcnt(4)
    v_mfma_f32_32x32x16_bf16 v[64:79], a[108:111], a[120:123], v[64:79]
    ds_read_b64_tr_b16 a[100:101], v14 offset:57408
    ds_read_b64_tr_b16 a[102:103], v14 offset:58432
    v_mfma_f32_32x32x16_bf16 v[80:95], a[112:115], a[120:123], v[80:95]
    s_waitcnt lgkmcnt(2)
    v_mfma_f32_32x32x16_bf16 v[32:47], a[88:91], a[96:99], v[32:47]
    ds_read_b128 a[108:111], v12 offset:24576
    ds_read_b64_tr_b16 a[116:117], v13 offset:61504
    v_mfma_f32_32x32x16_bf16 v[48:63], a[92:95], a[96:99], v[48:63]
    ds_read_b64_tr_b16 a[118:119], v13 offset:62528
    ds_read_b128 a[112:115], v12 offset:28672
    s_waitcnt lgkmcnt(4)
    v_mfma_f32_32x32x16_bf16 v[64:79], a[88:91], a[100:103], v[64:79]
    ds_read_b64_tr_b16 a[120:121], v14 offset:61504
    ds_read_b64_tr_b16 a[122:123], v14 offset:62528
    v_mfma_f32_32x32x16_bf16 v[80:95], a[92:95], a[100:103], v[80:95]
    s_waitcnt lgkmcnt(2)
    v_mfma_f32_32x32x16_bf16 v[32:47], a[108:111], a[116:119], v[32:47]
    s_waitcnt lgkmcnt(0)
    s_barrier
    ds_read_b128 a[88:91], v9 offset:32768
    ds_read_b64_tr_b16 a[96:97], v13 offset:0
    v_mfma_f32_32x32x16_bf16 v[48:63], a[112:115], a[116:119], v[48:63]
    ds_read_b64_tr_b16 a[98:99], v13 offset:1024
    ds_read_b128 a[92:95], v9 offset:36864
    v_mfma_f32_32x32x16_bf16 v[64:79], a[108:111], a[120:123], v[64:79]
    ds_read_b64_tr_b16 a[100:101], v14 offset:0
    ds_read_b64_tr_b16 a[102:103], v14 offset:1024
    v_mfma_f32_32x32x16_bf16 v[80:95], a[112:115], a[120:123], v[80:95]
    s_waitcnt lgkmcnt(2)
    v_mfma_f32_32x32x16_bf16 v[32:47], a[88:91], a[96:99], v[32:47]
    ds_read_b128 a[108:111], v10 offset:32768
    ds_read_b64_tr_b16 a[116:117], v13 offset:4096
    v_mfma_f32_32x32x16_bf16 v[48:63], a[92:95], a[96:99], v[48:63]
    ds_read_b64_tr_b16 a[118:119], v13 offset:5120
    ds_read_b128 a[112:115], v10 offset:36864
    s_waitcnt lgkmcnt(4)
    v_mfma_f32_32x32x16_bf16 v[64:79], a[88:91], a[100:103], v[64:79]
    ds_read_b64_tr_b16 a[120:121], v14 offset:4096
    ds_read_b64_tr_b16 a[122:123], v14 offset:5120
    v_mfma_f32_32x32x16_bf16 v[80:95], a[92:95], a[100:103], v[80:95]
    s_waitcnt lgkmcnt(2)
    v_mfma_f32_32x32x16_bf16 v[32:47], a[108:111], a[116:119], v[32:47]
    ds_read_b128 a[88:91], v11 offset:32768
    ds_read_b64_tr_b16 a[96:97], v13 offset:8192
    v_mfma_f32_32x32x16_bf16 v[48:63], a[112:115], a[116:119], v[48:63]
    ds_read_b64_tr_b16 a[98:99], v13 offset:9216
    ds_read_b128 a[92:95], v11 offset:36864
    s_waitcnt lgkmcnt(4)
    v_mfma_f32_32x32x16_bf16 v[64:79], a[108:111], a[120:123], v[64:79]
    ds_read_b64_tr_b16 a[100:101], v14 offset:8192
    ds_read_b64_tr_b16 a[102:103], v14 offset:9216
    v_mfma_f32_32x32x16_bf16 v[80:95], a[112:115], a[120:123], v[80:95]
    s_waitcnt lgkmcnt(2)
    v_mfma_f32_32x32x16_bf16 v[32:47], a[88:91], a[96:99], v[32:47]
    ds_read_b128 a[108:111], v12 offset:32768
    ds_read_b64_tr_b16 a[116:117], v13 offset:12288
    v_mfma_f32_32x32x16_bf16 v[48:63], a[92:95], a[96:99], v[48:63]
    ds_read_b64_tr_b16 a[118:119], v13 offset:13312
    ds_read_b128 a[112:115], v12 offset:36864
    s_waitcnt lgkmcnt(4)
    v_mfma_f32_32x32x16_bf16 v[64:79], a[88:91], a[100:103], v[64:79]
    ds_read_b64_tr_b16 a[120:121], v14 offset:12288
    ds_read_b64_tr_b16 a[122:123], v14 offset:13312
    v_mfma_f32_32x32x16_bf16 v[80:95], a[92:95], a[100:103], v[80:95]
    s_waitcnt lgkmcnt(2)
    v_mfma_f32_32x32x16_bf16 v[32:47], a[108:111], a[116:119], v[32:47]
    s_waitcnt lgkmcnt(0)
    ds_write_b32 v21, v22
    v_mfma_f32_32x32x16_bf16 v[48:63], a[112:115], a[116:119], v[48:63]
    v_mfma_f32_32x32x16_bf16 v[64:79], a[108:111], a[120:123], v[64:79]
    v_mfma_f32_32x32x16_bf16 v[80:95], a[112:115], a[120:123], v[80:95]
    s_setprio 3
    s_lshl_b32 s52, s46, 1
    s_add_u32 s52, s52, s26
    s_lshl_b32 s52, s52, 1
    s_mul_i32 s53, s3, 52
    s_lshr_b32 s53, s53, 8
    s_mul_i32 s53, s53, 5
    s_sub_u32 s53, s3, s53
    s_lshl_b32 s54, s53, 1
    s_add_u32 s54, s54, s27
    s_lshl_b32 s54, s54, 1
    s_mul_i32 s66, s52, 82560
    s_lshl_b32 s54, s54, 9
    s_add_u32 s66, s66, s54
    s_add_u32 s66, s66, 3186688
    v_mul_u32_u24 v101, 10240, v3
    v_lshl_add_u32 v101, v2, 4, v101
    s_cmp_eq_u32 s62, 15
    s_cselect_b32 s54, 0x40000000, 0
    v_add_u32 v101, s54, v101
    s_mul_i32 s52, s65, 82560
    s_lshl_b32 s53, s53, 7
    s_add_u32 s52, s52, s53
    s_add_u32 s52, s52, s54
    s_add_u32 s52, s52, 3227648
    v_lshrrev_b32 v102, 3, v1
    v_lshlrev_b32 v102, 28, v102
    v_lshl_add_u32 v102, v1, 4, v102
    v_add_u32 v102, s52, v102
    s_add_u32 s67, s66, 0
    v_cvt_pk_bf16_f32 v24, v32, v33
    v_cvt_pk_bf16_f32 v25, v34, v35
    v_cvt_pk_bf16_f32 v26, v36, v37
    v_cvt_pk_bf16_f32 v27, v38, v39
    buffer_store_dwordx4 v[24:27], v101, s[36:39], s67 offen offset:0 sc1
    s_nop 0
    v_cvt_pk_bf16_f32 v28, v64, v65
    v_cvt_pk_bf16_f32 v29, v66, v67
    v_cvt_pk_bf16_f32 v30, v68, v69
    v_cvt_pk_bf16_f32 v31, v70, v71
    buffer_store_dwordx4 v[28:31], v101, s[36:39], s67 offen offset:512 sc1
    s_add_u32 s67, s66, 20480
    v_cvt_pk_bf16_f32 v24, v40, v41
    v_cvt_pk_bf16_f32 v25, v42, v43
    v_cvt_pk_bf16_f32 v26, v44, v45
    v_cvt_pk_bf16_f32 v27, v46, v47
    buffer_store_dwordx4 v[24:27], v101, s[36:39], s67 offen offset:0 sc1
    s_nop 0
    v_cvt_pk_bf16_f32 v28, v72, v73
    v_cvt_pk_bf16_f32 v29, v74, v75
    v_cvt_pk_bf16_f32 v30, v76, v77
    v_cvt_pk_bf16_f32 v31, v78, v79
    buffer_store_dwordx4 v[28:31], v101, s[36:39], s67 offen offset:512 sc1
    s_add_u32 s67, s66, 82560
    v_cvt_pk_bf16_f32 v24, v48, v49
    v_cvt_pk_bf16_f32 v25, v50, v51
    v_cvt_pk_bf16_f32 v26, v52, v53
    v_cvt_pk_bf16_f32 v27, v54, v55
    buffer_store_dwordx4 v[24:27], v101, s[36:39], s67 offen offset:0 sc1
    s_nop 0
    v_cvt_pk_bf16_f32 v28, v80, v81
    v_cvt_pk_bf16_f32 v29, v82, v83
    v_cvt_pk_bf16_f32 v30, v84, v85
    v_cvt_pk_bf16_f32 v31, v86, v87
    buffer_store_dwordx4 v[28:31], v101, s[36:39], s67 offen offset:512 sc1
    s_add_u32 s67, s66, 103040
    v_cvt_pk_bf16_f32 v24, v56, v57
    v_cvt_pk_bf16_f32 v25, v58, v59
    v_cvt_pk_bf16_f32 v26, v60, v61
    v_cvt_pk_bf16_f32 v27, v62, v63
    buffer_store_dwordx4 v[24:27], v101, s[36:39], s67 offen offset:0 sc1
    s_nop 0
    v_cvt_pk_bf16_f32 v28, v88, v89
    v_cvt_pk_bf16_f32 v29, v90, v91
    v_cvt_pk_bf16_f32 v30, v92, v93
    v_cvt_pk_bf16_f32 v31, v94, v95
    buffer_store_dwordx4 v[28:31], v101, s[36:39], s67 offen offset:512 sc1
    v_mov_b32 v16, 0x3f803f80
    v_mov_b32 v17, 0x3f803f80
    v_mov_b32 v18, 0x3f803f80
    v_mov_b32 v19, 0x3f803f80
    buffer_store_dwordx4 v[16:19], v102, s[36:39], 0 offen sc1
L_A_r2:
    s_setprio 0
    v_mov_b32 v104, 159768
    ds_read_b64 v[106:107], v104
    s_lshl_b32 s66, s62, 7
    s_lshl_b32 s53, s46, 3
    s_add_u32 s66, s66, s53
    s_add_u32 s66, s66, 11075584
    s_mov_b32 s67, 11075584
    s_barrier
    s_waitcnt lgkmcnt(0)
    v_readfirstlane_b32 s50, v106
    v_readfirstlane_b32 s51, v107
    v_accvgpr_write_b32 a88, 0
    v_accvgpr_write_b32 a89, 0
    v_accvgpr_write_b32 a90, 0
    v_accvgpr_write_b32 a91, 0
    v_accvgpr_write_b32 a92, 0
    v_accvgpr_write_b32 a93, 0
    v_accvgpr_write_b32 a94, 0
    v_accvgpr_write_b32 a95, 0
    v_accvgpr_write_b32 a96, 0
    v_accvgpr_write_b32 a97, 0
    v_accvgpr_write_b32 a98, 0
    v_accvgpr_write_b32 a99, 0
    v_accvgpr_write_b32 a120, 0
    v_accvgpr_write_b32 a121, 0
    v_accvgpr_write_b32 a122, 0
    v_accvgpr_write_b32 a123, 0
    v_accvgpr_write_b32 a124, 0
    v_accvgpr_write_b32 a125, 0
    v_accvgpr_write_b32 a126, 0
    v_accvgpr_write_b32 a127, 0
    s_barrier
    s_mul_i32 s60, s58, 196608
    s_add_u32 m0, s57, 49216
    s_add_u32 s55, s60, 0
    buffer_load_dwordx4 v6, s[32:35], s55 offen lds
    s_add_u32 m0, s57, 50240
    s_add_u32 s55, s60, 0
    buffer_load_dwordx4 v7, s[32:35], s55 offen lds
    s_add_u32 m0, s57, 51264
    s_add_u32 s55, s60, 0
    buffer_load_dwordx4 v8, s[32:35], s55 offen lds
    s_add_u32 m0, s57, 52288
    s_add_u32 s55, s60, 49152
    buffer_load_dwordx4 v6, s[32:35], s55 offen lds
    s_add_u32 m0, s57, 53312
    s_add_u32 s55, s60, 49152
    buffer_load_dwordx4 v7, s[32:35], s55 offen lds
    s_add_u32 m0, s57, 54336
    s_add_u32 s55, s60, 49152
    buffer_load_dwordx4 v8, s[32:35], s55 offen lds
    s_add_u32 s58, s58, 9
    s_cmp_ge_u32 s58, 10
    s_cselect_b32 s54, 10, 0
    s_sub_u32 s58, s58, s54
    s_waitcnt vmcnt(6)
    v_mov_b32 v108, 159748
    v_mov_b32 v109, 1
    s_mov_b64 exec, 1
    ds_add_rtn_u32 v109, v108, v109
    s_mov_b64 exec, -1
    s_waitcnt lgkmcnt(0)
    v_readfirstlane_b32 s54, v109
    s_cmp_lg_u32 s54, 3
    s_cbranch_scc1 Lsg_50
    v_mov_b32 v108, s50
    v_mov_b32 v109, s51
    v_mov_b32 v110, 0
    s_mov_b64 exec, 1
    buffer_store_dwordx2 v[108:109], v110, s[36:39], s66 offen sc1
    s_mov_b64 exec, -1
Lsg_50:
    s_barrier
    s_mul_i32 s60, s58, 196608
    s_add_u32 m0, s57, 0
    s_add_u32 s55, s60, 0
    buffer_load_dwordx4 v6, s[32:35], s55 offen lds
    s_add_u32 m0, s57, 1024
    s_add_u32 s55, s60, 0
    buffer_load_dwordx4 v7, s[32:35], s55 offen lds
    s_add_u32 m0, s57, 2048
    s_add_u32 s55, s60, 0
    buffer_load_dwordx4 v8, s[32:35], s55 offen lds
    s_add_u32 m0, s57, 3072
    s_add_u32 s55, s60, 49152
    buffer_load_dwordx4 v6, s[32:35], s55 offen lds
    s_add_u32 m0, s57, 4096
    s_add_u32 s55, s60, 49152
    buffer_load_dwordx4 v7, s[32:35], s55 offen lds
    s_add_u32 m0, s57, 5120
    s_add_u32 s55, s60, 49152
    buffer_load_dwordx4 v8, s[32:35], s55 offen lds
    s_lshl_b32 s59, s58, 7
    s_add_u32 m0, s56, 32768
    s_add_u32 s55, s59, 0
    buffer_load_dwordx4 v4, s[28:31], s55 offen lds
    s_add_u32 m0, s56, 33792
    s_add_u32 s55, s59, 10240
    buffer_load_dwordx4 v5, s[28:31], s55 offen lds
    s_add_u32 m0, s56, 34816
    s_add_u32 s55, s59, 20480
    buffer_load_dwordx4 v4, s[28:31], s55 offen lds
    s_add_u32 m0, s56, 35840
    s_add_u32 s55, s59, 30720
    buffer_load_dwordx4 v5, s[28:31], s55 offen lds
    s_add_u32 s58, s58, 9
    s_cmp_ge_u32 s58, 10
    s_cselect_b32 s54, 10, 0
    s_sub_u32 s58, s58, s54
    s_waitcnt vmcnt(10)
    s_barrier
    s_mul_i32 s60, s58, 196608
    s_add_u32 m0, s57, 24608
    s_add_u32 s55, s60, 0
    buffer_load_dwordx4 v6, s[32:35], s55 offen lds
    s_add_u32 m0, s57, 25632
    s_add_u32 s55, s60, 0
    buffer_load_dwordx4 v7, s[32:35], s55 offen lds
    s_add_u32 m0, s57, 26656
    s_add_u32 s55, s60, 0
    buffer_load_dwordx4 v8, s[32:35], s55 offen lds
    s_add_u32 m0, s57, 27680
    s_add_u32 s55, s60, 49152
    buffer_load_dwordx4 v6, s[32:35], s55 offen lds
    s_add_u32 m0, s57, 28704
    s_add_u32 s55, s60, 49152
    buffer_load_dwordx4 v7, s[32:35], s55 offen lds
    s_add_u32 m0, s57, 29728
    s_add_u32 s55, s60, 49152
    buffer_load_dwordx4 v8, s[32:35], s55 offen lds
    s_lshl_b32 s59, s58, 7
    s_add_u32 m0, s56, 24576
    s_add_u32 s55, s59, 0
    buffer_load_dwordx4 v4, s[28:31], s55 offen lds
    s_add_u32 m0, s56, 25600
    s_add_u32 s55, s59, 10240
    buffer_load_dwordx4 v5, s[28:31], s55 offen lds
    s_add_u32 m0, s56, 26624
    s_add_u32 s55, s59, 20480
    buffer_load_dwordx4 v4, s[28:31], s55 offen lds
    s_add_u32 m0, s56, 27648
    s_add_u32 s55, s59, 30720
    buffer_load_dwordx4 v5, s[28:31], s55 offen lds
    s_add_u32 s58, s58, 9
    s_cmp_ge_u32 s58, 10
    s_cselect_b32 s54, 10, 0
    s_sub_u32 s58, s58, s54
    s_waitcnt vmcnt(10)
    s_barrier
    s_mul_i32 s60, s58, 196608
    s_add_u32 m0, s57, 49216
    s_add_u32 s55, s60, 0
    buffer_load_dwordx4 v6, s[32:35], s55 offen lds
    s_add_u32 m0, s57, 50240
    s_add_u32 s55, s60, 0
    buffer_load_dwordx4 v7, s[32:35], s55 offen lds
    s_add_u32 m0, s57, 51264
    s_add_u32 s55, s60, 0
    buffer_load_dwordx4 v8, s[32:35], s55 offen lds
    s_add_u32 m0, s57, 52288
    s_add_u32 s55, s60, 49152
    buffer_load_dwordx4 v6, s[32:35], s55 offen lds
    s_add_u32 m0, s57, 53312
    s_add_u32 s55, s60, 49152
    buffer_load_dwordx4 v7, s[32:35], s55 offen lds
    s_add_u32 m0, s57, 54336
    s_add_u32 s55, s60, 49152
    buffer_load_dwordx4 v8, s[32:35], s55 offen lds
    s_lshl_b32 s59, s58, 7
    s_add_u32 m0, s56, 16384
    s_add_u32 s55, s59, 0
    buffer_load_dwordx4 v4, s[28:31], s55 offen lds
    s_add_u32 m0, s56, 17408
    s_add_u32 s55, s59, 10240
    buffer_load_dwordx4 v5, s[28:31], s55 offen lds
    s_add_u32 m0, s56, 18432
    s_add_u32 s55, s59, 20480
    buffer_load_dwordx4 v4, s[28:31], s55 offen lds
    s_add_u32 m0, s56, 19456
    s_add_u32 s55, s59, 30720
    buffer_load_dwordx4 v5, s[28:31], s55 offen lds
    s_add_u32 s58, s58, 9
    s_cmp_ge_u32 s58, 10
    s_cselect_b32 s54, 10, 0
    s_sub_u32 s58, s58, s54
    s_waitcnt vmcnt(10)
    s_barrier
    s_mul_i32 s60, s58, 196608
    s_add_u32 m0, s57, 0
    s_add_u32 s55, s60, 0
    buffer_load_dwordx4 v6, s[32:35], s55 offen lds
    s_add_u32 m0, s57, 1024
    s_add_u32 s55, s60, 0
    buffer_load_dwordx4 v7, s[32:35], s55 offen lds
    s_add_u32 m0, s57, 2048
    s_add_u32 s55, s60, 0
    buffer_load_dwordx4 v8, s[32:35], s55 offen lds
    s_add_u32 m0, s57, 3072
    s_add_u32 s55, s60, 49152
    buffer_load_dwordx4 v6, s[32:35], s55 offen lds
    s_add_u32 m0, s57, 4096
    s_add_u32 s55, s60, 49152
    buffer_load_dwordx4 v7, s[32:35], s55 offen lds
    s_add_u32 m0, s57, 5120
    s_add_u32 s55, s60, 49152
    buffer_load_dwordx4 v8, s[32:35], s55 offen lds
    s_lshl_b32 s59, s58, 7
    s_add_u32 m0, s56, 8192
    s_add_u32 s55, s59, 0
    buffer_load_dwordx4 v4, s[28:31], s55 offen lds
    s_add_u32 m0, s56, 9216
    s_add_u32 s55, s59, 10240
    buffer_load_dwordx4 v5, s[28:31], s55 offen lds
    s_add_u32 m0, s56, 10240
    s_add_u32 s55, s59, 20480
    buffer_load_dwordx4 v4, s[28:31], s55 offen lds
    s_add_u32 m0, s56, 11264
    s_add_u32 s55, s59, 30720
    buffer_load_dwordx4 v5, s[28:31], s55 offen lds
    s_add_u32 s58, s58, 9
    s_cmp_ge_u32 s58, 10
    s_cselect_b32 s54, 10, 0
    s_sub_u32 s58, s58, s54
    s_waitcnt vmcnt(10)
    s_barrier
    v_mov_b32 v104, 159808
    ds_read_b32 v105, v104
    s_cmp_lg_u32 s45, 0
    s_cbranch_scc1 Lqs_51
    s_mov_b32 exec_hi, 0xffff
    buffer_load_dwordx4 v[108:111], v117, s[36:39], s67 offen sc1
    s_mov_b32 exec_hi, -1
Lqs_51:
    s_mul_i32 s60, s58, 196608
    s_add_u32 m0, s57, 24608
    s_add_u32 s55, s60, 0
    buffer_load_dwordx4 v6, s[32:35], s55 offen lds
    s_add_u32 m0, s57, 25632
    s_add_u32 s55, s60, 0
    buffer_load_dwordx4 v7, s[32:35], s55 offen lds
    s_add_u32 m0, s57, 26656
    s_add_u32 s55, s60, 0
    buffer_load_dwordx4 v8, s[32:35], s55 offen lds
    s_add_u32 m0, s57, 27680
    s_add_u32 s55, s60, 49152
    buffer_load_dwordx4 v6, s[32:35], s55 offen lds
    s_add_u32 m0, s57, 28704
    s_add_u32 s55, s60, 49152
    buffer_load_dwordx4 v7, s[32:35], s55 offen lds
    s_add_u32 m0, s57, 29728
    s_add_u32 s55, s60, 49152
    buffer_load_dwordx4 v8, s[32:35], s55 offen lds
    s_lshl_b32 s59, s58, 7
    s_add_u32 m0, s56, 0
    s_add_u32 s55, s59, 0
    buffer_load_dwordx4 v4, s[28:31], s55 offen lds
    s_add_u32 m0, s56, 1024
    s_add_u32 s55, s59, 10240
    buffer_load_dwordx4 v5, s[28:31], s55 offen lds
    s_add_u32 m0, s56, 2048
    s_add_u32 s55, s59, 20480
    buffer_load_dwordx4 v4, s[28:31], s55 offen lds
    s_add_u32 m0, s56, 3072
    s_add_u32 s55, s59, 30720
    buffer_load_dwordx4 v5, s[28:31], s55 offen lds
    s_add_u32 s58, s58, 9
    s_cmp_ge_u32 s58, 10
    s_cselect_b32 s54, 10, 0
    s_sub_u32 s58, s58, s54
    v_mov_b32 v4, v112
    v_mov_b32 v5, v113
    v_mov_b32 v6, v114
    v_mov_b32 v0, v115
    v_mov_b32 v11, v116
    v_mov_b32 v36, v117
    v_mov_b32 v7, v118
    v_mov_b32 v8, v119
    v_mov_b32 v9, v120
    s_waitcnt lgkmcnt(0)
    v_readfirstlane_b32 s52, v105
    s_cmp_eq_u32 s52, 0
    s_cbranch_scc1 L_att_late
    buffer_load_dwordx4 v[44:47], v4, s[36:39], s9 offen offset:0 sc1
    buffer_load_dwordx2 v[48:49], v5, s[36:39], s9 offen offset:0 sc1
    s_add_u32 s52, s45, 1
    s_and_b32 s52, s52, 3
    s_mul_i32 s52, s52, 81920
    s_add_u32 s52, s52, s18
    buffer_load_dwordx4 v[80:83], v4, s[36:39], s52 offen offset:0 sc1
    buffer_load_dwordx2 v[112:113], v11, s[36:39], s52 offen offset:0 sc1
    s_add_u32 s52, s52, 40960
    buffer_load_dwordx4 v[84:87], v4, s[36:39], s52 offen offset:0 sc1
    buffer_load_dwordx2 v[114:115], v11, s[36:39], s52 offen offset:0 sc1
    s_add_u32 s52, s45, 2
    s_and_b32 s52, s52, 3
    s_mul_i32 s52, s52, 81920
    s_add_u32 s52, s52, s18
    buffer_load_dwordx4 v[88:91], v4, s[36:39], s52 offen offset:0 sc1
    buffer_load_dwordx2 v[116:117], v11, s[36:39], s52 offen offset:0 sc1
    s_waitcnt vmcnt(18)
    s_barrier
    s_add_u32 s52, s52, 40960
    buffer_load_dwordx4 v[92:95], v4, s[36:39], s52 offen offset:0 sc1
    buffer_load_dwordx2 v[118:119], v11, s[36:39], s52 offen offset:0 sc1
    s_add_u32 s52, s45, 3
    s_and_b32 s52, s52, 3
    s_mul_i32 s52, s52, 81920
    s_add_u32 s52, s52, s18
    buffer_load_dwordx4 v[96:99], v4, s[36:39], s52 offen offset:0 sc1
    buffer_load_dwordx2 v[120:121], v11, s[36:39], s52 offen offset:0 sc1
    s_add_u32 s52, s52, 40960
    buffer_load_dwordx4 v[100:103], v4, s[36:39], s52 offen offset:0 sc1
    buffer_load_dwordx2 v[122:123], v11, s[36:39], s52 offen offset:0 sc1
    s_add_u32 s52, s45, 4
    s_and_b32 s52, s52, 3
    s_mul_i32 s52, s52, 81920
    s_add_u32 s52, s52, s18
    buffer_load_dwordx4 v[104:107], v4, s[36:39], s52 offen offset:0 sc1
    buffer_load_dwordx2 v[124:125], v11, s[36:39], s52 offen offset:0 sc1
    s_add_u32 s52, s52, 40960
    buffer_load_dwordx4 v[108:111], v4, s[36:39], s52 offen offset:0 sc1
    buffer_load_dwordx2 v[126:127], v11, s[36:39], s52 offen offset:0 sc1
    s_waitcnt vmcnt(18)
    s_barrier
    buffer_load_dwordx4 v[52:55], v4, s[36:39], s8 offen offset:0 sc1
    buffer_load_dwordx2 v[60:61], v5, s[36:39], s8 offen offset:0 sc1
    buffer_load_dwordx4 v[64:67], v6, s[36:39], s8 offen offset:0 sc1
    buffer_load_dwordx4 v[68:71], v0, s[36:39], s8 offen offset:0 sc1
    s_add_u32 s8, s8, 82560
    buffer_load_dwordx4 v[56:59], v4, s[36:39], s8 offen offset:0 sc1
    buffer_load_dwordx2 v[62:63], v5, s[36:39], s8 offen offset:0 sc1
    buffer_load_dwordx4 v[72:75], v6, s[36:39], s8 offen offset:0 sc1
    buffer_load_dwordx4 v[76:79], v0, s[36:39], s8 offen offset:0 sc1
    s_add_u32 s8, s8, 82560
    buffer_load_dwordx4 a[100:103], v4, s[36:39], s8 offen offset:0 sc1
    buffer_load_dwordx2 a[104:105], v5, s[36:39], s8 offen offset:0 sc1
    buffer_load_dwordx4 a[106:109], v6, s[36:39], s8 offen offset:0 sc1
    buffer_load_dwordx4 a[110:113], v0, s[36:39], s8 offen offset:0 sc1
    s_add_u32 s8, s8, 82560
    buffer_load_dwordx4 a[114:117], v4, s[36:39], s8 offen offset:0 sc1
    buffer_load_dwordx2 a[118:119], v5, s[36:39], s8 offen offset:0 sc1
    s_branch L_att_go
L_att_late:
    s_waitcnt vmcnt(10)
    s_cmp_lg_u32 s45, 0
    s_cbranch_scc1 Lqe_52
    s_mov_b32 exec_hi, 0xffff
    v_cmp_ne_u64 vcc, s[50:51], v[108:109]
    v_cmp_ne_u64 s[68:69], s[50:51], v[110:111]
    s_mov_b32 exec_hi, -1
    s_or_b64 vcc, vcc, s[68:69]
    s_cbranch_scc1 Lqe_52
    v_mov_b32 v108, 159808
    v_mov_b32 v109, 1
    s_mov_b64 exec, 1
    ds_add_u32 v108, v109
    s_mov_b64 exec, -1
    s_waitcnt lgkmcnt(0)
Lqe_52:
    s_barrier
    ds_read_b32 v105, v104
    s_cmp_lg_u32 s45, 0
    s_cbranch_scc1 Lqs_53
    s_mov_b32 exec_hi, 0xffff
    buffer_load_dwordx4 v[32:35], v36, s[36:39], s67 offen sc1
    s_mov_b32 exec_hi, -1
Lqs_53:
    s_waitcnt lgkmcnt(0)
    v_readfirstlane_b32 s52, v105
    s_cmp_eq_u32 s52, 0
    s_cbranch_scc1 L_att_late2
    buffer_load_dwordx4 v[44:47], v4, s[36:39], s9 offen offset:0 sc1
    buffer_load_dwordx2 v[48:49], v5, s[36:39], s9 offen offset:0 sc1
    s_add_u32 s52, s45, 1
    s_and_b32 s52, s52, 3
    s_mul_i32 s52, s52, 81920
    s_add_u32 s52, s52, s18
    buffer_load_dwordx4 v[80:83], v4, s[36:39], s52 offen offset:0 sc1
    buffer_load_dwordx2 v[112:113], v11, s[36:39], s52 offen offset:0 sc1
    s_add_u32 s52, s52, 40960
    buffer_load_dwordx4 v[84:87], v4, s[36:39], s52 offen offset:0 sc1
    buffer_load_dwordx2 v[114:115], v11, s[36:39], s52 offen offset:0 sc1
    s_add_u32 s52, s45, 2
    s_and_b32 s52, s52, 3
    s_mul_i32 s52, s52, 81920
    s_add_u32 s52, s52, s18
    buffer_load_dwordx4 v[88:91], v4, s[36:39], s52 offen offset:0 sc1
    buffer_load_dwordx2 v[116:117], v11, s[36:39], s52 offen offset:0 sc1
    s_add_u32 s52, s52, 40960
    buffer_load_dwordx4 v[92:95], v4, s[36:39], s52 offen offset:0 sc1
    buffer_load_dwordx2 v[118:119], v11, s[36:39], s52 offen offset:0 sc1
    s_waitcnt vmcnt(10)
    s_barrier
    s_add_u32 s52, s45, 3
    s_and_b32 s52, s52, 3
    s_mul_i32 s52, s52, 81920
    s_add_u32 s52, s52, s18
    buffer_load_dwordx4 v[96:99], v4, s[36:39], s52 offen offset:0 sc1
    buffer_load_dwordx2 v[120:121], v11, s[36:39], s52 offen offset:0 sc1
    s_add_u32 s52, s52, 40960
    buffer_load_dwordx4 v[100:103], v4, s[36:39], s52 offen offset:0 sc1
    buffer_load_dwordx2 v[122:123], v11, s[36:39], s52 offen offset:0 sc1
    s_add_u32 s52, s45, 4
    s_and_b32 s52, s52, 3
    s_mul_i32 s52, s52, 81920
    s_add_u32 s52, s52, s18
    buffer_load_dwordx4 v[104:107], v4, s[36:39], s52 offen offset:0 sc1
    buffer_load_dwordx2 v[124:125], v11, s[36:39], s52 offen offset:0 sc1
    s_add_u32 s52, s52, 40960
    buffer_load_dwordx4 v[108:111], v4, s[36:39], s52 offen offset:0 sc1
    buffer_load_dwordx2 v[126:127], v11, s[36:39], s52 offen offset:0 sc1
    buffer_load_dwordx4 v[52:55], v4, s[36:39], s8 offen offset:0 sc1
    buffer_load_dwordx2 v[60:61], v5, s[36:39], s8 offen offset:0 sc1
    buffer_load_dwordx4 v[64:67], v6, s[36:39], s8 offen offset:0 sc1
    buffer_load_dwordx4 v[68:71], v0, s[36:39], s8 offen offset:0 sc1
    s_add_u32 s8, s8, 82560
    buffer_load_dwordx4 v[56:59], v4, s[36:39], s8 offen offset:0 sc1
    buffer_load_dwordx2 v[62:63], v5, s[36:39], s8 offen offset:0 sc1
    buffer_load_dwordx4 v[72:75], v6, s[36:39], s8 offen offset:0 sc1
    buffer_load_dwordx4 v[76:79], v0, s[36:39], s8 offen offset:0 sc1
    s_add_u32 s8, s8, 82560
    buffer_load_dwordx4 a[100:103], v4, s[36:39], s8 offen offset:0 sc1
    buffer_load_dwordx2 a[104:105], v5, s[36:39], s8 offen offset:0 sc1
    buffer_load_dwordx4 a[106:109], v6, s[36:39], s8 offen offset:0 sc1
    buffer_load_dwordx4 a[110:113], v0, s[36:39], s8 offen offset:0 sc1
    s_add_u32 s8, s8, 82560
    buffer_load_dwordx4 a[114:117], v4, s[36:39], s8 offen offset:0 sc1
    buffer_load_dwordx2 a[118:119], v5, s[36:39], s8 offen offset:0 sc1
    s_branch L_att_go
L_att_late2:
    s_waitcnt vmcnt(0)
    s_cmp_lg_u32 s45, 0
    s_cbranch_scc1 Lqe_54
    s_mov_b32 exec_hi, 0xffff
    v_cmp_ne_u64 vcc, s[50:51], v[32:33]
    v_cmp_ne_u64 s[68:69], s[50:51], v[34:35]
    s_mov_b32 exec_hi, -1
    s_or_b64 vcc, vcc, s[68:69]
    s_cbranch_scc1 Lqe_54
    v_mov_b32 v32, 159808
    v_mov_b32 v33, 1
    s_mov_b64 exec, 1
    ds_add_u32 v32, v33
    s_mov_b64 exec, -1
    s_waitcnt lgkmcnt(0)
Lqe_54:
    s_barrier
    ds_read_b32 v105, v104
    s_waitcnt lgkmcnt(0)
    v_readfirstlane_b32 s52, v105
    s_cmp_lg_u32 s52, 0
    s_cbranch_scc1 L_att_late3
    s_cmp_lg_u32 s45, 0
    s_cbranch_scc1 Lgo_55
    s_mov_b32 exec_lo, 0xffffffff
    s_mov_b32 exec_hi, 0xffff
    s_mov_b32 s49, 0x40000
Lp_57:
    buffer_load_dwordx4 v[32:35], v36, s[36:39], s67 offen sc1
    s_waitcnt vmcnt(0)
    v_cmp_ne_u64 vcc, s[50:51], v[32:33]
    v_cmp_ne_u64 s[68:69], s[50:51], v[34:35]
    s_sub_u32 s49, s49, 1
    s_cbranch_scc1 Lpd_58
    s_or_b64 vcc, vcc, s[68:69]
    s_cbranch_scc0 Lpd_58
    s_sleep 8
    s_branch Lp_57
Lpd_58:
    s_mov_b64 exec, -1
    v_mov_b32 v32, 159808
    v_mov_b32 v33, 1
    s_mov_b64 exec, 1
    ds_add_u32 v32, v33
    s_mov_b64 exec, -1
    s_branch Lgd_56
Lgo_55:
    v_mov_b32 v32, 159808
Lw_59:
    ds_read_b32 v33, v32
    s_waitcnt lgkmcnt(0)
    v_readfirstlane_b32 s54, v33
    s_cmp_ge_u32 s54, 1
    s_cbranch_scc1 Lwd_60
    s_sleep 4
    s_branch Lw_59
Lwd_60:
Lgd_56:
L_att_late3:
    buffer_load_dwordx4 v[44:47], v4, s[36:39], s9 offen offset:0 sc1
    buffer_load_dwordx2 v[48:49], v5, s[36:39], s9 offen offset:0 sc1
    s_add_u32 s52, s45, 1
    s_and_b32 s52, s52, 3
    s_mul_i32 s52, s52, 81920
    s_add_u32 s52, s52, s18
    buffer_load_dwordx4 v[80:83], v4, s[36:39], s52 offen offset:0 sc1
    buffer_load_dwordx2 v[112:113], v11, s[36:39], s52 offen offset:0 sc1
    s_add_u32 s52, s52, 40960
    buffer_load_dwordx4 v[84:87], v4, s[36:39], s52 offen offset:0 sc1
    buffer_load_dwordx2 v[114:115], v11, s[36:39], s52 offen offset:0 sc1
    s_add_u32 s52, s45, 2
    s_and_b32 s52, s52, 3
    s_mul_i32 s52, s52, 81920
    s_add_u32 s52, s52, s18
    buffer_load_dwordx4 v[88:91], v4, s[36:39], s52 offen offset:0 sc1
    buffer_load_dwordx2 v[116:117], v11, s[36:39], s52 offen offset:0 sc1
    s_add_u32 s52, s52, 40960
    buffer_load_dwordx4 v[92:95], v4, s[36:39], s52 offen offset:0 sc1
    buffer_load_dwordx2 v[118:119], v11, s[36:39], s52 offen offset:0 sc1
    s_add_u32 s52, s45, 3
    s_and_b32 s52, s52, 3
    s_mul_i32 s52, s52, 81920
    s_add_u32 s52, s52, s18
    buffer_load_dwordx4 v[96:99], v4, s[36:39], s52 offen offset:0 sc1
    buffer_load_dwordx2 v[120:121], v11, s[36:39], s52 offen offset:0 sc1
    s_add_u32 s52, s52, 40960
    buffer_load_dwordx4 v[100:103], v4, s[36:39], s52 offen offset:0 sc1
    buffer_load_dwordx2 v[122:123], v11, s[36:39], s52 offen offset:0 sc1
    s_add_u32 s52, s45, 4
    s_and_b32 s52, s52, 3
    s_mul_i32 s52, s52, 81920
    s_add_u32 s52, s52, s18
    buffer_load_dwordx4 v[104:107], v4, s[36:39], s52 offen offset:0 sc1
    buffer_load_dwordx2 v[124:125], v11, s[36:39], s52 offen offset:0 sc1
    s_add_u32 s52, s52, 40960
    buffer_load_dwordx4 v[108:111], v4, s[36:39], s52 offen offset:0 sc1
    buffer_load_dwordx2 v[126:127], v11, s[36:39], s52 offen offset:0 sc1
    buffer_load_dwordx4 v[52:55], v4, s[36:39], s8 offen offset:0 sc1
    buffer_load_dwordx2 v[60:61], v5, s[36:39], s8 offen offset:0 sc1
    buffer_load_dwordx4 v[64:67], v6, s[36:39], s8 offen offset:0 sc1
    buffer_load_dwordx4 v[68:71], v0, s[36:39], s8 offen offset:0 sc1
    s_add_u32 s8, s8, 82560
    buffer_load_dwordx4 v[56:59], v4, s[36:39], s8 offen offset:0 sc1
    buffer_load_dwordx2 v[62:63], v5, s[36:39], s8 offen offset:0 sc1
    buffer_load_dwordx4 v[72:75], v6, s[36:39], s8 offen offset:0 sc1
    buffer_load_dwordx4 v[76:79], v0, s[36:39], s8 offen offset:0 sc1
    s_add_u32 s8, s8, 82560
    buffer_load_dwordx4 a[100:103], v4, s[36:39], s8 offen offset:0 sc1
    buffer_load_dwordx2 a[104:105], v5, s[36:39], s8 offen offset:0 sc1
    buffer_load_dwordx4 a[106:109], v6, s[36:39], s8 offen offset:0 sc1
    buffer_load_dwordx4 a[110:113], v0, s[36:39], s8 offen offset:0 sc1
    s_add_u32 s8, s8, 82560
    buffer_load_dwordx4 a[114:117], v4, s[36:39], s8 offen offset:0 sc1
    buffer_load_dwordx2 a[118:119], v5, s[36:39], s8 offen offset:0 sc1
L_att_go:
    s_setprio 3
    s_waitcnt vmcnt(14)
    v_mfma_f32_32x32x16_bf16 v[12:27], v[44:47], v[80:83], 0
    v_mfma_f32_32x32x8_bf16 v[12:27], v[48:49], v[112:113], v[12:27]
    v_mfma_f32_32x32x16_bf16 v[28:43], v[44:47], v[84:87], 0
    v_mfma_f32_32x32x8_bf16 v[28:43], v[48:49], v[114:115], v[28:43]
    s_nop 11
    v_max3_f32 v10, v12, v13, v14
    v_max3_f32 v11, v15, v16, v17
    v_max3_f32 v10, v10, v18, v19
    v_max3_f32 v11, v11, v20, v21
    v_max3_f32 v10, v10, v22, v23
    v_max3_f32 v11, v11, v24, v25
    v_max3_f32 v10, v10, v26, v27
    v_mfma_f32_32x32x16_bf16 v[12:27], v[44:47], v[88:91], 0
    v_mfma_f32_32x32x8_bf16 v[12:27], v[48:49], v[116:117], v[12:27]
    v_max_f32 v10, v10, v11
    s_mov_b32 exec_lo, 0
    v_cvt_pk_bf16_f32 v112, -v10, 0
    s_mov_b32 exec_lo, -1
    v_max3_f32 v10, v28, v29, v30
    v_max3_f32 v11, v31, v32, v33
    v_max3_f32 v10, v10, v34, v35
    v_max3_f32 v11, v11, v36, v37
    v_max3_f32 v10, v10, v38, v39
    v_max3_f32 v11, v11, v40, v41
    v_max3_f32 v10, v10, v42, v43
    v_mfma_f32_32x32x16_bf16 v[28:43], v[44:47], v[92:95], 0
    v_mfma_f32_32x32x8_bf16 v[28:43], v[48:49], v[118:119], v[28:43]
    v_max_f32 v10, v10, v11
    s_mov_b32 exec_lo, 0
    v_cvt_pk_bf16_f32 v114, -v10, 0
    s_mov_b32 exec_lo, -1
    v_max3_f32 v10, v12, v13, v14
    v_max3_f32 v11, v15, v16, v17
    v_max3_f32 v10, v10, v18, v19
    v_max3_f32 v11, v11, v20, v21
    v_max3_f32 v10, v10, v22, v23
    v_max3_f32 v11, v11, v24, v25
    v_max3_f32 v10, v10, v26, v27
    v_mfma_f32_32x32x16_bf16 v[12:27], v[44:47], v[96:99], 0
    v_mfma_f32_32x32x8_bf16 v[12:27], v[48:49], v[120:121], v[12:27]
    v_max_f32 v10, v10, v11
    s_mov_b32 exec_lo, 0
    v_cvt_pk_bf16_f32 v116, -v10, 0
    s_mov_b32 exec_lo, -1
    v_max3_f32 v10, v28, v29, v30
    v_max3_f32 v11, v31, v32, v33
    v_max3_f32 v10, v10, v34, v35
    v_max3_f32 v11, v11, v36, v37
    v_max3_f32 v10, v10, v38, v39
    v_max3_f32 v11, v11, v40, v41
    v_max3_f32 v10, v10, v42, v43
    v_mfma_f32_32x32x16_bf16 v[28:43], v[44:47], v[100:103], 0
    v_mfma_f32_32x32x8_bf16 v[28:43], v[48:49], v[122:123], v[28:43]
    v_max_f32 v10, v10, v11
    s_mov_b32 exec_lo, 0
    v_cvt_pk_bf16_f32 v118, -v10, 0
    s_mov_b32 exec_lo, -1
    v_max3_f32 v10, v12, v13, v14
    v_max3_f32 v11, v15, v16, v17
    v_max3_f32 v10, v10, v18, v19
    v_max3_f32 v11, v11, v20, v21
    v_max3_f32 v10, v10, v22, v23
    v_max3_f32 v11, v11, v24, v25
    v_max3_f32 v10, v10, v26, v27
    v_mfma_f32_32x32x16_bf16 v[12:27], v[44:47], v[104:107], 0
    v_mfma_f32_32x32x8_bf16 v[12:27], v[48:49], v[124:125], v[12:27]
    v_max_f32 v10, v10, v11
    s_mov_b32 exec_lo, 0
    v_cvt_pk_bf16_f32 v120, -v10, 0
    s_mov_b32 exec_lo, -1
    v_max3_f32 v10, v28, v29, v30
    v_max3_f32 v11, v31, v32, v33
    v_max3_f32 v10, v10, v34, v35
    v_max3_f32 v11, v11, v36, v37
    v_max3_f32 v10, v10, v38, v39
    v_max3_f32 v11, v11, v40, v41
    v_max3_f32 v10, v10, v42, v43
    v_mfma_f32_32x32x16_bf16 v[28:43], v[44:47], v[108:111], 0
    v_mfma_f32_32x32x8_bf16 v[28:43], v[48:49], v[126:127], v[28:43]
    v_max_f32 v10, v10, v11
    s_mov_b32 exec_lo, 0
    v_cvt_pk_bf16_f32 v122, -v10, 0
    s_mov_b32 exec_lo, -1
    v_max3_f32 v10, v12, v13, v14
    v_max3_f32 v11, v15, v16, v17
    v_max3_f32 v10, v10, v18, v19
    v_max3_f32 v11, v11, v20, v21
    v_max3_f32 v10, v10, v22, v23
    v_max3_f32 v11, v11, v24, v25
    v_max3_f32 v10, v10, v26, v27
    v_max_f32 v10, v10, v11
    s_mov_b32 exec_lo, 0
    v_cvt_pk_bf16_f32 v124, -v10, 0
    s_mov_b32 exec_lo, -1
    s_nop 2
    v_max3_f32 v10, v28, v29, v30
    v_max3_f32 v11, v31, v32, v33
    v_max3_f32 v10, v10, v34, v35
    v_max3_f32 v11, v11, v36, v37
    v_max3_f32 v10, v10, v38, v39
    v_max3_f32 v11, v11, v40, v41
    v_max3_f32 v10, v10, v42, v43
    v_max_f32 v10, v10, v11
    s_mov_b32 exec_lo, 0
    v_cvt_pk_bf16_f32 v126, -v10, 0
    s_mov_b32 exec_lo, -1
    s_nop 2
    s_waitcnt vmcnt(12)
    v_mfma_f32_32x32x16_bf16 v[12:27], v[52:55], v[80:83], 0
    v_mfma_f32_32x32x8_bf16 v[12:27], v[60:61], v[112:113], v[12:27]
    v_mov_b32 v51, 0xdddddddd
    s_nop 6
    s_mov_b32 s63, 3
    s_nop 3
    s_setprio 0
.p2align 6
L_att_loop:
    v_smfmac_f32_32x32x32_bf16 a[84:99], a[120:123], v[28:35], v51
    v_exp_f32 v12, v12
    v_exp_f32 v13, v13
    v_exp_f32 v14, v14
    v_smfmac_f32_32x32x32_bf16 a[84:99], a[124:127], v[36:43], v51
    v_exp_f32 v15, v15
    v_exp_f32 v16, v16
    v_exp_f32 v17, v17
    v_mfma_f32_32x32x16_bf16 v[28:43], v[52:55], v[84:87], 0
    v_exp_f32 v18, v18
    v_exp_f32 v19, v19
    v_exp_f32 v20, v20
    v_mfma_f32_32x32x8_bf16 v[28:43], v[60:61], v[114:115], v[28:43]
    v_exp_f32 v21, v21
    v_exp_f32 v22, v22
    v_exp_f32 v23, v23
    v_exp_f32 v24, v24
    v_exp_f32 v25, v25
    v_exp_f32 v26, v26
    v_exp_f32 v27, v27
    s_waitcnt vmcnt(10)
    v_smfmac_f32_32x32x32_bf16 a[0:15], v[64:67], v[12:19], v51
    v_exp_f32 v28, v28
    v_exp_f32 v29, v29
    v_exp_f32 v30, v30
    v_smfmac_f32_32x32x32_bf16 a[0:15], v[68:71], v[20:27], v51
    v_exp_f32 v31, v31
    v_exp_f32 v32, v32
    v_exp_f32 v33, v33
    v_mfma_f32_32x32x16_bf16 v[12:27], v[52:55], v[88:91], 0
    v_exp_f32 v34, v34
    v_exp_f32 v35, v35
    v_exp_f32 v36, v36
    v_mfma_f32_32x32x8_bf16 v[12:27], v[60:61], v[116:117], v[12:27]
    v_exp_f32 v37, v37
    v_exp_f32 v38, v38
    buffer_load_dwordx4 a[120:123], v6, s[36:39], s8 offen offset:0 sc1
    v_exp_f32 v39, v39
    v_exp_f32 v40, v40
    buffer_load_dwordx4 a[124:127], v0, s[36:39], s8 offen offset:0 sc1
    v_exp_f32 v41, v41
    v_exp_f32 v42, v42
    v_exp_f32 v43, v43
    v_smfmac_f32_32x32x32_bf16 a[12:27], v[64:67], v[28:35], v51
    v_exp_f32 v12, v12
    v_exp_f32 v13, v13
    v_exp_f32 v14, v14
    v_smfmac_f32_32x32x32_bf16 a[12:27], v[68:71], v[36:43], v51
    v_exp_f32 v15, v15
    v_exp_f32 v16, v16
    v_exp_f32 v17, v17
    v_mfma_f32_32x32x16_bf16 v[28:43], v[52:55], v[92:95], 0
    v_exp_f32 v18, v18
    v_exp_f32 v19, v19
    v_exp_f32 v20, v20
    v_mfma_f32_32x32x8_bf16 v[28:43], v[60:61], v[118:119], v[28:43]
    v_exp_f32 v21, v21
    v_exp_f32 v22, v22
    v_exp_f32 v23, v23
    v_exp_f32 v24, v24
    v_exp_f32 v25, v25
    v_exp_f32 v26, v26
    v_exp_f32 v27, v27
    v_smfmac_f32_32x32x32_bf16 a[24:39], v[64:67], v[12:19], v51
    v_exp_f32 v28, v28
    v_exp_f32 v29, v29
    v_exp_f32 v30, v30
    v_smfmac_f32_32x32x32_bf16 a[24:39], v[68:71], v[20:27], v51
    v_exp_f32 v31, v31
    v_exp_f32 v32, v32
    v_exp_f32 v33, v33
    v_mfma_f32_32x32x16_bf16 v[12:27], v[52:55], v[96:99], 0
    v_exp_f32 v34, v34
    v_exp_f32 v35, v35
    v_exp_f32 v36, v36
    v_mfma_f32_32x32x8_bf16 v[12:27], v[60:61], v[120:121], v[12:27]
    v_exp_f32 v37, v37
    v_exp_f32 v38, v38
    v_exp_f32 v39, v39
    v_exp_f32 v40, v40
    v_exp_f32 v41, v41
    s_add_u32 s8, s8, 82560
    v_exp_f32 v42, v42
    v_exp_f32 v43, v43
    v_smfmac_f32_32x32x32_bf16 a[36:51], v[64:67], v[28:35], v51
    v_exp_f32 v12, v12
    v_exp_f32 v13, v13
    v_exp_f32 v14, v14
    v_smfmac_f32_32x32x32_bf16 a[36:51], v[68:71], v[36:43], v51
    v_exp_f32 v15, v15
    v_exp_f32 v16, v16
    v_exp_f32 v17, v17
    v_mfma_f32_32x32x16_bf16 v[28:43], v[52:55], v[100:103], 0
    v_exp_f32 v18, v18
    v_exp_f32 v19, v19
    v_exp_f32 v20, v20
    v_mfma_f32_32x32x8_bf16 v[28:43], v[60:61], v[122:123], v[28:43]
    v_exp_f32 v21, v21
    v_exp_f32 v22, v22
    v_exp_f32 v23, v23
    v_exp_f32 v24, v24
    v_exp_f32 v25, v25
    v_exp_f32 v26, v26
    v_exp_f32 v27, v27
    v_smfmac_f32_32x32x32_bf16 a[48:63], v[64:67], v[12:19], v51
    v_exp_f32 v28, v28
    v_exp_f32 v29, v29
    v_exp_f32 v30, v30
    v_smfmac_f32_32x32x32_bf16 a[48:63], v[68:71], v[20:27], v51
    v_exp_f32 v31, v31
    v_exp_f32 v32, v32
    v_exp_f32 v33, v33
    v_mfma_f32_32x32x16_bf16 v[12:27], v[52:55], v[104:107], 0
    v_exp_f32 v34, v34
    v_exp_f32 v35, v35
    v_exp_f32 v36, v36
    v_mfma_f32_32x32x8_bf16 v[12:27], v[60:61], v[124:125], v[12:27]
    v_exp_f32 v37, v37
    v_exp_f32 v38, v38
    v_exp_f32 v39, v39
    v_exp_f32 v40, v40
    v_exp_f32 v41, v41
    v_exp_f32 v42, v42
    v_exp_f32 v43, v43
    v_smfmac_f32_32x32x32_bf16 a[60:75], v[64:67], v[28:35], v51
    v_exp_f32 v12, v12
    v_exp_f32 v13, v13
    v_exp_f32 v14, v14
    v_smfmac_f32_32x32x32_bf16 a[60:75], v[68:71], v[36:43], v51
    v_exp_f32 v15, v15
    v_exp_f32 v16, v16
    v_exp_f32 v17, v17
    v_mfma_f32_32x32x16_bf16 v[28:43], v[52:55], v[108:111], 0
    v_exp_f32 v18, v18
    v_exp_f32 v19, v19
    v_exp_f32 v20, v20
    v_mfma_f32_32x32x8_bf16 v[28:43], v[60:61], v[126:127], v[28:43]
    v_exp_f32 v21, v21
    v_exp_f32 v22, v22
    v_exp_f32 v23, v23
    v_exp_f32 v24, v24
    v_exp_f32 v25, v25
    v_exp_f32 v26, v26
    v_exp_f32 v27, v27
    v_smfmac_f32_32x32x32_bf16 a[72:87], v[64:67], v[12:19], v51
    v_exp_f32 v28, v28
    v_exp_f32 v29, v29
    v_exp_f32 v30, v30
    v_smfmac_f32_32x32x32_bf16 a[72:87], v[68:71], v[20:27], v51
    v_exp_f32 v31, v31
    v_exp_f32 v32, v32
    v_exp_f32 v33, v33
    s_waitcnt vmcnt(10)
    v_mfma_f32_32x32x16_bf16 v[12:27], v[56:59], v[80:83], 0
    v_exp_f32 v34, v34
    v_exp_f32 v35, v35
    v_exp_f32 v36, v36
    v_mfma_f32_32x32x8_bf16 v[12:27], v[62:63], v[112:113], v[12:27]
    v_exp_f32 v37, v37
    v_exp_f32 v38, v38
    buffer_load_dwordx4 v[52:55], v4, s[36:39], s8 offen offset:0 sc1
    v_exp_f32 v39, v39
    v_exp_f32 v40, v40
    buffer_load_dwordx2 v[60:61], v5, s[36:39], s8 offen offset:0 sc1
    v_exp_f32 v41, v41
    v_exp_f32 v42, v42
    v_exp_f32 v43, v43
    v_smfmac_f32_32x32x32_bf16 a[84:99], v[64:67], v[28:35], v51
    v_exp_f32 v12, v12
    v_exp_f32 v13, v13
    v_exp_f32 v14, v14
    v_smfmac_f32_32x32x32_bf16 a[84:99], v[68:71], v[36:43], v51
    v_exp_f32 v15, v15
    v_exp_f32 v16, v16
    v_exp_f32 v17, v17
    v_mfma_f32_32x32x16_bf16 v[28:43], v[56:59], v[84:87], 0
    v_exp_f32 v18, v18
    v_exp_f32 v19, v19
    v_exp_f32 v20, v20
    v_mfma_f32_32x32x8_bf16 v[28:43], v[62:63], v[114:115], v[28:43]
    v_exp_f32 v21, v21
    v_exp_f32 v22, v22
    v_exp_f32 v23, v23
    v_exp_f32 v24, v24
    v_exp_f32 v25, v25
    v_exp_f32 v26, v26
    v_exp_f32 v27, v27
    s_waitcnt vmcnt(10)
    v_smfmac_f32_32x32x32_bf16 a[0:15], v[72:75], v[12:19], v51
    v_exp_f32 v28, v28
    v_exp_f32 v29, v29
    v_exp_f32 v30, v30
    v_smfmac_f32_32x32x32_bf16 a[0:15], v[76:79], v[20:27], v51
    v_exp_f32 v31, v31
    v_exp_f32 v32, v32
    v_exp_f32 v33, v33
    v_mfma_f32_32x32x16_bf16 v[12:27], v[56:59], v[88:91], 0
    v_exp_f32 v34, v34
    v_exp_f32 v35, v35
    v_exp_f32 v36, v36
    v_mfma_f32_32x32x8_bf16 v[12:27], v[62:63], v[116:117], v[12:27]
    v_exp_f32 v37, v37
    v_exp_f32 v38, v38
    buffer_load_dwordx4 v[64:67], v6, s[36:39], s8 offen offset:0 sc1
    v_exp_f32 v39, v39
    v_exp_f32 v40, v40
    buffer_load_dwordx4 v[68:71], v0, s[36:39], s8 offen offset:0 sc1
    v_exp_f32 v41, v41
    v_exp_f32 v42, v42
    v_exp_f32 v43, v43
    v_smfmac_f32_32x32x32_bf16 a[12:27], v[72:75], v[28:35], v51
    v_exp_f32 v12, v12
    v_exp_f32 v13, v13
    v_exp_f32 v14, v14
    v_smfmac_f32_32x32x32_bf16 a[12:27], v[76:79], v[36:43], v51
    v_exp_f32 v15, v15
    v_exp_f32 v16, v16
    v_exp_f32 v17, v17
    v_mfma_f32_32x32x16_bf16 v[28:43], v[56:59], v[92:95], 0
    v_exp_f32 v18, v18
    v_exp_f32 v19, v19
    v_exp_f32 v20, v20
    v_mfma_f32_32x32x8_bf16 v[28:43], v[62:63], v[118:119], v[28:43]
    v_exp_f32 v21, v21
    v_exp_f32 v22, v22
    v_exp_f32 v23, v23
    v_exp_f32 v24, v24
    v_exp_f32 v25, v25
    v_exp_f32 v26, v26
    v_exp_f32 v27, v27
    v_smfmac_f32_32x32x32_bf16 a[24:39], v[72:75], v[12:19], v51
    v_exp_f32 v28, v28
    v_exp_f32 v29, v29
    v_exp_f32 v30, v30
    v_smfmac_f32_32x32x32_bf16 a[24:39], v[76:79], v[20:27], v51
    v_exp_f32 v31, v31
    v_exp_f32 v32, v32
    v_exp_f32 v33, v33
    v_mfma_f32_32x32x16_bf16 v[12:27], v[56:59], v[96:99], 0
    v_exp_f32 v34, v34
    v_exp_f32 v35, v35
    v_exp_f32 v36, v36
    v_mfma_f32_32x32x8_bf16 v[12:27], v[62:63], v[120:121], v[12:27]
    v_exp_f32 v37, v37
    v_exp_f32 v38, v38
    v_exp_f32 v39, v39
    v_exp_f32 v40, v40
    v_exp_f32 v41, v41
    s_add_u32 s8, s8, 82560
    v_exp_f32 v42, v42
    v_exp_f32 v43, v43
    v_smfmac_f32_32x32x32_bf16 a[36:51], v[72:75], v[28:35], v51
    v_exp_f32 v12, v12
    v_exp_f32 v13, v13
    v_exp_f32 v14, v14
    v_smfmac_f32_32x32x32_bf16 a[36:51], v[76:79], v[36:43], v51
    v_exp_f32 v15, v15
    v_exp_f32 v16, v16
    v_exp_f32 v17, v17
    v_mfma_f32_32x32x16_bf16 v[28:43], v[56:59], v[100:103], 0
    v_exp_f32 v18, v18
    v_exp_f32 v19, v19
    v_exp_f32 v20, v20
    v_mfma_f32_32x32x8_bf16 v[28:43], v[62:63], v[122:123], v[28:43]
    v_exp_f32 v21, v21
    v_exp_f32 v22, v22
    v_exp_f32 v23, v23
    v_exp_f32 v24, v24
    v_exp_f32 v25, v25
    v_exp_f32 v26, v26
    v_exp_f32 v27, v27
    v_smfmac_f32_32x32x32_bf16 a[48:63], v[72:75], v[12:19], v51
    v_exp_f32 v28, v28
    v_exp_f32 v29, v29
    v_exp_f32 v30, v30
    v_smfmac_f32_32x32x32_bf16 a[48:63], v[76:79], v[20:27], v51
    v_exp_f32 v31, v31
    v_exp_f32 v32, v32
    v_exp_f32 v33, v33
    v_mfma_f32_32x32x16_bf16 v[12:27], v[56:59], v[104:107], 0
    v_exp_f32 v34, v34
    v_exp_f32 v35, v35
    v_exp_f32 v36, v36
    v_mfma_f32_32x32x8_bf16 v[12:27], v[62:63], v[124:125], v[12:27]
    v_exp_f32 v37, v37
    v_exp_f32 v38, v38
    v_exp_f32 v39, v39
    v_exp_f32 v40, v40
    v_exp_f32 v41, v41
    v_exp_f32 v42, v42
    v_exp_f32 v43, v43
    v_smfmac_f32_32x32x32_bf16 a[60:75], v[72:75], v[28:35], v51
    v_exp_f32 v12, v12
    v_exp_f32 v13, v13
    v_exp_f32 v14, v14
    v_smfmac_f32_32x32x32_bf16 a[60:75], v[76:79], v[36:43], v51
    v_exp_f32 v15, v15
    v_exp_f32 v16, v16
    v_exp_f32 v17, v17
    v_mfma_f32_32x32x16_bf16 v[28:43], v[56:59], v[108:111], 0
    v_exp_f32 v18, v18
    v_exp_f32 v19, v19
    v_exp_f32 v20, v20
    v_mfma_f32_32x32x8_bf16 v[28:43], v[62:63], v[126:127], v[28:43]
    v_exp_f32 v21, v21
    v_exp_f32 v22, v22
    v_exp_f32 v23, v23
    v_exp_f32 v24, v24
    v_exp_f32 v25, v25
    v_exp_f32 v26, v26
    v_exp_f32 v27, v27
    v_smfmac_f32_32x32x32_bf16 a[72:87], v[72:75], v[12:19], v51
    v_exp_f32 v28, v28
    v_exp_f32 v29, v29
    v_exp_f32 v30, v30
    v_smfmac_f32_32x32x32_bf16 a[72:87], v[76:79], v[20:27], v51
    v_exp_f32 v31, v31
    v_exp_f32 v32, v32
    v_exp_f32 v33, v33
    s_waitcnt vmcnt(10)
    v_mfma_f32_32x32x16_bf16 v[12:27], a[100:103], v[80:83], 0
    v_exp_f32 v34, v34
    v_exp_f32 v35, v35
    v_exp_f32 v36, v36
    v_mfma_f32_32x32x8_bf16 v[12:27], a[104:105], v[112:113], v[12:27]
    v_exp_f32 v37, v37
    v_exp_f32 v38, v38
    buffer_load_dwordx4 v[56:59], v4, s[36:39], s8 offen offset:0 sc1
    v_exp_f32 v39, v39
    v_exp_f32 v40, v40
    buffer_load_dwordx2 v[62:63], v5, s[36:39], s8 offen offset:0 sc1
    v_exp_f32 v41, v41
    v_exp_f32 v42, v42
    v_exp_f32 v43, v43
    v_smfmac_f32_32x32x32_bf16 a[84:99], v[72:75], v[28:35], v51
    v_exp_f32 v12, v12
    v_exp_f32 v13, v13
    v_exp_f32 v14, v14
    v_smfmac_f32_32x32x32_bf16 a[84:99], v[76:79], v[36:43], v51
    v_exp_f32 v15, v15
    v_exp_f32 v16, v16
    v_exp_f32 v17, v17
    v_mfma_f32_32x32x16_bf16 v[28:43], a[100:103], v[84:87], 0
    v_exp_f32 v18, v18
    v_exp_f32 v19, v19
    v_exp_f32 v20, v20
    v_mfma_f32_32x32x8_bf16 v[28:43], a[104:105], v[114:115], v[28:43]
    v_exp_f32 v21, v21
    v_exp_f32 v22, v22
    v_exp_f32 v23, v23
    v_exp_f32 v24, v24
    v_exp_f32 v25, v25
    v_exp_f32 v26, v26
    v_exp_f32 v27, v27
    s_waitcnt vmcnt(10)
    v_smfmac_f32_32x32x32_bf16 a[0:15], a[106:109], v[12:19], v51
    v_exp_f32 v28, v28
    v_exp_f32 v29, v29
    v_exp_f32 v30, v30
    v_smfmac_f32_32x32x32_bf16 a[0:15], a[110:113], v[20:27], v51
    v_exp_f32 v31, v31
    v_exp_f32 v32, v32
    v_exp_f32 v33, v33
    v_mfma_f32_32x32x16_bf16 v[12:27], a[100:103], v[88:91], 0
    v_exp_f32 v34, v34
    v_exp_f32 v35, v35
    v_exp_f32 v36, v36
    v_mfma_f32_32x32x8_bf16 v[12:27], a[104:105], v[116:117], v[12:27]
    v_exp_f32 v37, v37
    v_exp_f32 v38, v38
    buffer_load_dwordx4 v[72:75], v6, s[36:39], s8 offen offset:0 sc1
    v_exp_f32 v39, v39
    v_exp_f32 v40, v40
    buffer_load_dwordx4 v[76:79], v0, s[36:39], s8 offen offset:0 sc1
    v_exp_f32 v41, v41
    v_exp_f32 v42, v42
    v_exp_f32 v43, v43
    v_smfmac_f32_32x32x32_bf16 a[12:27], a[106:109], v[28:35], v51
    v_exp_f32 v12, v12
    v_exp_f32 v13, v13
    v_exp_f32 v14, v14
    v_smfmac_f32_32x32x32_bf16 a[12:27], a[110:113], v[36:43], v51
    v_exp_f32 v15, v15
    v_exp_f32 v16, v16
    v_exp_f32 v17, v17
    v_mfma_f32_32x32x16_bf16 v[28:43], a[100:103], v[92:95], 0
    v_exp_f32 v18, v18
    v_exp_f32 v19, v19
    v_exp_f32 v20, v20
    v_mfma_f32_32x32x8_bf16 v[28:43], a[104:105], v[118:119], v[28:43]
    v_exp_f32 v21, v21
    v_exp_f32 v22, v22
    v_exp_f32 v23, v23
    v_exp_f32 v24, v24
    v_exp_f32 v25, v25
    v_exp_f32 v26, v26
    v_exp_f32 v27, v27
    v_smfmac_f32_32x32x32_bf16 a[24:39], a[106:109], v[12:19], v51
    v_exp_f32 v28, v28
    v_exp_f32 v29, v29
    v_exp_f32 v30, v30
    v_smfmac_f32_32x32x32_bf16 a[24:39], a[110:113], v[20:27], v51
    v_exp_f32 v31, v31
    v_exp_f32 v32, v32
    v_exp_f32 v33, v33
    v_mfma_f32_32x32x16_bf16 v[12:27], a[100:103], v[96:99], 0
    v_exp_f32 v34, v34
    v_exp_f32 v35, v35
    v_exp_f32 v36, v36
    v_mfma_f32_32x32x8_bf16 v[12:27], a[104:105], v[120:121], v[12:27]
    v_exp_f32 v37, v37
    v_exp_f32 v38, v38
    v_exp_f32 v39, v39
    v_exp_f32 v40, v40
    v_exp_f32 v41, v41
    s_add_u32 s8, s8, 82560
    v_exp_f32 v42, v42
    v_exp_f32 v43, v43
    v_smfmac_f32_32x32x32_bf16 a[36:51], a[106:109], v[28:35], v51
    v_exp_f32 v12, v12
    v_exp_f32 v13, v13
    v_exp_f32 v14, v14
    v_smfmac_f32_32x32x32_bf16 a[36:51], a[110:113], v[36:43], v51
    v_exp_f32 v15, v15
    v_exp_f32 v16, v16
    v_exp_f32 v17, v17
    v_mfma_f32_32x32x16_bf16 v[28:43], a[100:103], v[100:103], 0
    v_exp_f32 v18, v18
    v_exp_f32 v19, v19
    v_exp_f32 v20, v20
    v_mfma_f32_32x32x8_bf16 v[28:43], a[104:105], v[122:123], v[28:43]
    v_exp_f32 v21, v21
    v_exp_f32 v22, v22
    v_exp_f32 v23, v23
    v_exp_f32 v24, v24
    v_exp_f32 v25, v25
    v_exp_f32 v26, v26
    v_exp_f32 v27, v27
    v_smfmac_f32_32x32x32_bf16 a[48:63], a[106:109], v[12:19], v51
    v_exp_f32 v28, v28
    v_exp_f32 v29, v29
    v_exp_f32 v30, v30
    v_smfmac_f32_32x32x32_bf16 a[48:63], a[110:113], v[20:27], v51
    v_exp_f32 v31, v31
    v_exp_f32 v32, v32
    v_exp_f32 v33, v33
    v_mfma_f32_32x32x16_bf16 v[12:27], a[100:103], v[104:107], 0
    v_exp_f32 v34, v34
    v_exp_f32 v35, v35
    v_exp_f32 v36, v36
    v_mfma_f32_32x32x8_bf16 v[12:27], a[104:105], v[124:125], v[12:27]
    v_exp_f32 v37, v37
    v_exp_f32 v38, v38
    v_exp_f32 v39, v39
    v_exp_f32 v40, v40
    v_exp_f32 v41, v41
    v_exp_f32 v42, v42
    v_exp_f32 v43, v43
    v_smfmac_f32_32x32x32_bf16 a[60:75], a[106:109], v[28:35], v51
    v_exp_f32 v12, v12
    v_exp_f32 v13, v13
    v_exp_f32 v14, v14
    v_smfmac_f32_32x32x32_bf16 a[60:75], a[110:113], v[36:43], v51
    v_exp_f32 v15, v15
    v_exp_f32 v16, v16
    v_exp_f32 v17, v17
    v_mfma_f32_32x32x16_bf16 v[28:43], a[100:103], v[108:111], 0
    v_exp_f32 v18, v18
    v_exp_f32 v19, v19
    v_exp_f32 v20, v20
    v_mfma_f32_32x32x8_bf16 v[28:43], a[104:105], v[126:127], v[28:43]
    v_exp_f32 v21, v21
    v_exp_f32 v22, v22
    v_exp_f32 v23, v23
    v_exp_f32 v24, v24
    v_exp_f32 v25, v25
    v_exp_f32 v26, v26
    v_exp_f32 v27, v27
    v_smfmac_f32_32x32x32_bf16 a[72:87], a[106:109], v[12:19], v51
    v_exp_f32 v28, v28
    v_exp_f32 v29, v29
    v_exp_f32 v30, v30
    v_smfmac_f32_32x32x32_bf16 a[72:87], a[110:113], v[20:27], v51
    v_exp_f32 v31, v31
    v_exp_f32 v32, v32
    v_exp_f32 v33, v33
    s_waitcnt vmcnt(10)
    v_mfma_f32_32x32x16_bf16 v[12:27], a[114:117], v[80:83], 0
    v_exp_f32 v34, v34
    v_exp_f32 v35, v35
    v_exp_f32 v36, v36
    v_mfma_f32_32x32x8_bf16 v[12:27], a[118:119], v[112:113], v[12:27]
    v_exp_f32 v37, v37
    v_exp_f32 v38, v38
    buffer_load_dwordx4 a[100:103], v4, s[36:39], s8 offen offset:0 sc1
    v_exp_f32 v39, v39
    v_exp_f32 v40, v40
    buffer_load_dwordx2 a[104:105], v5, s[36:39], s8 offen offset:0 sc1
    v_exp_f32 v41, v41
    v_exp_f32 v42, v42
    v_exp_f32 v43, v43
    v_smfmac_f32_32x32x32_bf16 a[84:99], a[106:109], v[28:35], v51
    v_exp_f32 v12, v12
    v_exp_f32 v13, v13
    v_exp_f32 v14, v14
    v_smfmac_f32_32x32x32_bf16 a[84:99], a[110:113], v[36:43], v51
    v_exp_f32 v15, v15
    v_exp_f32 v16, v16
    v_exp_f32 v17, v17
    v_mfma_f32_32x32x16_bf16 v[28:43], a[114:117], v[84:87], 0
    v_exp_f32 v18, v18
    v_exp_f32 v19, v19
    v_exp_f32 v20, v20
    v_mfma_f32_32x32x8_bf16 v[28:43], a[118:119], v[114:115], v[28:43]
    v_exp_f32 v21, v21
    v_exp_f32 v22, v22
    v_exp_f32 v23, v23
    v_exp_f32 v24, v24
    v_exp_f32 v25, v25
    v_exp_f32 v26, v26
    v_exp_f32 v27, v27
    s_waitcnt vmcnt(10)
    v_smfmac_f32_32x32x32_bf16 a[0:15], a[120:123], v[12:19], v51
    v_exp_f32 v28, v28
    v_exp_f32 v29, v29
    v_exp_f32 v30, v30
    v_smfmac_f32_32x32x32_bf16 a[0:15], a[124:127], v[20:27], v51
    v_exp_f32 v31, v31
    v_exp_f32 v32, v32
    v_exp_f32 v33, v33
    v_mfma_f32_32x32x16_bf16 v[12:27], a[114:117], v[88:91], 0
    v_exp_f32 v34, v34
    v_exp_f32 v35, v35
    v_exp_f32 v36, v36
    v_mfma_f32_32x32x8_bf16 v[12:27], a[118:119], v[116:117], v[12:27]
    v_exp_f32 v37, v37
    v_exp_f32 v38, v38
    buffer_load_dwordx4 a[106:109], v6, s[36:39], s8 offen offset:0 sc1
    v_exp_f32 v39, v39
    v_exp_f32 v40, v40
    buffer_load_dwordx4 a[110:113], v0, s[36:39], s8 offen offset:0 sc1
    v_exp_f32 v41, v41
    v_exp_f32 v42, v42
    v_exp_f32 v43, v43
    v_smfmac_f32_32x32x32_bf16 a[12:27], a[120:123], v[28:35], v51
    v_exp_f32 v12, v12
    v_exp_f32 v13, v13
    v_exp_f32 v14, v14
    v_smfmac_f32_32x32x32_bf16 a[12:27], a[124:127], v[36:43], v51
    v_exp_f32 v15, v15
    v_exp_f32 v16, v16
    v_exp_f32 v17, v17
    v_mfma_f32_32x32x16_bf16 v[28:43], a[114:117], v[92:95], 0
    v_exp_f32 v18, v18
    v_exp_f32 v19, v19
    v_exp_f32 v20, v20
    v_mfma_f32_32x32x8_bf16 v[28:43], a[118:119], v[118:119], v[28:43]
    v_exp_f32 v21, v21
    v_exp_f32 v22, v22
    v_exp_f32 v23, v23
    v_exp_f32 v24, v24
    v_exp_f32 v25, v25
    v_exp_f32 v26, v26
    v_exp_f32 v27, v27
    v_smfmac_f32_32x32x32_bf16 a[24:39], a[120:123], v[12:19], v51
    v_exp_f32 v28, v28
    v_exp_f32 v29, v29
    v_exp_f32 v30, v30
    v_smfmac_f32_32x32x32_bf16 a[24:39], a[124:127], v[20:27], v51
    v_exp_f32 v31, v31
    v_exp_f32 v32, v32
    v_exp_f32 v33, v33
    v_mfma_f32_32x32x16_bf16 v[12:27], a[114:117], v[96:99], 0
    v_exp_f32 v34, v34
    v_exp_f32 v35, v35
    v_exp_f32 v36, v36
    v_mfma_f32_32x32x8_bf16 v[12:27], a[118:119], v[120:121], v[12:27]
    v_exp_f32 v37, v37
    v_exp_f32 v38, v38
    v_exp_f32 v39, v39
    v_exp_f32 v40, v40
    v_exp_f32 v41, v41
    s_add_u32 s8, s8, 82560
    v_exp_f32 v42, v42
    v_exp_f32 v43, v43
    v_smfmac_f32_32x32x32_bf16 a[36:51], a[120:123], v[28:35], v51
    v_exp_f32 v12, v12
    v_exp_f32 v13, v13
    v_exp_f32 v14, v14
    v_smfmac_f32_32x32x32_bf16 a[36:51], a[124:127], v[36:43], v51
    v_exp_f32 v15, v15
    v_exp_f32 v16, v16
    v_exp_f32 v17, v17
    v_mfma_f32_32x32x16_bf16 v[28:43], a[114:117], v[100:103], 0
    v_exp_f32 v18, v18
    v_exp_f32 v19, v19
    v_exp_f32 v20, v20
    v_mfma_f32_32x32x8_bf16 v[28:43], a[118:119], v[122:123], v[28:43]
    v_exp_f32 v21, v21
    v_exp_f32 v22, v22
    v_exp_f32 v23, v23
    v_exp_f32 v24, v24
    v_exp_f32 v25, v25
    v_exp_f32 v26, v26
    v_exp_f32 v27, v27
    v_smfmac_f32_32x32x32_bf16 a[48:63], a[120:123], v[12:19], v51
    v_exp_f32 v28, v28
    v_exp_f32 v29, v29
    v_exp_f32 v30, v30
    v_smfmac_f32_32x32x32_bf16 a[48:63], a[124:127], v[20:27], v51
    v_exp_f32 v31, v31
    v_exp_f32 v32, v32
    v_exp_f32 v33, v33
    v_mfma_f32_32x32x16_bf16 v[12:27], a[114:117], v[104:107], 0
    v_exp_f32 v34, v34
    v_exp_f32 v35, v35
    v_exp_f32 v36, v36
    v_mfma_f32_32x32x8_bf16 v[12:27], a[118:119], v[124:125], v[12:27]
    v_exp_f32 v37, v37
    v_exp_f32 v38, v38
    v_exp_f32 v39, v39
    v_exp_f32 v40, v40
    v_exp_f32 v41, v41
    v_exp_f32 v42, v42
    v_exp_f32 v43, v43
    v_smfmac_f32_32x32x32_bf16 a[60:75], a[120:123], v[28:35], v51
    v_exp_f32 v12, v12
    v_exp_f32 v13, v13
    v_exp_f32 v14, v14
    v_smfmac_f32_32x32x32_bf16 a[60:75], a[124:127], v[36:43], v51
    v_exp_f32 v15, v15
    v_exp_f32 v16, v16
    v_exp_f32 v17, v17
    v_mfma_f32_32x32x16_bf16 v[28:43], a[114:117], v[108:111], 0
    v_exp_f32 v18, v18
    v_exp_f32 v19, v19
    v_exp_f32 v20, v20
    v_mfma_f32_32x32x8_bf16 v[28:43], a[118:119], v[126:127], v[28:43]
    v_exp_f32 v21, v21
    v_exp_f32 v22, v22
    v_exp_f32 v23, v23
    v_exp_f32 v24, v24
    v_exp_f32 v25, v25
    v_exp_f32 v26, v26
    v_exp_f32 v27, v27
    v_smfmac_f32_32x32x32_bf16 a[72:87], a[120:123], v[12:19], v51
    v_exp_f32 v28, v28
    v_exp_f32 v29, v29
    v_exp_f32 v30, v30
    v_smfmac_f32_32x32x32_bf16 a[72:87], a[124:127], v[20:27], v51
    v_exp_f32 v31, v31
    v_exp_f32 v32, v32
    v_exp_f32 v33, v33
    s_waitcnt vmcnt(10)
    v_mfma_f32_32x32x16_bf16 v[12:27], v[52:55], v[80:83], 0
    v_exp_f32 v34, v34
    v_exp_f32 v35, v35
    v_exp_f32 v36, v36
    v_mfma_f32_32x32x8_bf16 v[12:27], v[60:61], v[112:113], v[12:27]
    v_exp_f32 v37, v37
    v_exp_f32 v38, v38
    buffer_load_dwordx4 a[114:117], v4, s[36:39], s8 offen offset:0 sc1
    v_exp_f32 v39, v39
    v_exp_f32 v40, v40
    buffer_load_dwordx2 a[118:119], v5, s[36:39], s8 offen offset:0 sc1
    v_exp_f32 v41, v41
    s_sub_u32 s63, s63, 1
    s_cmp_lg_u32 s63, 0
    v_exp_f32 v42, v42
    v_exp_f32 v43, v43
    s_cbranch_scc1 L_att_loop
    v_mov_b32 v10, 159744
Lw_61:
    ds_read_b32 v11, v10
    s_waitcnt lgkmcnt(0)
    v_readfirstlane_b32 s54, v11
    s_cmp_ge_u32 s54, 4
    s_cbranch_scc1 Lwd_62
    s_sleep 1
    s_branch Lw_61
Lwd_62:
    v_smfmac_f32_32x32x32_bf16 a[84:99], a[120:123], v[28:35], v51
    v_exp_f32 v12, v12
    v_exp_f32 v13, v13
    v_exp_f32 v14, v14
    v_smfmac_f32_32x32x32_bf16 a[84:99], a[124:127], v[36:43], v51
    v_exp_f32 v15, v15
    v_exp_f32 v16, v16
    v_exp_f32 v17, v17
    v_mfma_f32_32x32x16_bf16 v[28:43], v[52:55], v[84:87], 0
    v_exp_f32 v18, v18
    v_exp_f32 v19, v19
    v_exp_f32 v20, v20
    v_mfma_f32_32x32x8_bf16 v[28:43], v[60:61], v[114:115], v[28:43]
    v_exp_f32 v21, v21
    v_exp_f32 v22, v22
    v_exp_f32 v23, v23
    v_exp_f32 v24, v24
    v_exp_f32 v25, v25
    v_exp_f32 v26, v26
    v_exp_f32 v27, v27
    s_waitcnt vmcnt(10)
    v_smfmac_f32_32x32x32_bf16 a[0:15], v[64:67], v[12:19], v51
    v_exp_f32 v28, v28
    v_exp_f32 v29, v29
    v_exp_f32 v30, v30
    v_smfmac_f32_32x32x32_bf16 a[0:15], v[68:71], v[20:27], v51
    v_exp_f32 v31, v31
    v_exp_f32 v32, v32
    v_exp_f32 v33, v33
    v_mfma_f32_32x32x16_bf16 v[12:27], v[52:55], v[88:91], 0
    v_exp_f32 v34, v34
    v_exp_f32 v35, v35
    v_exp_f32 v36, v36
    v_mfma_f32_32x32x8_bf16 v[12:27], v[60:61], v[116:117], v[12:27]
    v_exp_f32 v37, v37
    v_exp_f32 v38, v38
    buffer_load_dwordx4 a[120:123], v6, s[36:39], s8 offen offset:0 sc1
    v_exp_f32 v39, v39
    v_exp_f32 v40, v40
    buffer_load_dwordx4 a[124:127], v0, s[36:39], s8 offen offset:0 sc1
    v_exp_f32 v41, v41
    v_exp_f32 v42, v42
    v_exp_f32 v43, v43
    v_smfmac_f32_32x32x32_bf16 a[12:27], v[64:67], v[28:35], v51
    v_exp_f32 v12, v12
    v_exp_f32 v13, v13
    v_exp_f32 v14, v14
    v_smfmac_f32_32x32x32_bf16 a[12:27], v[68:71], v[36:43], v51
    v_exp_f32 v15, v15
    v_exp_f32 v16, v16
    v_exp_f32 v17, v17
    v_mfma_f32_32x32x16_bf16 v[28:43], v[52:55], v[92:95], 0
    v_exp_f32 v18, v18
    v_exp_f32 v19, v19
    v_exp_f32 v20, v20
    v_mfma_f32_32x32x8_bf16 v[28:43], v[60:61], v[118:119], v[28:43]
    v_exp_f32 v21, v21
    v_exp_f32 v22, v22
    v_exp_f32 v23, v23
    v_exp_f32 v24, v24
    v_exp_f32 v25, v25
    v_exp_f32 v26, v26
    v_exp_f32 v27, v27
    v_smfmac_f32_32x32x32_bf16 a[24:39], v[64:67], v[12:19], v51
    v_exp_f32 v28, v28
    v_exp_f32 v29, v29
    v_exp_f32 v30, v30
    v_smfmac_f32_32x32x32_bf16 a[24:39], v[68:71], v[20:27], v51
    v_exp_f32 v31, v31
    v_exp_f32 v32, v32
    v_exp_f32 v33, v33
    v_mfma_f32_32x32x16_bf16 v[12:27], v[52:55], v[96:99], 0
    v_exp_f32 v34, v34
    v_exp_f32 v35, v35
    v_exp_f32 v36, v36
    v_mfma_f32_32x32x8_bf16 v[12:27], v[60:61], v[120:121], v[12:27]
    v_exp_f32 v37, v37
    v_exp_f32 v38, v38
    v_exp_f32 v39, v39
    v_exp_f32 v40, v40
    v_exp_f32 v41, v41
    v_exp_f32 v42, v42
    v_exp_f32 v43, v43
    v_smfmac_f32_32x32x32_bf16 a[36:51], v[64:67], v[28:35], v51
    v_exp_f32 v12, v12
    v_exp_f32 v13, v13
    v_exp_f32 v14, v14
    v_smfmac_f32_32x32x32_bf16 a[36:51], v[68:71], v[36:43], v51
    v_exp_f32 v15, v15
    v_exp_f32 v16, v16
    v_exp_f32 v17, v17
    v_mfma_f32_32x32x16_bf16 v[28:43], v[52:55], v[100:103], 0
    v_exp_f32 v18, v18
    v_exp_f32 v19, v19
    v_exp_f32 v20, v20
    v_mfma_f32_32x32x8_bf16 v[28:43], v[60:61], v[122:123], v[28:43]
    v_exp_f32 v21, v21
    v_exp_f32 v22, v22
    v_exp_f32 v23, v23
    v_exp_f32 v24, v24
    v_exp_f32 v25, v25
    v_exp_f32 v26, v26
    v_exp_f32 v27, v27
    v_smfmac_f32_32x32x32_bf16 a[48:63], v[64:67], v[12:19], v51
    v_exp_f32 v28, v28
    v_exp_f32 v29, v29
    v_exp_f32 v30, v30
    v_smfmac_f32_32x32x32_bf16 a[48:63], v[68:71], v[20:27], v51
    v_exp_f32 v31, v31
    v_exp_f32 v32, v32
    v_exp_f32 v33, v33
    v_mfma_f32_32x32x16_bf16 v[12:27], v[52:55], v[104:107], 0
    v_exp_f32 v34, v34
    v_exp_f32 v35, v35
    v_exp_f32 v36, v36
    v_mfma_f32_32x32x8_bf16 v[12:27], v[60:61], v[124:125], v[12:27]
    v_exp_f32 v37, v37
    v_exp_f32 v38, v38
    v_exp_f32 v39, v39
    v_exp_f32 v40, v40
    v_exp_f32 v41, v41
    v_exp_f32 v42, v42
    v_exp_f32 v43, v43
    v_smfmac_f32_32x32x32_bf16 a[60:75], v[64:67], v[28:35], v51
    v_exp_f32 v12, v12
    v_exp_f32 v13, v13
    v_exp_f32 v14, v14
    v_smfmac_f32_32x32x32_bf16 a[60:75], v[68:71], v[36:43], v51
    v_exp_f32 v15, v15
    v_exp_f32 v16, v16
    v_exp_f32 v17, v17
    v_mfma_f32_32x32x16_bf16 v[28:43], v[52:55], v[108:111], 0
    v_exp_f32 v18, v18
    v_exp_f32 v19, v19
    v_exp_f32 v20, v20
    v_mfma_f32_32x32x8_bf16 v[28:43], v[60:61], v[126:127], v[28:43]
    v_exp_f32 v21, v21
    v_exp_f32 v22, v22
    v_exp_f32 v23, v23
    v_exp_f32 v24, v24
    v_exp_f32 v25, v25
    v_exp_f32 v26, v26
    v_exp_f32 v27, v27
    v_smfmac_f32_32x32x32_bf16 a[72:87], v[64:67], v[12:19], v51
    v_exp_f32 v28, v28
    v_exp_f32 v29, v29
    v_exp_f32 v30, v30
    v_smfmac_f32_32x32x32_bf16 a[72:87], v[68:71], v[20:27], v51
    v_exp_f32 v31, v31
    v_exp_f32 v32, v32
    v_exp_f32 v33, v33
    s_waitcnt vmcnt(10)
    v_mfma_f32_32x32x16_bf16 v[12:27], v[56:59], v[80:83], 0
    v_exp_f32 v34, v34
    v_exp_f32 v35, v35
    v_exp_f32 v36, v36
    v_mfma_f32_32x32x8_bf16 v[12:27], v[62:63], v[112:113], v[12:27]
    v_exp_f32 v37, v37
    v_exp_f32 v38, v38
    v_exp_f32 v39, v39
    v_exp_f32 v40, v40
    v_exp_f32 v41, v41
    v_exp_f32 v42, v42
    v_exp_f32 v43, v43
    v_smfmac_f32_32x32x32_bf16 a[84:99], v[64:67], v[28:35], v51
    v_exp_f32 v12, v12
    v_exp_f32 v13, v13
    v_exp_f32 v14, v14
    v_smfmac_f32_32x32x32_bf16 a[84:99], v[68:71], v[36:43], v51
    v_exp_f32 v15, v15
    v_exp_f32 v16, v16
    v_exp_f32 v17, v17
    v_mfma_f32_32x32x16_bf16 v[28:43], v[56:59], v[84:87], 0
    v_exp_f32 v18, v18
    v_exp_f32 v19, v19
    v_exp_f32 v20, v20
    v_mfma_f32_32x32x8_bf16 v[28:43], v[62:63], v[114:115], v[28:43]
    v_exp_f32 v21, v21
    v_exp_f32 v22, v22
    v_exp_f32 v23, v23
    v_exp_f32 v24, v24
    v_exp_f32 v25, v25
    v_exp_f32 v26, v26
    v_exp_f32 v27, v27
    s_waitcnt vmcnt(8)
    v_smfmac_f32_32x32x32_bf16 a[0:15], v[72:75], v[12:19], v51
    v_exp_f32 v28, v28
    v_exp_f32 v29, v29
    v_exp_f32 v30, v30
    v_smfmac_f32_32x32x32_bf16 a[0:15], v[76:79], v[20:27], v51
    v_exp_f32 v31, v31
    v_exp_f32 v32, v32
    v_exp_f32 v33, v33
    v_mfma_f32_32x32x16_bf16 v[12:27], v[56:59], v[88:91], 0
    v_exp_f32 v34, v34
    v_exp_f32 v35, v35
    v_exp_f32 v36, v36
    v_mfma_f32_32x32x8_bf16 v[12:27], v[62:63], v[116:117], v[12:27]
    v_exp_f32 v37, v37
    v_exp_f32 v38, v38
    v_exp_f32 v39, v39
    v_exp_f32 v40, v40
    v_exp_f32 v41, v41
    v_exp_f32 v42, v42
    v_exp_f32 v43, v43
    v_smfmac_f32_32x32x32_bf16 a[12:27], v[72:75], v[28:35], v51
    v_exp_f32 v12, v12
    v_exp_f32 v13, v13
    v_exp_f32 v14, v14
    v_smfmac_f32_32x32x32_bf16 a[12:27], v[76:79], v[36:43], v51
    v_exp_f32 v15, v15
    v_exp_f32 v16, v16
    v_exp_f32 v17, v17
    v_mfma_f32_32x32x16_bf16 v[28:43], v[56:59], v[92:95], 0
    v_exp_f32 v18, v18
    v_exp_f32 v19, v19
    v_exp_f32 v20, v20
    v_mfma_f32_32x32x8_bf16 v[28:43], v[62:63], v[118:119], v[28:43]
    v_exp_f32 v21, v21
    v_exp_f32 v22, v22
    v_exp_f32 v23, v23
    v_exp_f32 v24, v24
    v_exp_f32 v25, v25
    v_exp_f32 v26, v26
    v_exp_f32 v27, v27
    v_smfmac_f32_32x32x32_bf16 a[24:39], v[72:75], v[12:19], v51
    v_exp_f32 v28, v28
    v_exp_f32 v29, v29
    v_exp_f32 v30, v30
    v_smfmac_f32_32x32x32_bf16 a[24:39], v[76:79], v[20:27], v51
    v_exp_f32 v31, v31
    v_exp_f32 v32, v32
    v_exp_f32 v33, v33
    v_mfma_f32_32x32x16_bf16 v[12:27], v[56:59], v[96:99], 0
    v_exp_f32 v34, v34
    v_exp_f32 v35, v35
    v_exp_f32 v36, v36
    v_mfma_f32_32x32x8_bf16 v[12:27], v[62:63], v[120:121], v[12:27]
    v_exp_f32 v37, v37
    v_exp_f32 v38, v38
    v_exp_f32 v39, v39
    v_exp_f32 v40, v40
    v_exp_f32 v41, v41
    v_exp_f32 v42, v42
    v_exp_f32 v43, v43
    v_smfmac_f32_32x32x32_bf16 a[36:51], v[72:75], v[28:35], v51
    v_exp_f32 v12, v12
    v_exp_f32 v13, v13
    v_exp_f32 v14, v14
    v_smfmac_f32_32x32x32_bf16 a[36:51], v[76:79], v[36:43], v51
    v_exp_f32 v15, v15
    v_exp_f32 v16, v16
    v_exp_f32 v17, v17
    v_mfma_f32_32x32x16_bf16 v[28:43], v[56:59], v[100:103], 0
    v_exp_f32 v18, v18
    v_exp_f32 v19, v19
    v_exp_f32 v20, v20
    v_mfma_f32_32x32x8_bf16 v[28:43], v[62:63], v[122:123], v[28:43]
    v_exp_f32 v21, v21
    v_exp_f32 v22, v22
    v_exp_f32 v23, v23
    v_exp_f32 v24, v24
    v_exp_f32 v25, v25
    v_exp_f32 v26, v26
    v_exp_f32 v27, v27
    v_smfmac_f32_32x32x32_bf16 a[48:63], v[72:75], v[12:19], v51
    v_exp_f32 v28, v28
    v_exp_f32 v29, v29
    v_exp_f32 v30, v30
    v_smfmac_f32_32x32x32_bf16 a[48:63], v[76:79], v[20:27], v51
    v_exp_f32 v31, v31
    v_exp_f32 v32, v32
    v_exp_f32 v33, v33
    v_mfma_f32_32x32x16_bf16 v[12:27], v[56:59], v[104:107], 0
    v_exp_f32 v34, v34
    v_exp_f32 v35, v35
    v_exp_f32 v36, v36
    v_mfma_f32_32x32x8_bf16 v[12:27], v[62:63], v[124:125], v[12:27]
    v_exp_f32 v37, v37
    v_exp_f32 v38, v38
    v_exp_f32 v39, v39
    v_exp_f32 v40, v40
    v_exp_f32 v41, v41
    v_exp_f32 v42, v42
    v_exp_f32 v43, v43
    v_smfmac_f32_32x32x32_bf16 a[60:75], v[72:75], v[28:35], v51
    v_exp_f32 v12, v12
    v_exp_f32 v13, v13
    v_exp_f32 v14, v14
    v_smfmac_f32_32x32x32_bf16 a[60:75], v[76:79], v[36:43], v51
    v_exp_f32 v15, v15
    v_exp_f32 v16, v16
    v_exp_f32 v17, v17
    v_mfma_f32_32x32x16_bf16 v[28:43], v[56:59], v[108:111], 0
    v_exp_f32 v18, v18
    v_exp_f32 v19, v19
    v_exp_f32 v20, v20
    v_mfma_f32_32x32x8_bf16 v[28:43], v[62:63], v[126:127], v[28:43]
    v_exp_f32 v21, v21
    v_exp_f32 v22, v22
    v_exp_f32 v23, v23
    v_exp_f32 v24, v24
    v_exp_f32 v25, v25
    v_exp_f32 v26, v26
    v_exp_f32 v27, v27
    v_smfmac_f32_32x32x32_bf16 a[72:87], v[72:75], v[12:19], v51
    v_exp_f32 v28, v28
    v_exp_f32 v29, v29
    v_exp_f32 v30, v30
    v_smfmac_f32_32x32x32_bf16 a[72:87], v[76:79], v[20:27], v51
    v_exp_f32 v31, v31
    v_exp_f32 v32, v32
    v_exp_f32 v33, v33
    s_waitcnt vmcnt(6)
    v_mfma_f32_32x32x16_bf16 v[12:27], a[100:103], v[80:83], 0
    v_exp_f32 v34, v34
    v_exp_f32 v35, v35
    v_exp_f32 v36, v36
    v_mfma_f32_32x32x8_bf16 v[12:27], a[104:105], v[112:113], v[12:27]
    v_exp_f32 v37, v37
    v_exp_f32 v38, v38
    v_exp_f32 v39, v39
    v_exp_f32 v40, v40
    v_exp_f32 v41, v41
    v_exp_f32 v42, v42
    v_exp_f32 v43, v43
    v_smfmac_f32_32x32x32_bf16 a[84:99], v[72:75], v[28:35], v51
    v_exp_f32 v12, v12
    v_exp_f32 v13, v13
    v_exp_f32 v14, v14
    v_smfmac_f32_32x32x32_bf16 a[84:99], v[76:79], v[36:43], v51
    v_exp_f32 v15, v15
    v_exp_f32 v16, v16
    v_exp_f32 v17, v17
    v_mfma_f32_32x32x16_bf16 v[28:43], a[100:103], v[84:87], 0
    v_exp_f32 v18, v18
    v_exp_f32 v19, v19
    v_exp_f32 v20, v20
    v_mfma_f32_32x32x8_bf16 v[28:43], a[104:105], v[114:115], v[28:43]
    v_exp_f32 v21, v21
    v_exp_f32 v22, v22
    v_exp_f32 v23, v23
    v_exp_f32 v24, v24
    v_exp_f32 v25, v25
    v_exp_f32 v26, v26
    v_exp_f32 v27, v27
    s_waitcnt vmcnt(4)
    v_smfmac_f32_32x32x32_bf16 a[0:15], a[106:109], v[12:19], v51
    v_exp_f32 v28, v28
    v_exp_f32 v29, v29
    v_exp_f32 v30, v30
    v_smfmac_f32_32x32x32_bf16 a[0:15], a[110:113], v[20:27], v51
    v_exp_f32 v31, v31
    v_exp_f32 v32, v32
    v_exp_f32 v33, v33
    v_mfma_f32_32x32x16_bf16 v[12:27], a[100:103], v[88:91], 0
    v_exp_f32 v34, v34
    v_exp_f32 v35, v35
    v_exp_f32 v36, v36
    v_mfma_f32_32x32x8_bf16 v[12:27], a[104:105], v[116:117], v[12:27]
    v_exp_f32 v37, v37
    v_exp_f32 v38, v38
    v_exp_f32 v39, v39
    v_exp_f32 v40, v40
    v_exp_f32 v41, v41
    v_exp_f32 v42, v42
    v_exp_f32 v43, v43
    v_smfmac_f32_32x32x32_bf16 a[12:27], a[106:109], v[28:35], v51
    v_exp_f32 v12, v12
    v_exp_f32 v13, v13
    v_exp_f32 v14, v14
    v_smfmac_f32_32x32x32_bf16 a[12:27], a[110:113], v[36:43], v51
    v_exp_f32 v15, v15
    v_exp_f32 v16, v16
    v_exp_f32 v17, v17
    v_mfma_f32_32x32x16_bf16 v[28:43], a[100:103], v[92:95], 0
    v_exp_f32 v18, v18
    v_exp_f32 v19, v19
    v_exp_f32 v20, v20
    v_mfma_f32_32x32x8_bf16 v[28:43], a[104:105], v[118:119], v[28:43]
    v_exp_f32 v21, v21
    v_exp_f32 v22, v22
    v_exp_f32 v23, v23
    v_exp_f32 v24, v24
    v_exp_f32 v25, v25
    v_exp_f32 v26, v26
    v_exp_f32 v27, v27
    v_smfmac_f32_32x32x32_bf16 a[24:39], a[106:109], v[12:19], v51
    v_exp_f32 v28, v28
    v_exp_f32 v29, v29
    v_exp_f32 v30, v30
    v_smfmac_f32_32x32x32_bf16 a[24:39], a[110:113], v[20:27], v51
    v_exp_f32 v31, v31
    v_exp_f32 v32, v32
    v_exp_f32 v33, v33
    v_mfma_f32_32x32x16_bf16 v[12:27], a[100:103], v[96:99], 0
    v_exp_f32 v34, v34
    v_exp_f32 v35, v35
    v_exp_f32 v36, v36
    v_mfma_f32_32x32x8_bf16 v[12:27], a[104:105], v[120:121], v[12:27]
    v_exp_f32 v37, v37
    v_exp_f32 v38, v38
    v_exp_f32 v39, v39
    v_exp_f32 v40, v40
    v_exp_f32 v41, v41
    v_exp_f32 v42, v42
    v_exp_f32 v43, v43
    v_smfmac_f32_32x32x32_bf16 a[36:51], a[106:109], v[28:35], v51
    v_exp_f32 v12, v12
    v_exp_f32 v13, v13
    v_exp_f32 v14, v14
    v_smfmac_f32_32x32x32_bf16 a[36:51], a[110:113], v[36:43], v51
    v_exp_f32 v15, v15
    v_exp_f32 v16, v16
    v_exp_f32 v17, v17
    v_mfma_f32_32x32x16_bf16 v[28:43], a[100:103], v[100:103], 0
    v_exp_f32 v18, v18
    v_exp_f32 v19, v19
    v_exp_f32 v20, v20
    v_mfma_f32_32x32x8_bf16 v[28:43], a[104:105], v[122:123], v[28:43]
    v_exp_f32 v21, v21
    v_exp_f32 v22, v22
    v_exp_f32 v23, v23
    v_exp_f32 v24, v24
    v_exp_f32 v25, v25
    v_exp_f32 v26, v26
    v_exp_f32 v27, v27
    v_smfmac_f32_32x32x32_bf16 a[48:63], a[106:109], v[12:19], v51
    v_exp_f32 v28, v28
    v_exp_f32 v29, v29
    v_exp_f32 v30, v30
    v_smfmac_f32_32x32x32_bf16 a[48:63], a[110:113], v[20:27], v51
    v_exp_f32 v31, v31
    v_exp_f32 v32, v32
    v_exp_f32 v33, v33
    v_mfma_f32_32x32x16_bf16 v[12:27], a[100:103], v[104:107], 0
    v_exp_f32 v34, v34
    v_exp_f32 v35, v35
    v_exp_f32 v36, v36
    v_mfma_f32_32x32x8_bf16 v[12:27], a[104:105], v[124:125], v[12:27]
    v_exp_f32 v37, v37
    v_exp_f32 v38, v38
    v_exp_f32 v39, v39
    v_exp_f32 v40, v40
    v_exp_f32 v41, v41
    v_exp_f32 v42, v42
    v_exp_f32 v43, v43
    v_smfmac_f32_32x32x32_bf16 a[60:75], a[106:109], v[28:35], v51
    v_exp_f32 v12, v12
    v_exp_f32 v13, v13
    v_exp_f32 v14, v14
    v_smfmac_f32_32x32x32_bf16 a[60:75], a[110:113], v[36:43], v51
    v_exp_f32 v15, v15
    v_exp_f32 v16, v16
    v_exp_f32 v17, v17
    v_mfma_f32_32x32x16_bf16 v[28:43], a[100:103], v[108:111], 0
    v_exp_f32 v18, v18
    v_exp_f32 v19, v19
    v_exp_f32 v20, v20
    v_mfma_f32_32x32x8_bf16 v[28:43], a[104:105], v[126:127], v[28:43]
    v_exp_f32 v21, v21
    v_exp_f32 v22, v22
    v_exp_f32 v23, v23
    v_exp_f32 v24, v24
    v_exp_f32 v25, v25
    v_exp_f32 v26, v26
    v_exp_f32 v27, v27
    v_smfmac_f32_32x32x32_bf16 a[72:87], a[106:109], v[12:19], v51
    v_exp_f32 v28, v28
    v_exp_f32 v29, v29
    v_exp_f32 v30, v30
    v_smfmac_f32_32x32x32_bf16 a[72:87], a[110:113], v[20:27], v51
    v_exp_f32 v31, v31
    v_exp_f32 v32, v32
    v_exp_f32 v33, v33
    s_waitcnt vmcnt(2)
    v_mfma_f32_32x32x16_bf16 v[12:27], a[114:117], v[80:83], 0
    v_exp_f32 v34, v34
    v_exp_f32 v35, v35
    v_exp_f32 v36, v36
    v_mfma_f32_32x32x8_bf16 v[12:27], a[118:119], v[112:113], v[12:27]
    v_exp_f32 v37, v37
    v_exp_f32 v38, v38
    v_exp_f32 v39, v39
    v_exp_f32 v40, v40
    v_exp_f32 v41, v41
    v_exp_f32 v42, v42
    v_exp_f32 v43, v43
    v_smfmac_f32_32x32x32_bf16 a[84:99], a[106:109], v[28:35], v51
    v_exp_f32 v12, v12
    v_exp_f32 v13, v13
    v_exp_f32 v14, v14
    v_smfmac_f32_32x32x32_bf16 a[84:99], a[110:113], v[36:43], v51
    v_exp_f32 v15, v15
    v_exp_f32 v16, v16
    v_exp_f32 v17, v17
    v_mfma_f32_32x32x16_bf16 v[28:43], a[114:117], v[84:87], 0
    v_exp_f32 v18, v18
    v_exp_f32 v19, v19
    v_exp_f32 v20, v20
    v_mfma_f32_32x32x8_bf16 v[28:43], a[118:119], v[114:115], v[28:43]
    v_exp_f32 v21, v21
    v_exp_f32 v22, v22
    v_exp_f32 v23, v23
    v_exp_f32 v24, v24
    v_exp_f32 v25, v25
    v_exp_f32 v26, v26
    v_exp_f32 v27, v27
    s_waitcnt vmcnt(0)
    v_smfmac_f32_32x32x32_bf16 a[0:15], a[120:123], v[12:19], v51
    v_exp_f32 v28, v28
    v_exp_f32 v29, v29
    v_exp_f32 v30, v30
    v_smfmac_f32_32x32x32_bf16 a[0:15], a[124:127], v[20:27], v51
    v_exp_f32 v31, v31
    v_exp_f32 v32, v32
    v_exp_f32 v33, v33
    v_mfma_f32_32x32x16_bf16 v[12:27], a[114:117], v[88:91], 0
    v_exp_f32 v34, v34
    v_exp_f32 v35, v35
    v_exp_f32 v36, v36
    v_mfma_f32_32x32x8_bf16 v[12:27], a[118:119], v[116:117], v[12:27]
    v_exp_f32 v37, v37
    v_exp_f32 v38, v38
    v_exp_f32 v39, v39
    v_exp_f32 v40, v40
    ds_write_b128 v7, a[0:3] offset:0
    v_exp_f32 v41, v41
    ds_write_b128 v7, a[4:7] offset:1024
    v_exp_f32 v42, v42
    ds_write_b128 v7, a[8:11] offset:2048
    v_exp_f32 v43, v43
    v_smfmac_f32_32x32x32_bf16 a[12:27], a[120:123], v[28:35], v51
    v_exp_f32 v12, v12
    v_exp_f32 v13, v13
    v_exp_f32 v14, v14
    v_smfmac_f32_32x32x32_bf16 a[12:27], a[124:127], v[36:43], v51
    v_exp_f32 v15, v15
    v_exp_f32 v16, v16
    v_exp_f32 v17, v17
    v_mfma_f32_32x32x16_bf16 v[28:43], a[114:117], v[92:95], 0
    v_exp_f32 v18, v18
    v_exp_f32 v19, v19
    v_exp_f32 v20, v20
    v_mfma_f32_32x32x8_bf16 v[28:43], a[118:119], v[118:119], v[28:43]
    v_exp_f32 v21, v21
    v_exp_f32 v22, v22
    v_exp_f32 v23, v23
    v_exp_f32 v24, v24
    ds_write_b128 v7, a[12:15] offset:9216
    v_exp_f32 v25, v25
    ds_write_b128 v7, a[16:19] offset:10240
    v_exp_f32 v26, v26
    ds_write_b128 v7, a[20:23] offset:11264
    v_exp_f32 v27, v27
    v_smfmac_f32_32x32x32_bf16 a[24:39], a[120:123], v[12:19], v51
    v_exp_f32 v28, v28
    v_exp_f32 v29, v29
    v_exp_f32 v30, v30
    v_smfmac_f32_32x32x32_bf16 a[24:39], a[124:127], v[20:27], v51
    v_exp_f32 v31, v31
    v_exp_f32 v32, v32
    v_exp_f32 v33, v33
    v_mfma_f32_32x32x16_bf16 v[12:27], a[114:117], v[96:99], 0
    v_exp_f32 v34, v34
    v_exp_f32 v35, v35
    v_exp_f32 v36, v36
    v_mfma_f32_32x32x8_bf16 v[12:27], a[118:119], v[120:121], v[12:27]
    v_exp_f32 v37, v37
    v_exp_f32 v38, v38
    v_exp_f32 v39, v39
    v_exp_f32 v40, v40
    ds_write_b128 v8, a[24:27] offset:0
    v_exp_f32 v41, v41
    ds_write_b128 v8, a[28:31] offset:1024
    v_exp_f32 v42, v42
    ds_write_b128 v8, a[32:35] offset:2048
    v_exp_f32 v43, v43
    v_smfmac_f32_32x32x32_bf16 a[36:51], a[120:123], v[28:35], v51
    v_exp_f32 v12, v12
    v_exp_f32 v13, v13
    v_exp_f32 v14, v14
    v_smfmac_f32_32x32x32_bf16 a[36:51], a[124:127], v[36:43], v51
    v_exp_f32 v15, v15
    v_exp_f32 v16, v16
    v_exp_f32 v17, v17
    v_mfma_f32_32x32x16_bf16 v[28:43], a[114:117], v[100:103], 0
    v_exp_f32 v18, v18
    v_exp_f32 v19, v19
    v_exp_f32 v20, v20
    v_mfma_f32_32x32x8_bf16 v[28:43], a[118:119], v[122:123], v[28:43]
    v_exp_f32 v21, v21
    v_exp_f32 v22, v22
    v_exp_f32 v23, v23
    v_exp_f32 v24, v24
    ds_write_b128 v8, a[36:39] offset:9216
    v_exp_f32 v25, v25
    ds_write_b128 v8, a[40:43] offset:10240
    v_exp_f32 v26, v26
    ds_write_b128 v8, a[44:47] offset:11264
    v_exp_f32 v27, v27
    v_smfmac_f32_32x32x32_bf16 a[48:63], a[120:123], v[12:19], v51
    v_exp_f32 v28, v28
    v_exp_f32 v29, v29
    v_exp_f32 v30, v30
    v_smfmac_f32_32x32x32_bf16 a[48:63], a[124:127], v[20:27], v51
    v_exp_f32 v31, v31
    v_exp_f32 v32, v32
    v_exp_f32 v33, v33
    v_mfma_f32_32x32x16_bf16 v[12:27], a[114:117], v[104:107], 0
    v_exp_f32 v34, v34
    v_exp_f32 v35, v35
    v_exp_f32 v36, v36
    v_mfma_f32_32x32x8_bf16 v[12:27], a[118:119], v[124:125], v[12:27]
    v_exp_f32 v37, v37
    v_exp_f32 v38, v38
    v_exp_f32 v39, v39
    v_exp_f32 v40, v40
    ds_write_b128 v9, a[48:51] offset:0
    v_exp_f32 v41, v41
    ds_write_b128 v9, a[52:55] offset:1024
    v_exp_f32 v42, v42
    ds_write_b128 v9, a[56:59] offset:2048
    v_exp_f32 v43, v43
    v_smfmac_f32_32x32x32_bf16 a[60:75], a[120:123], v[28:35], v51
    v_exp_f32 v12, v12
    v_exp_f32 v13, v13
    v_exp_f32 v14, v14
    v_smfmac_f32_32x32x32_bf16 a[60:75], a[124:127], v[36:43], v51
    v_exp_f32 v15, v15
    v_exp_f32 v16, v16
    v_exp_f32 v17, v17
    v_mfma_f32_32x32x16_bf16 v[28:43], a[114:117], v[108:111], 0
    v_exp_f32 v18, v18
    v_exp_f32 v19, v19
    v_exp_f32 v20, v20
    v_mfma_f32_32x32x8_bf16 v[28:43], a[118:119], v[126:127], v[28:43]
    v_exp_f32 v21, v21
    v_exp_f32 v22, v22
    v_exp_f32 v23, v23
    v_exp_f32 v24, v24
    ds_write_b128 v9, a[60:63] offset:9216
    v_exp_f32 v25, v25
    ds_write_b128 v9, a[64:67] offset:10240
    v_exp_f32 v26, v26
    ds_write_b128 v9, a[68:71] offset:11264
    v_exp_f32 v27, v27
    v_smfmac_f32_32x32x32_bf16 a[72:87], a[120:123], v[12:19], v51
    v_exp_f32 v28, v28
    v_exp_f32 v29, v29
    v_exp_f32 v30, v30
    v_smfmac_f32_32x32x32_bf16 a[72:87], a[124:127], v[20:27], v51
    v_exp_f32 v31, v31
    v_exp_f32 v32, v32
    v_exp_f32 v33, v33
    v_exp_f32 v34, v34
    v_exp_f32 v35, v35
    v_exp_f32 v36, v36
    v_exp_f32 v37, v37
    v_exp_f32 v38, v38
    v_exp_f32 v39, v39
    v_exp_f32 v40, v40
    v_exp_f32 v41, v41
    v_exp_f32 v42, v42
    v_exp_f32 v43, v43
    s_setprio 3
    s_waitcnt lgkmcnt(0)
    s_nop 0
    v_smfmac_f32_32x32x32_bf16 a[84:99], a[120:123], v[28:35], v51
    v_smfmac_f32_32x32x32_bf16 a[84:99], a[124:127], v[36:43], v51
    v_mov_b32 v7, 159752
    v_mov_b32 v8, 1
    s_mov_b64 exec, 1
    ds_add_u32 v7, v8
    s_mov_b64 exec, -1
    v_lshlrev_b32 v60, 4, v1
    s_mul_i32 s53, s45, 18432
    v_add_u32 v9, s53, v60
    v_lshlrev_b32 v10, 30, v3
    v_lshl_add_u32 v10, v2, 3, v10
    v_accvgpr_read_b32 v12, a72
    v_accvgpr_read_b32 v13, a73
    v_accvgpr_read_b32 v14, a74
    v_accvgpr_read_b32 v15, a75
    v_accvgpr_read_b32 v16, a76
    v_accvgpr_read_b32 v17, a77
    v_accvgpr_read_b32 v18, a78
    v_accvgpr_read_b32 v19, a79
    v_accvgpr_read_b32 v20, a80
    v_accvgpr_read_b32 v21, a81
    v_accvgpr_read_b32 v22, a82
    v_accvgpr_read_b32 v23, a83
    v_accvgpr_read_b32 v80, a84
    v_accvgpr_read_b32 v81, a85
    v_accvgpr_read_b32 v82, a86
    v_accvgpr_read_b32 v83, a87
    v_accvgpr_read_b32 v84, a88
    v_accvgpr_read_b32 v85, a89
    v_accvgpr_read_b32 v86, a90
    v_accvgpr_read_b32 v87, a91
    v_accvgpr_read_b32 v88, a92
    v_accvgpr_read_b32 v89, a93
    v_accvgpr_read_b32 v90, a94
    v_accvgpr_read_b32 v91, a95
    v_mov_b32 v7, 159752
Lw_63:
    ds_read_b32 v8, v7
    s_waitcnt lgkmcnt(0)
    v_readfirstlane_b32 s54, v8
    s_cmp_ge_u32 s54, 4
    s_cbranch_scc1 Lwd_64
    s_sleep 1
    s_branch Lw_63
Lwd_64:
    ds_read_b128 v[24:27], v9 offset:0
    ds_read_b128 v[28:31], v9 offset:1024
    ds_read_b128 v[32:35], v9 offset:2048
    ds_read_b128 v[36:39], v9 offset:3072
    ds_read_b128 v[40:43], v9 offset:4096
    ds_read_b128 v[44:47], v9 offset:5120
    ds_read_b128 v[48:51], v9 offset:6144
    ds_read_b128 v[52:55], v9 offset:7168
    ds_read_b128 v[56:59], v9 offset:8192
    s_waitcnt lgkmcnt(3)
    ds_read_b128 v[92:95], v9 offset:9216
    ds_read_b128 v[96:99], v9 offset:10240
    ds_read_b128 v[100:103], v9 offset:11264
    ds_read_b128 v[104:107], v9 offset:12288
    ds_read_b128 v[108:111], v9 offset:13312
    ds_read_b128 v[112:115], v9 offset:14336
    ds_read_b128 v[116:119], v9 offset:15360
    ds_read_b128 v[120:123], v9 offset:16384
    ds_read_b128 v[124:127], v9 offset:17408
    s_mov_b32 s63, 0
    s_waitcnt lgkmcnt(9)
    v_pk_add_f32 v[12:13], v[12:13], v[24:25]
    v_pk_add_f32 v[14:15], v[14:15], v[26:27]
    v_pk_add_f32 v[16:17], v[16:17], v[28:29]
    v_pk_add_f32 v[18:19], v[18:19], v[30:31]
    v_pk_add_f32 v[20:21], v[20:21], v[32:33]
    v_pk_add_f32 v[22:23], v[22:23], v[34:35]
    v_pk_add_f32 v[36:37], v[36:37], v[48:49]
    v_pk_add_f32 v[38:39], v[38:39], v[50:51]
    v_pk_add_f32 v[40:41], v[40:41], v[52:53]
    v_pk_add_f32 v[42:43], v[42:43], v[54:55]
    v_pk_add_f32 v[44:45], v[44:45], v[56:57]
    v_pk_add_f32 v[46:47], v[46:47], v[58:59]
    v_pk_add_f32 v[12:13], v[12:13], v[36:37]
    v_pk_add_f32 v[14:15], v[14:15], v[38:39]
    v_pk_add_f32 v[16:17], v[16:17], v[40:41]
    v_pk_add_f32 v[18:19], v[18:19], v[42:43]
    v_pk_add_f32 v[20:21], v[20:21], v[44:45]
    v_pk_add_f32 v[22:23], v[22:23], v[46:47]
L_att_fin0:
    v_mov_b32 v28, v20
    v_mov_b32 v29, v20
    v_pk_add_f32 v[30:31], v[12:13], v[14:15]
    v_pk_add_f32 v[32:33], v[16:17], v[18:19]
    v_permlane32_swap_b32 v28, v29
    s_cmp_eq_u32 s63, -1
    s_cbranch_scc1 L_att_ok0
    v_pk_add_f32 v[30:31], v[30:31], v[20:21]
    v_pk_add_f32 v[32:33], v[32:33], v[22:23]
    s_mov_b32 s53, 0x21800000
    s_mov_b32 s54, 0x5d800000
    v_pk_add_f32 v[30:31], v[30:31], v[32:33]
    v_cmp_le_f32 vcc, s53, v29
    v_cmp_ge_f32 s[68:69], s54, v29
    v_add_f32 v30, v30, v31
    s_mov_b32 s53, 0x7f000000
    v_cmp_gt_f32 s[70:71], s53, abs(v30)
    s_and_b64 vcc, vcc, s[68:69]
    s_and_b64 vcc, vcc, s[70:71]
    s_cmp_eq_u64 vcc, -1
    s_cbranch_scc0 L_att_exact0
L_att_ok0:
    s_mov_b32 s63, 0
    v_rcp_f32 v29, v29
    s_add_u32 s53, s10, 0
    v_mov_b32 v28, v29
    v_pk_mul_f32 v[12:13], v[12:13], v[28:29]
    v_pk_mul_f32 v[14:15], v[14:15], v[28:29]
    v_pk_mul_f32 v[16:17], v[16:17], v[28:29]
    v_pk_mul_f32 v[18:19], v[18:19], v[28:29]
    v_pk_mul_f32 v[20:21], v[20:21], v[28:29]
    v_pk_mul_f32 v[22:23], v[22:23], v[28:29]
    v_cvt_pk_bf16_f32 v36, v12, v13
    v_cvt_pk_bf16_f32 v37, v14, v15
    v_cvt_pk_bf16_f32 v38, v16, v17
    v_cvt_pk_bf16_f32 v39, v18, v19
    v_cvt_pk_bf16_f32 v40, v20, v21
    v_cvt_pk_bf16_f32 v41, v22, v23
    v_min_u32 v36, -2, v36
    v_min_u32 v37, -2, v37
    v_min_u32 v38, -2, v38
    v_min_u32 v39, -2, v39
    v_min_u32 v40, -2, v40
    v_min_u32 v41, -2, v41
    buffer_store_dwordx4 v[36:39], v60, s[36:39], s53 offen sc1
    buffer_store_dwordx2 v[40:41], v10, s[36:39], s53 offen offset:1024 sc1
    s_waitcnt lgkmcnt(0)
    v_pk_add_f32 v[80:81], v[80:81], v[92:93]
    v_pk_add_f32 v[82:83], v[82:83], v[94:95]
    v_pk_add_f32 v[84:85], v[84:85], v[96:97]
    v_pk_add_f32 v[86:87], v[86:87], v[98:99]
    v_pk_add_f32 v[88:89], v[88:89], v[100:101]
    v_pk_add_f32 v[90:91], v[90:91], v[102:103]
    v_pk_add_f32 v[104:105], v[104:105], v[116:117]
    v_pk_add_f32 v[106:107], v[106:107], v[118:119]
    v_pk_add_f32 v[108:109], v[108:109], v[120:121]
    v_pk_add_f32 v[110:111], v[110:111], v[122:123]
    v_pk_add_f32 v[112:113], v[112:113], v[124:125]
    v_pk_add_f32 v[114:115], v[114:115], v[126:127]
    v_pk_add_f32 v[80:81], v[80:81], v[104:105]
    v_pk_add_f32 v[82:83], v[82:83], v[106:107]
    v_pk_add_f32 v[84:85], v[84:85], v[108:109]
    v_pk_add_f32 v[86:87], v[86:87], v[110:111]
    v_pk_add_f32 v[88:89], v[88:89], v[112:113]
    v_pk_add_f32 v[90:91], v[90:91], v[114:115]
L_att_fin1:
    v_mov_b32 v96, v88
    v_mov_b32 v97, v88
    v_pk_add_f32 v[98:99], v[80:81], v[82:83]
    v_pk_add_f32 v[100:101], v[84:85], v[86:87]
    v_permlane32_swap_b32 v96, v97
    s_cmp_eq_u32 s63, -1
    s_cbranch_scc1 L_att_ok1
    v_pk_add_f32 v[98:99], v[98:99], v[88:89]
    v_pk_add_f32 v[100:101], v[100:101], v[90:91]
    s_mov_b32 s53, 0x21800000
    s_mov_b32 s54, 0x5d800000
    v_pk_add_f32 v[98:99], v[98:99], v[100:101]
    v_cmp_le_f32 vcc, s53, v97
    v_cmp_ge_f32 s[68:69], s54, v97
    v_add_f32 v98, v98, v99
    s_mov_b32 s53, 0x7f000000
    v_cmp_gt_f32 s[70:71], s53, abs(v98)
    s_and_b64 vcc, vcc, s[68:69]
    s_and_b64 vcc, vcc, s[70:71]
    s_cmp_eq_u64 vcc, -1
    s_cbranch_scc0 L_att_exact1
L_att_ok1:
    s_mov_b32 s63, 0
    v_rcp_f32 v97, v97
    s_add_u32 s53, s10, 40960
    v_mov_b32 v96, v97
    v_pk_mul_f32 v[80:81], v[80:81], v[96:97]
    v_pk_mul_f32 v[82:83], v[82:83], v[96:97]
    v_pk_mul_f32 v[84:85], v[84:85], v[96:97]
    v_pk_mul_f32 v[86:87], v[86:87], v[96:97]
    v_pk_mul_f32 v[88:89], v[88:89], v[96:97]
    v_pk_mul_f32 v[90:91], v[90:91], v[96:97]
    v_cvt_pk_bf16_f32 v104, v80, v81
    v_cvt_pk_bf16_f32 v105, v82, v83
    v_cvt_pk_bf16_f32 v106, v84, v85
    v_cvt_pk_bf16_f32 v107, v86, v87
    v_cvt_pk_bf16_f32 v108, v88, v89
    v_cvt_pk_bf16_f32 v109, v90, v91
    v_min_u32 v104, -2, v104
    v_min_u32 v105, -2, v105
    v_min_u32 v106, -2, v106
    v_min_u32 v107, -2, v107
    v_min_u32 v108, -2, v108
    v_min_u32 v109, -2, v109
    buffer_store_dwordx4 v[104:107], v60, s[36:39], s53 offen sc1
    buffer_store_dwordx2 v[108:109], v10, s[36:39], s53 offen offset:1024 sc1
    v_mov_b32 v8, 159756
    v_mov_b32 v9, 1
    s_mov_b64 exec, 1
    ds_add_u32 v8, v9
    s_mov_b64 exec, -1
    s_endpgm
L_att_exact0:
    s_add_u32 s53, s16, 0
    s_mul_i32 s53, s53, 40960
    v_lshlrev_b32 v7, 30, v3
    v_add_u32 v7, v7, v5
    buffer_load_dwordx4 v[72:75], v4, s[36:39], s53 offen offset:0 sc1
    buffer_load_dwordx2 v[76:77], v7, s[36:39], s53 offen offset:0 sc1
    v_mov_b32 v78, 0xff800000
    s_mov_b32 s53, s9
    s_mov_b32 s63, 64
L_att_fb1_0:
    buffer_load_dwordx4 v[52:55], v4, s[36:39], s53 offen offset:0 sc1
    buffer_load_dwordx2 v[56:57], v5, s[36:39], s53 offen offset:0 sc1
    s_add_u32 s53, s53, 82560
    s_waitcnt vmcnt(0)
    v_mfma_f32_32x32x16_bf16 v[28:43], v[52:55], v[72:75], 0
    v_mfma_f32_32x32x8_bf16 v[28:43], v[56:57], v[76:77], v[28:43]
    s_nop 15
    v_max3_f32 v78, v78, v28, v29
    v_max3_f32 v78, v78, v30, v31
    v_max3_f32 v78, v78, v32, v33
    v_max3_f32 v78, v78, v34, v35
    v_max3_f32 v78, v78, v36, v37
    v_max3_f32 v78, v78, v38, v39
    v_max3_f32 v78, v78, v40, v41
    v_max3_f32 v78, v78, v42, v43
    s_sub_u32 s63, s63, 1
    s_cmp_lg_u32 s63, 0
    s_cbranch_scc1 L_att_fb1_0
    v_mov_b32 v79, v78
    s_nop 1
    v_permlane32_swap_b32 v78, v79
    s_nop 1
    v_max_f32 v78, v78, v79
    v_sub_f32 v78, 0, v78
    v_and_b32 v79, 0xffff0000, v78
    v_sub_f32 v78, v78, v79
    v_and_b32 v7, 0xffff0000, v78
    v_sub_f32 v78, v78, v7
    v_lshrrev_b32 v79, 16, v79
    s_mov_b32 exec_lo, 0
    v_or_b32 v76, v79, v7
    v_lshrrev_b32 v77, 16, v78
    s_mov_b32 exec_lo, -1
    v_mov_b32 v12, 0
    v_mov_b32 v13, 0
    v_mov_b32 v14, 0
    v_mov_b32 v15, 0
    v_mov_b32 v16, 0
    v_mov_b32 v17, 0
    v_mov_b32 v18, 0
    v_mov_b32 v19, 0
    v_mov_b32 v20, 0
    v_mov_b32 v21, 0
    v_mov_b32 v22, 0
    v_mov_b32 v23, 0
    v_mov_b32 v24, 0
    v_mov_b32 v25, 0
    v_mov_b32 v26, 0
    v_mov_b32 v27, 0
    s_mov_b32 s53, s9
    s_mov_b32 s63, 64
L_att_fb2_0:
    buffer_load_dwordx4 v[52:55], v4, s[36:39], s53 offen offset:0 sc1
    buffer_load_dwordx2 v[56:57], v5, s[36:39], s53 offen offset:0 sc1
    buffer_load_dwordx4 v[64:67], v6, s[36:39], s53 offen offset:0 sc1
    buffer_load_dwordx4 v[68:71], v0, s[36:39], s53 offen offset:0 sc1
    s_add_u32 s53, s53, 82560
    s_waitcnt vmcnt(0)
    v_mfma_f32_32x32x16_bf16 v[28:43], v[52:55], v[72:75], 0
    v_mfma_f32_32x32x8_bf16 v[28:43], v[56:57], v[76:77], v[28:43]
    s_nop 15
    v_exp_f32 v28, v28
    v_exp_f32 v29, v29
    v_exp_f32 v30, v30
    v_exp_f32 v31, v31
    v_exp_f32 v32, v32
    v_exp_f32 v33, v33
    v_exp_f32 v34, v34
    v_exp_f32 v35, v35
    v_exp_f32 v36, v36
    v_exp_f32 v37, v37
    v_exp_f32 v38, v38
    v_exp_f32 v39, v39
    v_exp_f32 v40, v40
    v_exp_f32 v41, v41
    v_exp_f32 v42, v42
    v_exp_f32 v43, v43
    v_mov_b32 v44, 0xdddddddd
    s_nop 1
    v_smfmac_f32_32x32x32_bf16 v[12:27], v[64:67], v[28:35], v44
    v_smfmac_f32_32x32x32_bf16 v[12:27], v[68:71], v[36:43], v44
    s_sub_u32 s63, s63, 1
    s_cmp_lg_u32 s63, 0
    s_cbranch_scc1 L_att_fb2_0
    s_nop 15
    s_mov_b32 s63, -1
    s_branch L_att_fin0
L_att_exact1:
    s_add_u32 s53, s16, 1
    s_mul_i32 s53, s53, 40960
    v_lshlrev_b32 v7, 30, v3
    v_add_u32 v7, v7, v5
    buffer_load_dwordx4 v[72:75], v4, s[36:39], s53 offen offset:0 sc1
    buffer_load_dwordx2 v[76:77], v7, s[36:39], s53 offen offset:0 sc1
    v_mov_b32 v78, 0xff800000
    s_mov_b32 s53, s9
    s_mov_b32 s63, 64
L_att_fb1_1:
    buffer_load_dwordx4 v[120:123], v4, s[36:39], s53 offen offset:0 sc1
    buffer_load_dwordx2 v[124:125], v5, s[36:39], s53 offen offset:0 sc1
    s_add_u32 s53, s53, 82560
    s_waitcnt vmcnt(0)
    v_mfma_f32_32x32x16_bf16 v[96:111], v[120:123], v[72:75], 0
    v_mfma_f32_32x32x8_bf16 v[96:111], v[124:125], v[76:77], v[96:111]
    s_nop 15
    v_max3_f32 v78, v78, v96, v97
    v_max3_f32 v78, v78, v98, v99
    v_max3_f32 v78, v78, v100, v101
    v_max3_f32 v78, v78, v102, v103
    v_max3_f32 v78, v78, v104, v105
    v_max3_f32 v78, v78, v106, v107
    v_max3_f32 v78, v78, v108, v109
    v_max3_f32 v78, v78, v110, v111
    s_sub_u32 s63, s63, 1
    s_cmp_lg_u32 s63, 0
    s_cbranch_scc1 L_att_fb1_1
    v_mov_b32 v79, v78
    s_nop 1
    v_permlane32_swap_b32 v78, v79
    s_nop 1
    v_max_f32 v78, v78, v79
    v_sub_f32 v78, 0, v78
    v_and_b32 v79, 0xffff0000, v78
    v_sub_f32 v78, v78, v79
    v_and_b32 v7, 0xffff0000, v78
    v_sub_f32 v78, v78, v7
    v_lshrrev_b32 v79, 16, v79
    s_mov_b32 exec_lo, 0
    v_or_b32 v76, v79, v7
    v_lshrrev_b32 v77, 16, v78
    s_mov_b32 exec_lo, -1
    v_mov_b32 v80, 0
    v_mov_b32 v81, 0
    v_mov_b32 v82, 0
    v_mov_b32 v83, 0
    v_mov_b32 v84, 0
    v_mov_b32 v85, 0
    v_mov_b32 v86, 0
    v_mov_b32 v87, 0
    v_mov_b32 v88, 0
    v_mov_b32 v89, 0
    v_mov_b32 v90, 0
    v_mov_b32 v91, 0
    v_mov_b32 v92, 0
    v_mov_b32 v93, 0
    v_mov_b32 v94, 0
    v_mov_b32 v95, 0
    s_mov_b32 s53, s9
    s_mov_b32 s63, 64
L_att_fb2_1:
    buffer_load_dwordx4 v[120:123], v4, s[36:39], s53 offen offset:0 sc1
    buffer_load_dwordx2 v[124:125], v5, s[36:39], s53 offen offset:0 sc1
    buffer_load_dwordx4 v[64:67], v6, s[36:39], s53 offen offset:0 sc1
    buffer_load_dwordx4 v[68:71], v0, s[36:39], s53 offen offset:0 sc1
    s_add_u32 s53, s53, 82560
    s_waitcnt vmcnt(0)
    v_mfma_f32_32x32x16_bf16 v[96:111], v[120:123], v[72:75], 0
    v_mfma_f32_32x32x8_bf16 v[96:111], v[124:125], v[76:77], v[96:111]
    s_nop 15
    v_exp_f32 v96, v96
    v_exp_f32 v97, v97
    v_exp_f32 v98, v98
    v_exp_f32 v99, v99
    v_exp_f32 v100, v100
    v_exp_f32 v101, v101
    v_exp_f32 v102, v102
    v_exp_f32 v103, v103
    v_exp_f32 v104, v104
    v_exp_f32 v105, v105
    v_exp_f32 v106, v106
    v_exp_f32 v107, v107
    v_exp_f32 v108, v108
    v_exp_f32 v109, v109
    v_exp_f32 v110, v110
    v_exp_f32 v111, v111
    v_mov_b32 v112, 0xdddddddd
    s_nop 1
    v_smfmac_f32_32x32x32_bf16 v[80:95], v[64:67], v[96:103], v112
    v_smfmac_f32_32x32x32_bf16 v[80:95], v[68:71], v[104:111], v112
    s_sub_u32 s63, s63, 1
    s_cmp_lg_u32 s63, 0
    s_cbranch_scc1 L_att_fb2_1
    s_nop 15
    s_mov_b32 s63, -1
    s_branch L_att_fin1
L_end:
    s_endpgm
.section .rodata,"a"
.p2align 6
.amdhsa_kernel gated_mix__mha_block__swiglu_ffn__prompt_kernel
  .amdhsa_next_free_vgpr 256
  .amdhsa_next_free_sgpr 102
  .amdhsa_accum_offset 128
  .amdhsa_group_segment_fixed_size 0
  .amdhsa_kernarg_size 88
  .amdhsa_user_sgpr_count 2
  .amdhsa_user_sgpr_kernarg_segment_ptr 1
  .amdhsa_system_sgpr_workgroup_id_x 1
.end_amdhsa_kernel
```
